```python
import torch

def _softmax(x, axis=-1):
    return torch.softmax(x, dim=axis)
def _gelu(x):
    return torch.nn.functional.gelu(x, approximate="tanh")
def _silu(x):
    return torch.nn.functional.silu(x)
def _sigmoid(x):
    return torch.sigmoid(x)
def _layernorm(x, axis=-1, eps=1e-5):
    m = x.mean(dim=axis, keepdim=True)
    v = x.var(dim=axis, keepdim=True, unbiased=False)
    return (x - m) / torch.sqrt(v + eps)
def _scatter_add(tgt, idx, src, axis=0):
    return tgt.clone().index_add_(axis, idx, src)
def _segment_sum(src, seg, n):
    out = torch.zeros((n,) + src.shape[1:], dtype=src.dtype)
    return out.index_add_(0, seg, src)
def _pad(x, pw):
    flat = tuple(v for pair in reversed(pw) for v in pair)
    return torch.nn.functional.pad(x, flat)

kernel_name = 'sequential_preLN__ssm_conv_s4__swiglu_ffn__prompt'

def setup_inputs():

    _w = (lambda a: (lambda t: t.to(torch.bfloat16) if t.is_floating_point() else t)(torch.as_tensor(a)))
    def _A_setup():
        B, L, D, N = 1, 2048, 640, 192
        A_re = -(lambda _x: torch.exp(torch.as_tensor(_x)))((lambda *s: torch.randn(*s, dtype=torch.bfloat16) * 3.2)(D, N))
        A_im = torch.pi * (lambda *s: torch.randn(*s, dtype=torch.bfloat16) * 0.05)(D, N)
        B_re = (lambda *s: torch.randn(*s, dtype=torch.bfloat16) * 0.05)(D, N)
        B_im = (lambda *s: torch.randn(*s, dtype=torch.bfloat16) * 0.05)(D, N)
        C_re = (lambda *s: torch.randn(*s, dtype=torch.bfloat16) * 0.05)(D, N)
        C_im = (lambda *s: torch.randn(*s, dtype=torch.bfloat16) * 0.05)(D, N)
        log_dt = (lambda *s: torch.randn(*s, dtype=torch.bfloat16) * 0.05)(D) * 0.5 - 4.0
        Dskip = (lambda *s: torch.randn(*s, dtype=torch.bfloat16) * 0.05)(D)
        return {
            "u": _w((lambda *s: torch.randn(*s, dtype=torch.bfloat16) * 0.05)(B, L, D)),
            "A_re": _w(A_re),
            "A_im": _w(A_im),
            "B_re": _w(B_re),
            "B_im": _w(B_im),
            "C_re": _w(C_re),
            "C_im": _w(C_im),
            "log_dt": _w(log_dt),
            "Dskip": _w(Dskip),
        }
    _A_in = _A_setup()

    def _B_setup():
        B, S, D, F = 1, 2048, 640, 1536
        return {
            "x": _w((lambda *s: torch.randn(*s, dtype=torch.bfloat16) * 0.05)(B, S, D)),
            "w_gate": _w((lambda *s: torch.randn(*s, dtype=torch.bfloat16) * 0.05)(D, F)),
            "w_up": _w((lambda *s: torch.randn(*s, dtype=torch.bfloat16) * 0.05)(D, F)),
            "w_down": _w((lambda *s: torch.randn(*s, dtype=torch.bfloat16) * 0.05)(F, D)),
        }
    _B_in = _B_setup()

    return {
        "A_u": _A_in["u"],
        "A_A_re": _A_in["A_re"],
        "A_A_im": _A_in["A_im"],
        "A_B_re": _A_in["B_re"],
        "A_B_im": _A_in["B_im"],
        "A_C_re": _A_in["C_re"],
        "A_C_im": _A_in["C_im"],
        "A_log_dt": _A_in["log_dt"],
        "A_Dskip": _A_in["Dskip"],
        "B_x": _B_in["x"],
        "B_w_gate": _B_in["w_gate"],
        "B_w_up": _B_in["w_up"],
        "B_w_down": _B_in["w_down"],
    }

def reference(A_u, A_A_re, A_A_im, A_B_re, A_B_im, A_C_re, A_C_im, A_log_dt, A_Dskip, B_x, B_w_gate, B_w_up, B_w_down):
    def _A_ref(u, A_re, A_im, B_re, B_im, C_re, C_im, log_dt, Dskip):
        Bsz, L, D = u.shape
        dt = torch.exp(log_dt)[:, None]
        A = A_re + 1j * A_im
        Bc = B_re + 1j * B_im
        Cc = C_re + 1j * C_im
        logdA = dt * A
        dB = dt * Bc
        l = (lambda x, dt: x.to(dt))(torch.arange(L), A_re.dtype)
        P = torch.exp(logdA[:, :, None] * l[None, None, :])
        K = torch.einsum("dn,dnl,dn->dl", Cc, P, dB).real
        L2 = 2 * L
        Kp = _pad(K, ((0, 0), (0, L)))
        up = (lambda x, *d: x.permute(*d))(u, 0, 2, 1)
        up = _pad(up, ((0, 0), (0, 0), (0, L)))
        Kf = (lambda x, axes=(-2,-1): torch.fft.rfft2(x.float(), dim=axes))(Kp[:, None, :], axes=(-2, -1))
        Uf = (lambda x, axes=(-2,-1): torch.fft.rfft2(x.float(), dim=axes))(up[:, :, None, :], axes=(-2, -1))
        Yf = Uf * Kf[None, :, :, :]
        y = (lambda x, s, axes=(-2,-1): torch.fft.irfft2(x, s=s, dim=axes).to(torch.bfloat16))(Yf, (1, L2), axes=(-2, -1))[:, :, 0, :L]
        y = (lambda x, *d: x.permute(*d))(y, 0, 2, 1) + u * Dskip[None, None, :]
        return y

    def _B_ref(x, w_gate, w_up, w_down):
        g = _silu(x @ w_gate)
        u = x @ w_up
        return (g * u) @ w_down

    x = A_u
    h = x + _A_ref(_layernorm(x, axis=-1), A_A_re, A_A_im, A_B_re, A_B_im, A_C_re, A_C_im, A_log_dt, A_Dskip)
    h2 = h + _B_ref(_layernorm(h, axis=-1), B_w_gate, B_w_up, B_w_down)
    return h2
```

```asm
; @launch grid=(256,1,1) block=(256,1,1) lds=163840
.amdgcn_target "amdgcn-amd-amdhsa--gfx950"
.text
.p2align 12
.globl sequential_preLN__ssm_conv_s4__swiglu_ffn__prompt_kernel
.p2align 8
.type sequential_preLN__ssm_conv_s4__swiglu_ffn__prompt_kernel,@function
sequential_preLN__ssm_conv_s4__swiglu_ffn__prompt_kernel:
    s_load_dwordx16 s[4:19], s[0:1], 0
    s_load_dwordx16 s[20:35], s[0:1], 64
    s_getpc_b64 s[54:55]
L_pc:
    s_cmp_ge_u32 s2, 256
    s_cbranch_scc1 L_end
    s_lshr_b32 s47, s2, 3
    v_lshrrev_b32 v5, 3, v0
    v_min_u32 v5, 18, v5
    s_lshl_b32 s49, s47, 7
    v_lshl_add_u32 v5, v5, 12, s49
    v_lshrrev_b32 v7, 6, v0
    v_and_b32 v1, 63, v0
    global_load_dword v5, v5, s[54:55]
    v_readfirstlane_b32 s44, v7
    v_lshlrev_b32 v6, 4, v1
    v_lshrrev_b32 v23, 5, v0
    v_and_b32 v22, 31, v0
    v_mul_u32_u24 v7, 1280, v23
    s_mul_i32 s49, s2, 10240
    v_add_u32 v7, s49, v7
    v_lshl_add_u32 v18, v22, 4, v7
    v_lshl_add_u32 v19, v22, 3, v7
    v_mul_u32_u24 v23, 1312, v23
    v_add_u32 v23, 85760, v23
    v_lshl_add_u32 v76, v22, 4, v23
    v_lshl_add_u32 v77, v22, 3, v23
    s_min_u32 s49, s2, 159
    s_lshl_b32 s49, s49, 2
    s_add_u32 s49, s49, s44
    s_mul_i32 s50, s49, 384
    s_lshl_b32 s51, s49, 1
    v_lshl_add_u32 v94, v1, 2, s50
    v_lshl_add_u32 v95, v1, 1, s50
    v_mov_b32 v93, s51
    s_mov_b32 s38, 34603008
    s_mov_b32 s39, 0x20000
    s_mov_b32 s53, 0x3f803f80
    v_mov_b32 v4, 1
    s_mov_b32 s42, 256
    s_mov_b32 s43, 0x20000
    s_sub_u32 s49, s2, 160
    s_lshl_b32 s49, s49, 2
    s_add_u32 s49, s49, s44
    s_cmp_lt_u32 s49, 7
    s_waitcnt lgkmcnt(0)
    s_mov_b32 s36, s34
    s_mov_b32 s37, s35
    s_cbranch_scc0 L_noinit
    v_mov_b64 v[24:25], 0
    v_mov_b64 v[26:27], 0
    s_lshl_b32 s50, s49, 12
    buffer_store_dwordx4 v[24:27], v6, s[36:39], s50 offen sc1
    buffer_store_dwordx4 v[24:27], v6, s[36:39], s50 offen offset:1024 sc1
    buffer_store_dwordx4 v[24:27], v6, s[36:39], s50 offen offset:2048 sc1
    buffer_store_dwordx4 v[24:27], v6, s[36:39], s50 offen offset:3072 sc1
L_noinit:
    global_load_dwordx4 v[8:11], v18, s[4:5]
    global_load_dwordx4 v[12:15], v18, s[4:5] offset:512
    global_load_dwordx2 v[16:17], v19, s[4:5] offset:1024
    s_mov_b32 s40, s32
    s_mov_b32 s41, s33
    s_cmp_eq_u32 s2, 160
    s_cbranch_scc0 L_noflag
    v_mov_b64 v[28:29], 1
    v_mov_b64 v[30:31], 1
    v_lshrrev_b32 v26, 2, v1
    v_lshl_add_u32 v26, v26, 8, v6
    s_lshl_b32 s50, s44, 6
    s_waitcnt vmcnt(3)
    buffer_store_dwordx4 v[28:31], v26, s[40:43], s50 offen sc1
L_noflag:
    v_bfe_u32 v78, v1, 2, 2
    v_mul_u32_u24 v78, 1312, v78
    v_and_b32 v79, 1, v1
    v_xor_b32 v79, 1, v79
    v_mul_u32_u24 v79, 10624, v79
    v_and_b32 v23, 48, v1
    v_add3_u32 v78, v78, v79, v23
    v_and_b32 v23, 2, v1
    v_lshl_add_u32 v78, v23, 2, v78
    s_mul_i32 s49, s44, 320
    s_add_u32 s49, s49, 85760
    v_add_u32 v78, s49, v78
    s_bfe_u32 s49, s2, 0x30001
    v_and_b32 v79, 7, v1
    v_xor_b32 v79, s49, v79
    v_lshlrev_b32 v79, 4, v79
    v_lshrrev_b32 v23, 3, v1
    v_mul_u32_u24 v23, 32896, v23
    v_add_u32 v79, v23, v79
    s_lshl_b32 s56, s2, 7
    s_mul_i32 s49, s44, 1315840
    s_add_u32 s56, s56, s49
    s_add_u32 s56, s56, 1048576
    global_load_ushort v92, v93, s[18:19]
    global_load_ushort v93, v93, s[20:21]
    global_load_dword v80, v94, s[6:7]
    global_load_dword v81, v94, s[8:9]
    global_load_dword v82, v94, s[10:11]
    global_load_dword v83, v94, s[12:13]
    global_load_dword v84, v94, s[14:15]
    global_load_dword v85, v94, s[16:17]
    global_load_ushort v86, v95, s[6:7] offset:256
    global_load_ushort v87, v95, s[8:9] offset:256
    global_load_ushort v88, v95, s[10:11] offset:256
    global_load_ushort v89, v95, s[12:13] offset:256
    global_load_ushort v90, v95, s[14:15] offset:256
    global_load_ushort v91, v95, s[16:17] offset:256
    s_and_b32 s50, s47, 3
    s_and_b32 s49, s2, 3
    s_lshl_b32 s49, s49, 2
    s_add_u32 s46, s49, s50
    s_lshl_b32 s50, s50, 1
    s_lshr_b32 s49, s47, 2
    s_add_u32 s50, s50, s49
    s_and_b32 s50, s50, 7
    s_and_b32 s49, s2, 4
    s_lshl_b32 s49, s49, 1
    s_add_u32 s45, s49, s50
    s_add_u32 s60, s54, K_ctab-L_pc+4096
    s_addc_u32 s61, s55, 0
    s_mul_i32 s49, s44, 11264
    s_add_u32 s60, s60, s49
    s_addc_u32 s61, s61, 0
    s_mov_b32 s48, 0x40000
    v_mov_b32 v7, 2147483632
    v_cmp_ne_u32 vcc, 0, v0
    v_cmp_gt_u32 s[58:59], 16, v0
    v_lshlrev_b32 v23, 8, v0
    v_cndmask_b32 v2, 0, v7, vcc
    v_cndmask_b32 v3, v7, v23, s[58:59]
    v_cndmask_b32 v255, v7, 0, s[58:59]
    v_lshrrev_b32 v253, 2, v3
    v_and_b32 v253, 0xfffffcff, v253
    s_and_b32 s33, s2, 15
    s_lshl_b32 s33, s33, 8
    s_cmp_ge_u32 s44, 2
    s_cselect_b64 s[8:9], s[26:27], s[24:25]
    s_mov_b32 s10, 1966080
    s_mov_b32 s11, 0x20000
    s_cselect_b32 s49, 16, 0
    s_mul_i32 s13, s44, 3072
    s_add_u32 s13, s13, s49
    s_and_b32 s49, s44, 1
    s_mul_i32 s49, s49, 192
    v_add_u32 v20, s49, v1
    s_mul_i32 s50, s46, 192
    v_lshl_add_u32 v21, v20, 4, s50
    s_mov_b32 s51, 2880
    v_mul_u32_u24 v224, 5462, v20
    v_add_u32 v20, 64, v20
    v_lshrrev_b32 v224, 16, v224
    v_and_b32 v22, 4, v224
    v_mad_u32_u24 v224, v224, s51, v21
    v_lshlrev_b32 v22, 3, v22
    v_xor_b32 v224, v224, v22
    v_mul_u32_u24 v225, 5462, v20
    v_add_u32 v20, 64, v20
    v_lshrrev_b32 v225, 16, v225
    v_and_b32 v22, 4, v225
    v_mad_u32_u24 v225, v225, s51, v21
    v_lshlrev_b32 v22, 3, v22
    v_xor_b32 v225, v225, v22
    v_mul_u32_u24 v226, 5462, v20
    v_add_u32 v20, 64, v20
    v_lshrrev_b32 v226, 16, v226
    v_and_b32 v22, 4, v226
    v_mad_u32_u24 v226, v226, s51, v21
    v_lshlrev_b32 v22, 3, v22
    v_xor_b32 v226, v226, v22
    v_lshrrev_b32 v20, 2, v1
    v_mul_u32_u24 v20, 192, v20
    v_add_u32 v20, 137024, v20
    s_mul_i32 s49, s44, 48
    v_and_b32 v21, 3, v1
    v_lshl_add_u32 v21, v21, 3, s49
    v_and_b32 v22, 16, v1
    v_lshlrev_b32 v22, 1, v22
    v_xor_b32 v21, v21, v22
    v_add_u32 v232, v20, v21
    s_add_u32 s49, s49, 32
    v_xor_b32 v22, s49, v22
    v_and_b32 v21, 1, v1
    v_lshl_add_u32 v22, v21, 3, v22
    v_bfe_u32 v21, v1, 1, 1
    v_mul_u32_u24 v21, 6160, v21
    v_add3_u32 v233, v20, v21, v22
    v_subrev_u32 v234, 120640, v232
    v_subrev_u32 v235, 120640, v233
    v_subrev_u32 v236, 137024, v232
    v_subrev_u32 v237, 137024, v233
    s_add_u32 s54, s54, K_ramp1-L_pc
    s_addc_u32 s55, s55, 0
    s_load_dwordx16 s[64:79], s[54:55], 0
    s_load_dwordx4 s[80:83], s[54:55], 64
    s_mul_i32 s12, s44, 16592
    s_mov_b32 m0, s12
    v_and_b32 v24, 31, v1
    v_mul_u32_u24 v24, 272, v24
    v_lshrrev_b32 v25, 5, v1
    v_lshl_add_u32 v24, v25, 4, v24
    v_add_u32 v96, s12, v24
    v_mov_b64 v[28:29], 0
    v_mov_b64 v[30:31], 0
    v_min_u32 v24, 239, v0
    v_lshlrev_b32 v24, 4, v24
    v_add_u32 v24, 81920, v24
    ds_write_b128 v24, v[28:31]
    s_bfe_u32 s15, s2, 0x10002
    s_mul_i32 s15, s15, 3
    s_lshr_b32 s49, s47, 2
    s_add_u32 s15, s15, s49
    s_sub_u32 s15, s15, 5
    s_mul_i32 s14, s15, 196608
    s_mul_i32 s50, s2, 4608
    s_add_u32 s50, s50, 786432
    v_bfe_u32 v20, v0, 1, 6
    v_min_u32 v21, 35, v20
    v_lshl_add_u32 v21, v21, 7, s50
    s_mul_i32 s50, s2, 4992
    v_min_u32 v20, 38, v20
    v_lshl_add_u32 v20, v20, 7, s50
    global_load_dwordx4 v[200:203], v6, s[60:61] offset:-4096
    global_load_dwordx4 v[208:211], v6, s[60:61] offset:-3072
    global_load_dwordx4 v[244:247], v6, s[60:61] offset:-2048
    global_load_dwordx4 v[248:251], v6, s[60:61] offset:-1024
    s_add_u32 s60, s60, 4096
    s_addc_u32 s61, s61, 0
    s_mul_i32 s49, s45, 82048
    s_lshl_b32 s50, s44, 10
    s_add_u32 s49, s49, s50
    s_add_u32 s49, s49, 6422528
    v_add_u32 v254, s49, v6
    s_lshl_b32 s49, s46, 2
    s_add_u32 s49, s49, s44
    s_mul_i32 s49, s49, 61440
    s_add_u32 s49, s49, 9437184
    v_add_u32 v252, s49, v6
    s_lshl_b32 s16, s46, 8
    s_add_u32 s16, s16, 4096
    s_mov_b64 exec, 0
    s_cmp_eq_u32 s44, 0
    s_cbranch_scc1 L_pg0
    s_cmp_eq_u32 s44, 1
    s_cbranch_scc1 L_pg1
    s_cmp_eq_u32 s44, 2
    s_cbranch_scc1 L_pg2
    s_branch L_pg3
L_pgback:
    s_mov_b64 exec, -1
    s_waitcnt vmcnt(20)
    ds_write_b128 v76, v[8:11]
    s_waitcnt vmcnt(19)
    ds_write_b128 v76, v[12:15] offset:512
    s_waitcnt vmcnt(18)
    ds_write_b64 v77, v[16:17] offset:1024
    buffer_load_dword v21, v21, s[8:11], 0 offen
    v_dot2_f32_bf16 v18, v8, s53, 0
    v_dot2_f32_bf16 v22, v8, v8, 0
    v_dot2_f32_bf16 v19, v9, s53, 0
    v_dot2_f32_bf16 v23, v9, v9, 0
    v_dot2_f32_bf16 v18, v10, s53, v18
    v_dot2_f32_bf16 v22, v10, v10, v22
    v_dot2_f32_bf16 v19, v11, s53, v19
    v_dot2_f32_bf16 v23, v11, v11, v23
    v_dot2_f32_bf16 v18, v12, s53, v18
    v_dot2_f32_bf16 v22, v12, v12, v22
    v_dot2_f32_bf16 v19, v13, s53, v19
    v_dot2_f32_bf16 v23, v13, v13, v23
    v_dot2_f32_bf16 v18, v14, s53, v18
    v_dot2_f32_bf16 v22, v14, v14, v22
    v_dot2_f32_bf16 v19, v15, s53, v19
    v_dot2_f32_bf16 v23, v15, v15, v23
    v_dot2_f32_bf16 v18, v16, s53, v18
    v_dot2_f32_bf16 v22, v16, v16, v22
    v_dot2_f32_bf16 v19, v17, s53, v19
    v_dot2_f32_bf16 v23, v17, v17, v23
    v_lshlrev_b32 v24, 16, v8
    v_and_b32 v25, 0xffff0000, v8
    v_lshlrev_b32 v26, 16, v9
    v_and_b32 v27, 0xffff0000, v9
    v_add_f32 v18, v18, v19
    v_add_f32 v22, v22, v23
    v_lshlrev_b32 v28, 16, v10
    v_and_b32 v29, 0xffff0000, v10
    v_add_f32_dpp v18, v18, v18 row_ror:8 row_mask:0xf bank_mask:0xf
    v_add_f32_dpp v22, v22, v22 row_ror:8 row_mask:0xf bank_mask:0xf
    v_lshlrev_b32 v30, 16, v11
    v_and_b32 v31, 0xffff0000, v11
    v_add_f32_dpp v18, v18, v18 row_ror:4 row_mask:0xf bank_mask:0xf
    v_add_f32_dpp v22, v22, v22 row_ror:4 row_mask:0xf bank_mask:0xf
    v_lshlrev_b32 v32, 16, v12
    v_and_b32 v33, 0xffff0000, v12
    v_add_f32_dpp v18, v18, v18 row_ror:2 row_mask:0xf bank_mask:0xf
    v_add_f32_dpp v22, v22, v22 row_ror:2 row_mask:0xf bank_mask:0xf
    v_lshlrev_b32 v34, 16, v13
    v_and_b32 v35, 0xffff0000, v13
    v_add_f32_dpp v18, v18, v18 row_ror:1 row_mask:0xf bank_mask:0xf
    v_add_f32_dpp v22, v22, v22 row_ror:1 row_mask:0xf bank_mask:0xf
    v_mov_b32 v19, v18
    v_mov_b32 v23, v22
    v_lshlrev_b32 v36, 16, v14
    v_and_b32 v37, 0xffff0000, v14
    v_permlane16_swap_b32 v18, v19
    v_permlane16_swap_b32 v22, v23
    v_lshlrev_b32 v38, 16, v15
    v_and_b32 v39, 0xffff0000, v15
    v_add_f32 v18, v18, v19
    v_add_f32 v22, v22, v23
    v_mul_f32 v18, 986500301, v18
    v_mul_f32 v22, 986500301, v22
    v_fma_f32 v22, -v18, v18, v22
    v_max_f32 v22, 0, v22
    v_add_f32 v22, 925353388, v22
    v_rsq_f32 v22, v22
    v_lshlrev_b32 v40, 16, v16
    v_and_b32 v41, 0xffff0000, v16
    v_lshlrev_b32 v42, 16, v17
    v_and_b32 v43, 0xffff0000, v17
    v_mul_f32_e64 v23, -v18, v22
    v_pk_fma_f32 v[24:25], v[24:25], v[22:23], v[22:23] op_sel:[0,0,1] op_sel_hi:[1,0,1]
    v_pk_fma_f32 v[26:27], v[26:27], v[22:23], v[22:23] op_sel:[0,0,1] op_sel_hi:[1,0,1]
    v_pk_fma_f32 v[28:29], v[28:29], v[22:23], v[22:23] op_sel:[0,0,1] op_sel_hi:[1,0,1]
    v_pk_fma_f32 v[30:31], v[30:31], v[22:23], v[22:23] op_sel:[0,0,1] op_sel_hi:[1,0,1]
    v_pk_fma_f32 v[32:33], v[32:33], v[22:23], v[22:23] op_sel:[0,0,1] op_sel_hi:[1,0,1]
    v_pk_fma_f32 v[34:35], v[34:35], v[22:23], v[22:23] op_sel:[0,0,1] op_sel_hi:[1,0,1]
    v_pk_fma_f32 v[36:37], v[36:37], v[22:23], v[22:23] op_sel:[0,0,1] op_sel_hi:[1,0,1]
    v_pk_fma_f32 v[38:39], v[38:39], v[22:23], v[22:23] op_sel:[0,0,1] op_sel_hi:[1,0,1]
    v_pk_fma_f32 v[40:41], v[40:41], v[22:23], v[22:23] op_sel:[0,0,1] op_sel_hi:[1,0,1]
    v_pk_fma_f32 v[42:43], v[42:43], v[22:23], v[22:23] op_sel:[0,0,1] op_sel_hi:[1,0,1]
    v_cvt_pk_bf16_f32 v44, v24, v25
    v_cvt_pk_bf16_f32 v45, v26, v27
    v_cvt_pk_bf16_f32 v46, v28, v29
    v_cvt_pk_bf16_f32 v47, v30, v31
    ds_write_b128 v76, v[44:47] offset:10624
    v_cvt_pk_bf16_f32 v48, v32, v33
    v_cvt_pk_bf16_f32 v49, v34, v35
    v_cvt_pk_bf16_f32 v50, v36, v37
    v_cvt_pk_bf16_f32 v51, v38, v39
    ds_write_b128 v76, v[48:51] offset:11136
    v_cvt_pk_bf16_f32 v52, v40, v41
    v_cvt_pk_bf16_f32 v53, v42, v43
    ds_write_b64 v77, v[52:53] offset:11648
    s_waitcnt vmcnt(18)
    v_lshlrev_b32 v92, 16, v92
    v_mul_f32 v92, 1069066811, v92
    v_exp_f32 v92, v92
    v_mov_b32 v160, 0x3f80
    v_cvt_pk_bf16_f32 v92, v92, v92
    v_and_b32 v92, 0xffff0000, v92
    s_waitcnt lgkmcnt(0)
    s_barrier
    ds_read_b64_tr_b16 v[56:57], v78 offset:0
    ds_read_b64_tr_b16 v[58:59], v78 offset:5248
    ds_read_b64_tr_b16 v[60:61], v78 offset:64
    ds_read_b64_tr_b16 v[62:63], v78 offset:5312
    ds_read_b64_tr_b16 v[64:65], v78 offset:128
    ds_read_b64_tr_b16 v[66:67], v78 offset:5376
    ds_read_b64_tr_b16 v[68:69], v78 offset:192
    ds_read_b64_tr_b16 v[70:71], v78 offset:5440
    ds_read_b64_tr_b16 v[72:73], v78 offset:256
    ds_read_b64_tr_b16 v[74:75], v78 offset:5504
    v_mul_f32 v94, 1069066811, v92
    v_mul_f32 v95, 0.15915494, v92
    s_waitcnt vmcnt(16)
    v_lshlrev_b32 v8, 16, v80
    s_waitcnt vmcnt(15)
    v_lshlrev_b32 v9, 16, v81
    s_waitcnt vmcnt(14)
    v_lshlrev_b32 v10, 16, v82
    s_waitcnt vmcnt(13)
    v_lshlrev_b32 v11, 16, v83
    s_waitcnt vmcnt(12)
    v_lshlrev_b32 v12, 16, v84
    s_waitcnt vmcnt(11)
    v_lshlrev_b32 v13, 16, v85
    v_mul_f32 v100, v94, v8
    v_mul_f32 v101, v95, v9
    s_waitcnt lgkmcnt(8)
    buffer_store_dwordx4 v[56:59], v79, s[36:39], s56 offen sc1
    v_mul_f32 v10, v92, v10
    v_mul_f32 v11, v92, v11
    v_mul_f32 v36, v12, v10
    v_mul_f32 v37, v12, v11
    v_mul_f32 v102, 1090519040, v100
    v_mul_f32 v103, 1090519040, v101
    s_add_u32 s56, s56, 263168
    s_waitcnt lgkmcnt(6)
    buffer_store_dwordx4 v[60:63], v79, s[36:39], s56 offen sc1
    v_mul_f32 v104, 1124073472, v100
    v_mul_f32 v105, 1124073472, v101
    v_fma_f32 v36, -v13, v11, v36
    v_fma_f32 v37, v13, v10, v37
    v_fract_f32 v101, v101
    v_exp_f32 v100, v100
    s_add_u32 s56, s56, 263168
    s_waitcnt lgkmcnt(4)
    buffer_store_dwordx4 v[64:67], v79, s[36:39], s56 offen sc1
    v_fract_f32 v103, v103
    v_exp_f32 v102, v102
    v_fract_f32 v105, v105
    v_exp_f32 v104, v104
    v_cos_f32 v30, v101
    v_sin_f32 v31, v101
    s_add_u32 s56, s56, 263168
    s_waitcnt lgkmcnt(2)
    buffer_store_dwordx4 v[68:71], v79, s[36:39], s56 offen sc1
    v_cos_f32 v32, v103
    v_sin_f32 v33, v103
    v_cos_f32 v34, v105
    v_sin_f32 v35, v105
    v_mul_f32 v30, v100, v30
    v_mul_f32 v31, v100, v31
    s_add_u32 s56, s56, 263168
    s_waitcnt lgkmcnt(0)
    buffer_store_dwordx4 v[72:75], v79, s[36:39], s56 offen sc1
    v_mul_f32 v32, v102, v32
    v_mul_f32 v33, v102, v33
    v_mul_f32 v34, v104, v34
    v_mul_f32 v35, v104, v35
    buffer_load_dword v5, v253, s[40:43], 0 offen sc1
    s_cmp_ge_u32 s2, 160
    s_cbranch_scc1 L_helper
    v_pk_mul_f32 v[64:65], v[34:35], v[34:35] op_sel:[0,0] op_sel_hi:[1,0]
    v_cvt_pk_bf16_f32 v176, v34, v35
    v_cvt_pk_bf16_f32 v128, v36, -v37
    v_pk_fma_f32 v[42:43], v[34:35], v[34:35], v[64:65] op_sel:[1,1,0] op_sel_hi:[0,1,1] neg_lo:[1,0,0]
    v_pk_mul_f32 v[52:53], v[34:35], v[32:33] op_sel:[0,0] op_sel_hi:[1,0]
    v_pk_mul_f32 v[58:59], v[36:37], v[30:31] op_sel:[0,0] op_sel_hi:[1,0]
    v_pk_mul_f32 v[64:65], v[36:37], v[42:43] op_sel:[0,0] op_sel_hi:[1,0]
    v_pk_fma_f32 v[50:51], v[34:35], v[32:33], v[52:53] op_sel:[1,1,0] op_sel_hi:[0,1,1] neg_lo:[1,0,0]
    v_pk_fma_f32 v[56:57], v[36:37], v[30:31], v[58:59] op_sel:[1,1,0] op_sel_hi:[0,1,1] neg_lo:[1,0,0]
    v_pk_fma_f32 v[62:63], v[36:37], v[42:43], v[64:65] op_sel:[1,1,0] op_sel_hi:[0,1,1] neg_lo:[1,0,0]
    v_cvt_pk_bf16_f32 v161, v32, v33
    v_cvt_pk_bf16_f32 v177, v50, v51
    v_cvt_pk_bf16_f32 v129, v56, -v57
    ds_write_addtid_b32 v176 offset:12240
    ds_write_addtid_b32 v128 offset:0
    ds_write_addtid_b32 v161 offset:8160
    ds_write_addtid_b32 v177 offset:12512
    ds_write_addtid_b32 v129 offset:272
    ds_write_addtid_b32 v160 offset:7888
    v_cvt_pk_bf16_f32 v144, v62, -v63
    v_pk_mul_f32 v[46:47], v[32:33], v[32:33] op_sel:[0,0] op_sel_hi:[1,0]
    v_pk_mul_f32 v[52:53], v[50:51], v[32:33] op_sel:[0,0] op_sel_hi:[1,0]
    v_pk_mul_f32 v[58:59], v[56:57], v[30:31] op_sel:[0,0] op_sel_hi:[1,0]
    v_pk_mul_f32 v[64:65], v[62:63], v[42:43] op_sel:[0,0] op_sel_hi:[1,0]
    v_pk_fma_f32 v[44:45], v[32:33], v[32:33], v[46:47] op_sel:[1,1,0] op_sel_hi:[0,1,1] neg_lo:[1,0,0]
    v_pk_fma_f32 v[50:51], v[50:51], v[32:33], v[52:53] op_sel:[1,1,0] op_sel_hi:[0,1,1] neg_lo:[1,0,0]
    v_pk_fma_f32 v[56:57], v[56:57], v[30:31], v[58:59] op_sel:[1,1,0] op_sel_hi:[0,1,1] neg_lo:[1,0,0]
    v_pk_fma_f32 v[62:63], v[62:63], v[42:43], v[64:65] op_sel:[1,1,0] op_sel_hi:[0,1,1] neg_lo:[1,0,0]
    v_cvt_pk_bf16_f32 v162, v44, v45
    v_cvt_pk_bf16_f32 v178, v50, v51
    v_cvt_pk_bf16_f32 v130, v56, -v57
    v_cvt_pk_bf16_f32 v146, v62, -v63
    ds_write_addtid_b32 v144 offset:4352
    ds_write_addtid_b32 v162 offset:8432
    ds_write_addtid_b32 v178 offset:12784
    ds_write_addtid_b32 v130 offset:544
    ds_write_addtid_b32 v146 offset:4896
    v_pk_mul_f32 v[46:47], v[44:45], v[32:33] op_sel:[0,0] op_sel_hi:[1,0]
    v_pk_mul_f32 v[52:53], v[50:51], v[32:33] op_sel:[0,0] op_sel_hi:[1,0]
    v_pk_mul_f32 v[58:59], v[56:57], v[42:43] op_sel:[0,0] op_sel_hi:[1,0]
    v_pk_mul_f32 v[64:65], v[62:63], v[42:43] op_sel:[0,0] op_sel_hi:[1,0]
    v_pk_fma_f32 v[44:45], v[44:45], v[32:33], v[46:47] op_sel:[1,1,0] op_sel_hi:[0,1,1] neg_lo:[1,0,0]
    v_pk_fma_f32 v[50:51], v[50:51], v[32:33], v[52:53] op_sel:[1,1,0] op_sel_hi:[0,1,1] neg_lo:[1,0,0]
    v_pk_fma_f32 v[60:61], v[56:57], v[42:43], v[58:59] op_sel:[1,1,0] op_sel_hi:[0,1,1] neg_lo:[1,0,0]
    v_pk_fma_f32 v[62:63], v[62:63], v[42:43], v[64:65] op_sel:[1,1,0] op_sel_hi:[0,1,1] neg_lo:[1,0,0]
    v_cvt_pk_bf16_f32 v163, v44, v45
    v_cvt_pk_bf16_f32 v179, v50, v51
    v_cvt_pk_bf16_f32 v145, v60, -v61
    v_cvt_pk_bf16_f32 v150, v62, -v63
    v_pk_mul_f32 v[46:47], v[44:45], v[32:33] op_sel:[0,0] op_sel_hi:[1,0]
    v_pk_mul_f32 v[52:53], v[50:51], v[32:33] op_sel:[0,0] op_sel_hi:[1,0]
    v_pk_mul_f32 v[58:59], v[56:57], v[30:31] op_sel:[0,0] op_sel_hi:[1,0]
    v_pk_mul_f32 v[64:65], v[62:63], v[42:43] op_sel:[0,0] op_sel_hi:[1,0]
    v_pk_fma_f32 v[44:45], v[44:45], v[32:33], v[46:47] op_sel:[1,1,0] op_sel_hi:[0,1,1] neg_lo:[1,0,0]
    v_pk_fma_f32 v[50:51], v[50:51], v[32:33], v[52:53] op_sel:[1,1,0] op_sel_hi:[0,1,1] neg_lo:[1,0,0]
    v_pk_fma_f32 v[56:57], v[56:57], v[30:31], v[58:59] op_sel:[1,1,0] op_sel_hi:[0,1,1] neg_lo:[1,0,0]
    v_pk_fma_f32 v[62:63], v[62:63], v[42:43], v[64:65] op_sel:[1,1,0] op_sel_hi:[0,1,1] neg_lo:[1,0,0]
    v_cvt_pk_bf16_f32 v164, v44, v45
    ds_write_addtid_b32 v163 offset:8704
    ds_write_addtid_b32 v179 offset:13056
    ds_write_addtid_b32 v145 offset:4624
    ds_write_addtid_b32 v150 offset:5984
    ds_write_addtid_b32 v164 offset:8976
    buffer_load_dword v20, v20, s[8:11], 0 offen
    v_cvt_pk_bf16_f32 v180, v50, v51
    v_cvt_pk_bf16_f32 v131, v56, -v57
    v_cvt_pk_bf16_f32 v136, v62, -v63
    v_pk_mul_f32 v[46:47], v[44:45], v[32:33] op_sel:[0,0] op_sel_hi:[1,0]
    v_pk_mul_f32 v[52:53], v[50:51], v[32:33] op_sel:[0,0] op_sel_hi:[1,0]
    v_pk_mul_f32 v[58:59], v[56:57], v[30:31] op_sel:[0,0] op_sel_hi:[1,0]
    v_pk_mul_f32 v[64:65], v[62:63], v[42:43] op_sel:[0,0] op_sel_hi:[1,0]
    v_pk_fma_f32 v[44:45], v[44:45], v[32:33], v[46:47] op_sel:[1,1,0] op_sel_hi:[0,1,1] neg_lo:[1,0,0]
    v_pk_fma_f32 v[50:51], v[50:51], v[32:33], v[52:53] op_sel:[1,1,0] op_sel_hi:[0,1,1] neg_lo:[1,0,0]
    v_pk_fma_f32 v[56:57], v[56:57], v[30:31], v[58:59] op_sel:[1,1,0] op_sel_hi:[0,1,1] neg_lo:[1,0,0]
    v_pk_fma_f32 v[62:63], v[62:63], v[42:43], v[64:65] op_sel:[1,1,0] op_sel_hi:[0,1,1] neg_lo:[1,0,0]
    v_cvt_pk_bf16_f32 v165, v44, v45
    v_cvt_pk_bf16_f32 v181, v50, v51
    ds_write_addtid_b32 v180 offset:13328
    ds_write_addtid_b32 v131 offset:816
    ds_write_addtid_b32 v136 offset:2176
    ds_write_addtid_b32 v165 offset:9248
    ds_write_addtid_b32 v181 offset:13600
    v_cvt_pk_bf16_f32 v132, v56, -v57
    v_cvt_pk_bf16_f32 v140, v62, -v63
    v_pk_mul_f32 v[46:47], v[44:45], v[32:33] op_sel:[0,0] op_sel_hi:[1,0]
    v_pk_mul_f32 v[52:53], v[50:51], v[32:33] op_sel:[0,0] op_sel_hi:[1,0]
    v_pk_mul_f32 v[58:59], v[56:57], v[42:43] op_sel:[0,0] op_sel_hi:[1,0]
    v_pk_mul_f32 v[64:65], v[62:63], v[42:43] op_sel:[0,0] op_sel_hi:[1,0]
    v_pk_fma_f32 v[44:45], v[44:45], v[32:33], v[46:47] op_sel:[1,1,0] op_sel_hi:[0,1,1] neg_lo:[1,0,0]
    v_pk_fma_f32 v[50:51], v[50:51], v[32:33], v[52:53] op_sel:[1,1,0] op_sel_hi:[0,1,1] neg_lo:[1,0,0]
    v_pk_fma_f32 v[60:61], v[56:57], v[42:43], v[58:59] op_sel:[1,1,0] op_sel_hi:[0,1,1] neg_lo:[1,0,0]
    v_pk_fma_f32 v[62:63], v[62:63], v[42:43], v[64:65] op_sel:[1,1,0] op_sel_hi:[0,1,1] neg_lo:[1,0,0]
    v_cvt_pk_bf16_f32 v166, v44, v45
    v_cvt_pk_bf16_f32 v182, v50, v51
    v_cvt_pk_bf16_f32 v148, v60, -v61
    ds_write_addtid_b32 v132 offset:1088
    ds_write_addtid_b32 v140 offset:3264
L_pg0:
    s_cbranch_execz L_pg4
    ds_write_addtid_b32 v166 offset:9520
    ds_write_addtid_b32 v182 offset:13872
    ds_write_addtid_b32 v148 offset:5440
    v_cvt_pk_bf16_f32 v137, v62, -v63
    v_pk_mul_f32 v[46:47], v[44:45], v[32:33] op_sel:[0,0] op_sel_hi:[1,0]
    v_pk_mul_f32 v[52:53], v[50:51], v[32:33] op_sel:[0,0] op_sel_hi:[1,0]
    v_pk_mul_f32 v[58:59], v[60:61], v[42:43] op_sel:[0,0] op_sel_hi:[1,0]
    v_pk_mul_f32 v[64:65], v[62:63], v[42:43] op_sel:[0,0] op_sel_hi:[1,0]
    v_pk_fma_f32 v[44:45], v[44:45], v[32:33], v[46:47] op_sel:[1,1,0] op_sel_hi:[0,1,1] neg_lo:[1,0,0]
    v_pk_fma_f32 v[50:51], v[50:51], v[32:33], v[52:53] op_sel:[1,1,0] op_sel_hi:[0,1,1] neg_lo:[1,0,0]
    v_pk_fma_f32 v[60:61], v[60:61], v[42:43], v[58:59] op_sel:[1,1,0] op_sel_hi:[0,1,1] neg_lo:[1,0,0]
    v_pk_fma_f32 v[62:63], v[62:63], v[42:43], v[64:65] op_sel:[1,1,0] op_sel_hi:[0,1,1] neg_lo:[1,0,0]
    v_cvt_pk_bf16_f32 v167, v44, v45
    v_cvt_pk_bf16_f32 v183, v50, v51
    v_cvt_pk_bf16_f32 v147, v60, -v61
    v_cvt_pk_bf16_f32 v141, v62, -v63
    ds_write_addtid_b32 v137 offset:2448
    ds_write_addtid_b32 v167 offset:9792
    ds_write_addtid_b32 v183 offset:14144
    ds_write_addtid_b32 v147 offset:5168
    ds_write_addtid_b32 v141 offset:3536
    v_pk_mul_f32 v[46:47], v[44:45], v[32:33] op_sel:[0,0] op_sel_hi:[1,0]
    v_pk_mul_f32 v[52:53], v[50:51], v[32:33] op_sel:[0,0] op_sel_hi:[1,0]
    v_pk_mul_f32 v[58:59], v[60:61], v[42:43] op_sel:[0,0] op_sel_hi:[1,0]
    v_pk_mul_f32 v[64:65], v[62:63], v[42:43] op_sel:[0,0] op_sel_hi:[1,0]
    v_pk_fma_f32 v[44:45], v[44:45], v[32:33], v[46:47] op_sel:[1,1,0] op_sel_hi:[0,1,1] neg_lo:[1,0,0]
    v_pk_fma_f32 v[50:51], v[50:51], v[32:33], v[52:53] op_sel:[1,1,0] op_sel_hi:[0,1,1] neg_lo:[1,0,0]
    v_pk_fma_f32 v[60:61], v[60:61], v[42:43], v[58:59] op_sel:[1,1,0] op_sel_hi:[0,1,1] neg_lo:[1,0,0]
    v_pk_fma_f32 v[62:63], v[62:63], v[42:43], v[64:65] op_sel:[1,1,0] op_sel_hi:[0,1,1] neg_lo:[1,0,0]
    v_cvt_pk_bf16_f32 v168, v44, v45
    v_cvt_pk_bf16_f32 v184, v50, v51
    v_cvt_pk_bf16_f32 v151, v60, -v61
    v_cvt_pk_bf16_f32 v138, v62, -v63
    v_pk_mul_f32 v[46:47], v[44:45], v[32:33] op_sel:[0,0] op_sel_hi:[1,0]
    v_pk_mul_f32 v[52:53], v[50:51], v[32:33] op_sel:[0,0] op_sel_hi:[1,0]
    v_pk_mul_f32 v[58:59], v[56:57], v[30:31] op_sel:[0,0] op_sel_hi:[1,0]
    v_pk_fma_f32 v[44:45], v[44:45], v[32:33], v[46:47] op_sel:[1,1,0] op_sel_hi:[0,1,1] neg_lo:[1,0,0]
    v_pk_fma_f32 v[50:51], v[50:51], v[32:33], v[52:53] op_sel:[1,1,0] op_sel_hi:[0,1,1] neg_lo:[1,0,0]
    v_pk_fma_f32 v[56:57], v[56:57], v[30:31], v[58:59] op_sel:[1,1,0] op_sel_hi:[0,1,1] neg_lo:[1,0,0]
    v_cvt_pk_bf16_f32 v169, v44, v45
    ds_write_addtid_b32 v168 offset:10064
    ds_write_addtid_b32 v184 offset:14416
    ds_write_addtid_b32 v151 offset:6256
    ds_write_addtid_b32 v138 offset:2720
    ds_write_addtid_b32 v169 offset:10336
    v_cvt_pk_bf16_f32 v185, v50, v51
    v_cvt_pk_bf16_f32 v133, v56, -v57
    v_pk_mul_f32 v[46:47], v[44:45], v[32:33] op_sel:[0,0] op_sel_hi:[1,0]
    v_pk_mul_f32 v[52:53], v[50:51], v[32:33] op_sel:[0,0] op_sel_hi:[1,0]
    v_pk_mul_f32 v[58:59], v[56:57], v[30:31] op_sel:[0,0] op_sel_hi:[1,0]
    v_pk_fma_f32 v[44:45], v[44:45], v[32:33], v[46:47] op_sel:[1,1,0] op_sel_hi:[0,1,1] neg_lo:[1,0,0]
    v_pk_fma_f32 v[50:51], v[50:51], v[32:33], v[52:53] op_sel:[1,1,0] op_sel_hi:[0,1,1] neg_lo:[1,0,0]
    v_pk_fma_f32 v[56:57], v[56:57], v[30:31], v[58:59] op_sel:[1,1,0] op_sel_hi:[0,1,1] neg_lo:[1,0,0]
    v_cvt_pk_bf16_f32 v170, v44, v45
    v_cvt_pk_bf16_f32 v186, v50, v51
    v_cvt_pk_bf16_f32 v134, v56, -v57
    ds_write_addtid_b32 v185 offset:14688
    ds_write_addtid_b32 v133 offset:1360
    ds_write_addtid_b32 v170 offset:10608
    ds_write_addtid_b32 v186 offset:14960
    ds_write_addtid_b32 v134 offset:1632
    v_pk_mul_f32 v[46:47], v[44:45], v[32:33] op_sel:[0,0] op_sel_hi:[1,0]
    v_pk_mul_f32 v[52:53], v[50:51], v[32:33] op_sel:[0,0] op_sel_hi:[1,0]
    v_pk_mul_f32 v[58:59], v[56:57], v[42:43] op_sel:[0,0] op_sel_hi:[1,0]
    v_pk_fma_f32 v[44:45], v[44:45], v[32:33], v[46:47] op_sel:[1,1,0] op_sel_hi:[0,1,1] neg_lo:[1,0,0]
    v_pk_fma_f32 v[50:51], v[50:51], v[32:33], v[52:53] op_sel:[1,1,0] op_sel_hi:[0,1,1] neg_lo:[1,0,0]
    v_pk_fma_f32 v[60:61], v[56:57], v[42:43], v[58:59] op_sel:[1,1,0] op_sel_hi:[0,1,1] neg_lo:[1,0,0]
    v_cvt_pk_bf16_f32 v171, v44, v45
    v_cvt_pk_bf16_f32 v187, v50, v51
    v_cvt_pk_bf16_f32 v149, v60, -v61
    v_pk_mul_f32 v[46:47], v[44:45], v[32:33] op_sel:[0,0] op_sel_hi:[1,0]
    v_pk_mul_f32 v[52:53], v[50:51], v[32:33] op_sel:[0,0] op_sel_hi:[1,0]
    v_pk_mul_f32 v[58:59], v[56:57], v[30:31] op_sel:[0,0] op_sel_hi:[1,0]
    v_pk_fma_f32 v[44:45], v[44:45], v[32:33], v[46:47] op_sel:[1,1,0] op_sel_hi:[0,1,1] neg_lo:[1,0,0]
    v_pk_fma_f32 v[50:51], v[50:51], v[32:33], v[52:53] op_sel:[1,1,0] op_sel_hi:[0,1,1] neg_lo:[1,0,0]
    v_pk_fma_f32 v[56:57], v[56:57], v[30:31], v[58:59] op_sel:[1,1,0] op_sel_hi:[0,1,1] neg_lo:[1,0,0]
    v_cvt_pk_bf16_f32 v172, v44, v45
    v_cvt_pk_bf16_f32 v188, v50, v51
    ds_write_addtid_b32 v171 offset:10880
    ds_write_addtid_b32 v187 offset:15232
    ds_write_addtid_b32 v149 offset:5712
    ds_write_addtid_b32 v172 offset:11152
    ds_write_addtid_b32 v188 offset:15504
    v_cvt_pk_bf16_f32 v135, v56, -v57
    v_pk_mul_f32 v[46:47], v[44:45], v[32:33] op_sel:[0,0] op_sel_hi:[1,0]
    v_pk_mul_f32 v[52:53], v[50:51], v[32:33] op_sel:[0,0] op_sel_hi:[1,0]
    v_pk_fma_f32 v[44:45], v[44:45], v[32:33], v[46:47] op_sel:[1,1,0] op_sel_hi:[0,1,1] neg_lo:[1,0,0]
    v_pk_fma_f32 v[50:51], v[50:51], v[32:33], v[52:53] op_sel:[1,1,0] op_sel_hi:[0,1,1] neg_lo:[1,0,0]
    v_cvt_pk_bf16_f32 v173, v44, v45
    v_cvt_pk_bf16_f32 v189, v50, v51
    v_pk_mul_f32 v[46:47], v[44:45], v[32:33] op_sel:[0,0] op_sel_hi:[1,0]
    v_pk_mul_f32 v[52:53], v[50:51], v[32:33] op_sel:[0,0] op_sel_hi:[1,0]
    v_pk_fma_f32 v[44:45], v[44:45], v[32:33], v[46:47] op_sel:[1,1,0] op_sel_hi:[0,1,1] neg_lo:[1,0,0]
    v_pk_fma_f32 v[50:51], v[50:51], v[32:33], v[52:53] op_sel:[1,1,0] op_sel_hi:[0,1,1] neg_lo:[1,0,0]
    v_cvt_pk_bf16_f32 v174, v44, v45
    v_cvt_pk_bf16_f32 v190, v50, v51
    ds_write_addtid_b32 v135 offset:1904
    ds_write_addtid_b32 v173 offset:11424
    ds_write_addtid_b32 v189 offset:15776
    ds_write_addtid_b32 v174 offset:11696
    ds_write_addtid_b32 v190 offset:16048
    v_pk_mul_f32 v[46:47], v[44:45], v[32:33] op_sel:[0,0] op_sel_hi:[1,0]
    v_pk_mul_f32 v[52:53], v[50:51], v[32:33] op_sel:[0,0] op_sel_hi:[1,0]
    v_pk_fma_f32 v[44:45], v[44:45], v[32:33], v[46:47] op_sel:[1,1,0] op_sel_hi:[0,1,1] neg_lo:[1,0,0]
    v_pk_fma_f32 v[50:51], v[50:51], v[32:33], v[52:53] op_sel:[1,1,0] op_sel_hi:[0,1,1] neg_lo:[1,0,0]
    v_cvt_pk_bf16_f32 v175, v44, v45
    v_cvt_pk_bf16_f32 v191, v50, v51
    ds_write_addtid_b32 v175 offset:11968
    ds_write_addtid_b32 v191 offset:16320
    ds_read_b128 v[128:131], v96 offset:0
    ds_read_b128 v[132:135], v96 offset:7888
    ds_read_b128 v[136:139], v96 offset:32
    ds_read_b128 v[140:143], v96 offset:7920
    ds_read_b128 v[144:147], v96 offset:64
    ds_read_b128 v[148:151], v96 offset:7952
    v_and_b32 v8, 0xffff0000, v80
    v_and_b32 v9, 0xffff0000, v81
    v_and_b32 v10, 0xffff0000, v82
    v_and_b32 v11, 0xffff0000, v83
    v_and_b32 v12, 0xffff0000, v84
    v_and_b32 v13, 0xffff0000, v85
    v_mul_f32 v66, v94, v8
    v_mul_f32 v67, v95, v9
    v_mul_f32 v10, v92, v10
    v_mul_f32 v11, v92, v11
    s_waitcnt lgkmcnt(4)
    v_mfma_f32_32x32x16_bf16 v[112:127], v[128:131], v[132:135], 0
    ds_read_b128 v[152:155], v96 offset:96
    ds_read_b128 v[156:159], v96 offset:7984
    v_mul_f32 v36, v12, v10
    v_mul_f32 v37, v12, v11
    v_mul_f32 v68, 1090519040, v66
    v_mul_f32 v69, 1090519040, v67
    s_waitcnt lgkmcnt(4)
    v_mfma_f32_32x32x16_bf16 v[112:127], v[136:139], v[140:143], v[112:127]
    ds_read_b128 v[160:163], v96 offset:128
    ds_read_b128 v[164:167], v96 offset:8016
    v_mul_f32 v70, 1124073472, v66
    v_mul_f32 v71, 1124073472, v67
    v_fma_f32 v36, -v13, v11, v36
    v_fma_f32 v37, v13, v10, v37
    s_waitcnt lgkmcnt(4)
    v_mfma_f32_32x32x16_bf16 v[112:127], v[144:147], v[148:151], v[112:127]
    ds_read_b128 v[168:171], v96 offset:160
    ds_read_b128 v[172:175], v96 offset:8048
    v_fract_f32 v67, v67
    v_exp_f32 v66, v66
    v_fract_f32 v69, v69
    s_waitcnt lgkmcnt(4)
    v_mfma_f32_32x32x16_bf16 v[112:127], v[152:155], v[156:159], v[112:127]
    s_waitcnt lgkmcnt(2)
    ds_read_b128 v[176:179], v96 offset:192
    ds_read_b128 v[180:183], v96 offset:8080
    v_exp_f32 v68, v68
    v_fract_f32 v71, v71
    v_mfma_f32_32x32x16_bf16 v[112:127], v[160:163], v[164:167], v[112:127]
    s_waitcnt lgkmcnt(2)
    ds_read_b128 v[184:187], v96 offset:224
    ds_read_b128 v[188:191], v96 offset:8112
    v_exp_f32 v70, v70
    v_cos_f32 v30, v67
    v_mfma_f32_32x32x16_bf16 v[112:127], v[168:171], v[172:175], v[112:127]
    s_waitcnt lgkmcnt(2)
    v_sin_f32 v31, v67
    v_cos_f32 v32, v69
    v_sin_f32 v33, v69
    v_mfma_f32_32x32x16_bf16 v[112:127], v[176:179], v[180:183], v[112:127]
    s_waitcnt lgkmcnt(0)
    v_cos_f32 v34, v71
    v_sin_f32 v35, v71
    v_mul_f32 v30, v66, v30
    v_mul_f32 v31, v66, v31
    v_mfma_f32_32x32x16_bf16 v[112:127], v[184:187], v[188:191], v[112:127]
    v_mul_f32 v32, v68, v32
    v_mul_f32 v33, v68, v33
    v_mul_f32 v34, v70, v34
    v_mul_f32 v35, v70, v35
    v_pk_mul_f32 v[64:65], v[34:35], v[34:35] op_sel:[0,0] op_sel_hi:[1,0]
    v_cvt_pk_bf16_f32 v176, v34, v35
    v_cvt_pk_bf16_f32 v128, v36, -v37
    v_pk_fma_f32 v[42:43], v[34:35], v[34:35], v[64:65] op_sel:[1,1,0] op_sel_hi:[0,1,1] neg_lo:[1,0,0]
    v_pk_mul_f32 v[52:53], v[34:35], v[32:33] op_sel:[0,0] op_sel_hi:[1,0]
    v_pk_mul_f32 v[58:59], v[36:37], v[30:31] op_sel:[0,0] op_sel_hi:[1,0]
    v_pk_mul_f32 v[64:65], v[36:37], v[42:43] op_sel:[0,0] op_sel_hi:[1,0]
    v_pk_fma_f32 v[50:51], v[34:35], v[32:33], v[52:53] op_sel:[1,1,0] op_sel_hi:[0,1,1] neg_lo:[1,0,0]
    v_pk_fma_f32 v[56:57], v[36:37], v[30:31], v[58:59] op_sel:[1,1,0] op_sel_hi:[0,1,1] neg_lo:[1,0,0]
    v_pk_fma_f32 v[62:63], v[36:37], v[42:43], v[64:65] op_sel:[1,1,0] op_sel_hi:[0,1,1] neg_lo:[1,0,0]
    v_cvt_pk_bf16_f32 v161, v32, v33
    v_cvt_pk_bf16_f32 v177, v50, v51
    v_cvt_pk_bf16_f32 v129, v56, -v57
    ds_write_addtid_b32 v176 offset:12240
    ds_write_addtid_b32 v128 offset:0
    ds_write_addtid_b32 v161 offset:8160
    ds_write_addtid_b32 v177 offset:12512
    ds_write_addtid_b32 v129 offset:272
    v_cvt_pk_bf16_f32 v144, v62, -v63
    v_pk_mul_f32 v[46:47], v[32:33], v[32:33] op_sel:[0,0] op_sel_hi:[1,0]
    v_pk_mul_f32 v[52:53], v[50:51], v[32:33] op_sel:[0,0] op_sel_hi:[1,0]
    v_pk_mul_f32 v[58:59], v[56:57], v[30:31] op_sel:[0,0] op_sel_hi:[1,0]
    v_pk_mul_f32 v[64:65], v[62:63], v[42:43] op_sel:[0,0] op_sel_hi:[1,0]
    v_pk_fma_f32 v[44:45], v[32:33], v[32:33], v[46:47] op_sel:[1,1,0] op_sel_hi:[0,1,1] neg_lo:[1,0,0]
    v_pk_fma_f32 v[50:51], v[50:51], v[32:33], v[52:53] op_sel:[1,1,0] op_sel_hi:[0,1,1] neg_lo:[1,0,0]
    v_pk_fma_f32 v[56:57], v[56:57], v[30:31], v[58:59] op_sel:[1,1,0] op_sel_hi:[0,1,1] neg_lo:[1,0,0]
    v_pk_fma_f32 v[62:63], v[62:63], v[42:43], v[64:65] op_sel:[1,1,0] op_sel_hi:[0,1,1] neg_lo:[1,0,0]
    v_cvt_pk_bf16_f32 v162, v44, v45
    v_cvt_pk_bf16_f32 v178, v50, v51
    v_cvt_pk_bf16_f32 v130, v56, -v57
    v_cvt_pk_bf16_f32 v146, v62, -v63
    ds_write_addtid_b32 v144 offset:4352
    ds_write_addtid_b32 v162 offset:8432
    ds_write_addtid_b32 v178 offset:12784
    ds_write_addtid_b32 v130 offset:544
    ds_write_addtid_b32 v146 offset:4896
    v_pk_mul_f32 v[46:47], v[44:45], v[32:33] op_sel:[0,0] op_sel_hi:[1,0]
    v_pk_mul_f32 v[52:53], v[50:51], v[32:33] op_sel:[0,0] op_sel_hi:[1,0]
    v_pk_mul_f32 v[58:59], v[56:57], v[42:43] op_sel:[0,0] op_sel_hi:[1,0]
    v_pk_mul_f32 v[64:65], v[62:63], v[42:43] op_sel:[0,0] op_sel_hi:[1,0]
    v_pk_fma_f32 v[44:45], v[44:45], v[32:33], v[46:47] op_sel:[1,1,0] op_sel_hi:[0,1,1] neg_lo:[1,0,0]
    v_pk_fma_f32 v[50:51], v[50:51], v[32:33], v[52:53] op_sel:[1,1,0] op_sel_hi:[0,1,1] neg_lo:[1,0,0]
    v_pk_fma_f32 v[60:61], v[56:57], v[42:43], v[58:59] op_sel:[1,1,0] op_sel_hi:[0,1,1] neg_lo:[1,0,0]
    v_pk_fma_f32 v[62:63], v[62:63], v[42:43], v[64:65] op_sel:[1,1,0] op_sel_hi:[0,1,1] neg_lo:[1,0,0]
    v_cvt_pk_bf16_f32 v163, v44, v45
    v_cvt_pk_bf16_f32 v179, v50, v51
    v_cvt_pk_bf16_f32 v145, v60, -v61
    v_cvt_pk_bf16_f32 v150, v62, -v63
    v_pk_mul_f32 v[46:47], v[44:45], v[32:33] op_sel:[0,0] op_sel_hi:[1,0]
    v_pk_mul_f32 v[52:53], v[50:51], v[32:33] op_sel:[0,0] op_sel_hi:[1,0]
    v_pk_mul_f32 v[58:59], v[56:57], v[30:31] op_sel:[0,0] op_sel_hi:[1,0]
    v_pk_mul_f32 v[64:65], v[62:63], v[42:43] op_sel:[0,0] op_sel_hi:[1,0]
    v_pk_fma_f32 v[44:45], v[44:45], v[32:33], v[46:47] op_sel:[1,1,0] op_sel_hi:[0,1,1] neg_lo:[1,0,0]
    v_pk_fma_f32 v[50:51], v[50:51], v[32:33], v[52:53] op_sel:[1,1,0] op_sel_hi:[0,1,1] neg_lo:[1,0,0]
    v_pk_fma_f32 v[56:57], v[56:57], v[30:31], v[58:59] op_sel:[1,1,0] op_sel_hi:[0,1,1] neg_lo:[1,0,0]
    v_pk_fma_f32 v[62:63], v[62:63], v[42:43], v[64:65] op_sel:[1,1,0] op_sel_hi:[0,1,1] neg_lo:[1,0,0]
    v_cvt_pk_bf16_f32 v164, v44, v45
    ds_write_addtid_b32 v163 offset:8704
    ds_write_addtid_b32 v179 offset:13056
    ds_write_addtid_b32 v145 offset:4624
    ds_write_addtid_b32 v150 offset:5984
    ds_write_addtid_b32 v164 offset:8976
    v_cvt_pk_bf16_f32 v180, v50, v51
    v_cvt_pk_bf16_f32 v131, v56, -v57
    v_cvt_pk_bf16_f32 v136, v62, -v63
    v_pk_mul_f32 v[46:47], v[44:45], v[32:33] op_sel:[0,0] op_sel_hi:[1,0]
    v_pk_mul_f32 v[52:53], v[50:51], v[32:33] op_sel:[0,0] op_sel_hi:[1,0]
    v_pk_mul_f32 v[58:59], v[56:57], v[30:31] op_sel:[0,0] op_sel_hi:[1,0]
    v_pk_mul_f32 v[64:65], v[62:63], v[42:43] op_sel:[0,0] op_sel_hi:[1,0]
    v_pk_fma_f32 v[44:45], v[44:45], v[32:33], v[46:47] op_sel:[1,1,0] op_sel_hi:[0,1,1] neg_lo:[1,0,0]
    v_pk_fma_f32 v[50:51], v[50:51], v[32:33], v[52:53] op_sel:[1,1,0] op_sel_hi:[0,1,1] neg_lo:[1,0,0]
    v_pk_fma_f32 v[56:57], v[56:57], v[30:31], v[58:59] op_sel:[1,1,0] op_sel_hi:[0,1,1] neg_lo:[1,0,0]
    v_pk_fma_f32 v[62:63], v[62:63], v[42:43], v[64:65] op_sel:[1,1,0] op_sel_hi:[0,1,1] neg_lo:[1,0,0]
    v_cvt_pk_bf16_f32 v165, v44, v45
    v_cvt_pk_bf16_f32 v181, v50, v51
    ds_write_addtid_b32 v180 offset:13328
    ds_write_addtid_b32 v131 offset:816
    ds_write_addtid_b32 v136 offset:2176
    ds_write_addtid_b32 v165 offset:9248
    ds_write_addtid_b32 v181 offset:13600
    v_cvt_pk_bf16_f32 v132, v56, -v57
    v_cvt_pk_bf16_f32 v140, v62, -v63
    v_pk_mul_f32 v[46:47], v[44:45], v[32:33] op_sel:[0,0] op_sel_hi:[1,0]
    v_pk_mul_f32 v[52:53], v[50:51], v[32:33] op_sel:[0,0] op_sel_hi:[1,0]
    v_pk_mul_f32 v[58:59], v[56:57], v[42:43] op_sel:[0,0] op_sel_hi:[1,0]
    v_pk_mul_f32 v[64:65], v[62:63], v[42:43] op_sel:[0,0] op_sel_hi:[1,0]
    v_pk_fma_f32 v[44:45], v[44:45], v[32:33], v[46:47] op_sel:[1,1,0] op_sel_hi:[0,1,1] neg_lo:[1,0,0]
    v_pk_fma_f32 v[50:51], v[50:51], v[32:33], v[52:53] op_sel:[1,1,0] op_sel_hi:[0,1,1] neg_lo:[1,0,0]
    v_pk_fma_f32 v[60:61], v[56:57], v[42:43], v[58:59] op_sel:[1,1,0] op_sel_hi:[0,1,1] neg_lo:[1,0,0]
    v_pk_fma_f32 v[62:63], v[62:63], v[42:43], v[64:65] op_sel:[1,1,0] op_sel_hi:[0,1,1] neg_lo:[1,0,0]
    v_cvt_pk_bf16_f32 v166, v44, v45
    v_cvt_pk_bf16_f32 v182, v50, v51
    v_cvt_pk_bf16_f32 v148, v60, -v61
    ds_write_addtid_b32 v132 offset:1088
    ds_write_addtid_b32 v140 offset:3264
    ds_write_addtid_b32 v166 offset:9520
    ds_write_addtid_b32 v182 offset:13872
    ds_write_addtid_b32 v148 offset:5440
    v_cvt_pk_bf16_f32 v137, v62, -v63
    v_pk_mul_f32 v[46:47], v[44:45], v[32:33] op_sel:[0,0] op_sel_hi:[1,0]
    v_pk_mul_f32 v[52:53], v[50:51], v[32:33] op_sel:[0,0] op_sel_hi:[1,0]
    v_pk_mul_f32 v[58:59], v[60:61], v[42:43] op_sel:[0,0] op_sel_hi:[1,0]
    v_pk_mul_f32 v[64:65], v[62:63], v[42:43] op_sel:[0,0] op_sel_hi:[1,0]
    v_pk_fma_f32 v[44:45], v[44:45], v[32:33], v[46:47] op_sel:[1,1,0] op_sel_hi:[0,1,1] neg_lo:[1,0,0]
    v_pk_fma_f32 v[50:51], v[50:51], v[32:33], v[52:53] op_sel:[1,1,0] op_sel_hi:[0,1,1] neg_lo:[1,0,0]
    v_pk_fma_f32 v[60:61], v[60:61], v[42:43], v[58:59] op_sel:[1,1,0] op_sel_hi:[0,1,1] neg_lo:[1,0,0]
    v_pk_fma_f32 v[62:63], v[62:63], v[42:43], v[64:65] op_sel:[1,1,0] op_sel_hi:[0,1,1] neg_lo:[1,0,0]
    v_cvt_pk_bf16_f32 v167, v44, v45
    v_cvt_pk_bf16_f32 v183, v50, v51
    v_cvt_pk_bf16_f32 v147, v60, -v61
    v_cvt_pk_bf16_f32 v141, v62, -v63
    ds_write_addtid_b32 v137 offset:2448
    ds_write_addtid_b32 v167 offset:9792
    ds_write_addtid_b32 v183 offset:14144
    ds_write_addtid_b32 v147 offset:5168
    ds_write_addtid_b32 v141 offset:3536
    v_pk_mul_f32 v[46:47], v[44:45], v[32:33] op_sel:[0,0] op_sel_hi:[1,0]
    v_pk_mul_f32 v[52:53], v[50:51], v[32:33] op_sel:[0,0] op_sel_hi:[1,0]
    v_pk_mul_f32 v[58:59], v[60:61], v[42:43] op_sel:[0,0] op_sel_hi:[1,0]
    v_pk_mul_f32 v[64:65], v[62:63], v[42:43] op_sel:[0,0] op_sel_hi:[1,0]
    v_pk_fma_f32 v[44:45], v[44:45], v[32:33], v[46:47] op_sel:[1,1,0] op_sel_hi:[0,1,1] neg_lo:[1,0,0]
    v_pk_fma_f32 v[50:51], v[50:51], v[32:33], v[52:53] op_sel:[1,1,0] op_sel_hi:[0,1,1] neg_lo:[1,0,0]
    v_pk_fma_f32 v[60:61], v[60:61], v[42:43], v[58:59] op_sel:[1,1,0] op_sel_hi:[0,1,1] neg_lo:[1,0,0]
    v_pk_fma_f32 v[62:63], v[62:63], v[42:43], v[64:65] op_sel:[1,1,0] op_sel_hi:[0,1,1] neg_lo:[1,0,0]
    v_cvt_pk_bf16_f32 v168, v44, v45
    v_cvt_pk_bf16_f32 v184, v50, v51
    v_cvt_pk_bf16_f32 v151, v60, -v61
    v_cvt_pk_bf16_f32 v138, v62, -v63
    v_pk_mul_f32 v[46:47], v[44:45], v[32:33] op_sel:[0,0] op_sel_hi:[1,0]
    v_pk_mul_f32 v[52:53], v[50:51], v[32:33] op_sel:[0,0] op_sel_hi:[1,0]
    v_pk_mul_f32 v[58:59], v[56:57], v[30:31] op_sel:[0,0] op_sel_hi:[1,0]
    v_pk_fma_f32 v[44:45], v[44:45], v[32:33], v[46:47] op_sel:[1,1,0] op_sel_hi:[0,1,1] neg_lo:[1,0,0]
    v_pk_fma_f32 v[50:51], v[50:51], v[32:33], v[52:53] op_sel:[1,1,0] op_sel_hi:[0,1,1] neg_lo:[1,0,0]
    v_pk_fma_f32 v[56:57], v[56:57], v[30:31], v[58:59] op_sel:[1,1,0] op_sel_hi:[0,1,1] neg_lo:[1,0,0]
    v_cvt_pk_bf16_f32 v169, v44, v45
    ds_write_addtid_b32 v168 offset:10064
    ds_write_addtid_b32 v184 offset:14416
    ds_write_addtid_b32 v151 offset:6256
    ds_write_addtid_b32 v138 offset:2720
    ds_write_addtid_b32 v169 offset:10336
    v_cvt_pk_bf16_f32 v185, v50, v51
    v_cvt_pk_bf16_f32 v133, v56, -v57
    v_pk_mul_f32 v[46:47], v[44:45], v[32:33] op_sel:[0,0] op_sel_hi:[1,0]
    v_pk_mul_f32 v[52:53], v[50:51], v[32:33] op_sel:[0,0] op_sel_hi:[1,0]
    v_pk_mul_f32 v[58:59], v[56:57], v[30:31] op_sel:[0,0] op_sel_hi:[1,0]
    v_pk_fma_f32 v[44:45], v[44:45], v[32:33], v[46:47] op_sel:[1,1,0] op_sel_hi:[0,1,1] neg_lo:[1,0,0]
    v_pk_fma_f32 v[50:51], v[50:51], v[32:33], v[52:53] op_sel:[1,1,0] op_sel_hi:[0,1,1] neg_lo:[1,0,0]
    v_pk_fma_f32 v[56:57], v[56:57], v[30:31], v[58:59] op_sel:[1,1,0] op_sel_hi:[0,1,1] neg_lo:[1,0,0]
    v_cvt_pk_bf16_f32 v170, v44, v45
    v_cvt_pk_bf16_f32 v186, v50, v51
    v_cvt_pk_bf16_f32 v134, v56, -v57
    ds_write_addtid_b32 v185 offset:14688
    ds_write_addtid_b32 v133 offset:1360
    ds_write_addtid_b32 v170 offset:10608
    ds_write_addtid_b32 v186 offset:14960
    ds_write_addtid_b32 v134 offset:1632
    s_waitcnt vmcnt(1)
    v_cmp_gt_u32 vcc, 1, v5
    s_nop 0
    s_and_b64 vcc, vcc, s[58:59]
    s_cbranch_scc1 L_spin_1
L_back_2:
    s_add_u32 s62, s33, 0
    s_barrier
    buffer_atomic_add v4, v2, s[36:39], s62 offen offset:128 sc1
    v_pk_mul_f32 v[46:47], v[44:45], v[32:33] op_sel:[0,0] op_sel_hi:[1,0]
    v_pk_mul_f32 v[52:53], v[50:51], v[32:33] op_sel:[0,0] op_sel_hi:[1,0]
    v_pk_mul_f32 v[58:59], v[56:57], v[42:43] op_sel:[0,0] op_sel_hi:[1,0]
    v_pk_fma_f32 v[44:45], v[44:45], v[32:33], v[46:47] op_sel:[1,1,0] op_sel_hi:[0,1,1] neg_lo:[1,0,0]
    v_pk_fma_f32 v[50:51], v[50:51], v[32:33], v[52:53] op_sel:[1,1,0] op_sel_hi:[0,1,1] neg_lo:[1,0,0]
    v_pk_fma_f32 v[60:61], v[56:57], v[42:43], v[58:59] op_sel:[1,1,0] op_sel_hi:[0,1,1] neg_lo:[1,0,0]
    v_cvt_pk_bf16_f32 v171, v44, v45
    v_cvt_pk_bf16_f32 v187, v50, v51
    v_cvt_pk_bf16_f32 v149, v60, -v61
    v_pk_mul_f32 v[46:47], v[44:45], v[32:33] op_sel:[0,0] op_sel_hi:[1,0]
    v_pk_mul_f32 v[52:53], v[50:51], v[32:33] op_sel:[0,0] op_sel_hi:[1,0]
    v_pk_mul_f32 v[58:59], v[56:57], v[30:31] op_sel:[0,0] op_sel_hi:[1,0]
    v_pk_fma_f32 v[44:45], v[44:45], v[32:33], v[46:47] op_sel:[1,1,0] op_sel_hi:[0,1,1] neg_lo:[1,0,0]
    v_pk_fma_f32 v[50:51], v[50:51], v[32:33], v[52:53] op_sel:[1,1,0] op_sel_hi:[0,1,1] neg_lo:[1,0,0]
    v_pk_fma_f32 v[56:57], v[56:57], v[30:31], v[58:59] op_sel:[1,1,0] op_sel_hi:[0,1,1] neg_lo:[1,0,0]
    v_cvt_pk_bf16_f32 v172, v44, v45
    v_cvt_pk_bf16_f32 v188, v50, v51
    ds_write_addtid_b32 v171 offset:10880
    ds_write_addtid_b32 v187 offset:15232
    ds_write_addtid_b32 v149 offset:5712
    ds_write_addtid_b32 v172 offset:11152
    ds_write_addtid_b32 v188 offset:15504
    v_cvt_pk_bf16_f32 v135, v56, -v57
    v_pk_mul_f32 v[46:47], v[44:45], v[32:33] op_sel:[0,0] op_sel_hi:[1,0]
    v_pk_mul_f32 v[52:53], v[50:51], v[32:33] op_sel:[0,0] op_sel_hi:[1,0]
    v_pk_fma_f32 v[44:45], v[44:45], v[32:33], v[46:47] op_sel:[1,1,0] op_sel_hi:[0,1,1] neg_lo:[1,0,0]
    v_pk_fma_f32 v[50:51], v[50:51], v[32:33], v[52:53] op_sel:[1,1,0] op_sel_hi:[0,1,1] neg_lo:[1,0,0]
    v_cvt_pk_bf16_f32 v173, v44, v45
    v_cvt_pk_bf16_f32 v189, v50, v51
    v_pk_mul_f32 v[46:47], v[44:45], v[32:33] op_sel:[0,0] op_sel_hi:[1,0]
    v_pk_mul_f32 v[52:53], v[50:51], v[32:33] op_sel:[0,0] op_sel_hi:[1,0]
    v_pk_fma_f32 v[44:45], v[44:45], v[32:33], v[46:47] op_sel:[1,1,0] op_sel_hi:[0,1,1] neg_lo:[1,0,0]
    v_pk_fma_f32 v[50:51], v[50:51], v[32:33], v[52:53] op_sel:[1,1,0] op_sel_hi:[0,1,1] neg_lo:[1,0,0]
    v_cvt_pk_bf16_f32 v174, v44, v45
    v_cvt_pk_bf16_f32 v190, v50, v51
    ds_write_addtid_b32 v135 offset:1904
    ds_write_addtid_b32 v173 offset:11424
    ds_write_addtid_b32 v189 offset:15776
    ds_write_addtid_b32 v174 offset:11696
    ds_write_addtid_b32 v190 offset:16048
    s_add_u32 m0, s13, 137024
    s_mov_b32 s14, 0
    buffer_load_dwordx4 v224, s[8:11], s14 offen offset:0 lds
    buffer_load_dwordx4 v225, s[8:11], s14 offen offset:1024 lds
    buffer_load_dwordx4 v226, s[8:11], s14 offen offset:2048 lds
    v_pk_mul_f32 v[46:47], v[44:45], v[32:33] op_sel:[0,0] op_sel_hi:[1,0]
    v_pk_mul_f32 v[52:53], v[50:51], v[32:33] op_sel:[0,0] op_sel_hi:[1,0]
    v_pk_fma_f32 v[44:45], v[44:45], v[32:33], v[46:47] op_sel:[1,1,0] op_sel_hi:[0,1,1] neg_lo:[1,0,0]
    v_pk_fma_f32 v[50:51], v[50:51], v[32:33], v[52:53] op_sel:[1,1,0] op_sel_hi:[0,1,1] neg_lo:[1,0,0]
    v_cvt_pk_bf16_f32 v175, v44, v45
    v_cvt_pk_bf16_f32 v191, v50, v51
    s_mov_b32 m0, s12
    s_nop 0
    ds_write_addtid_b32 v175 offset:11968
    ds_write_addtid_b32 v191 offset:16320
    ds_read_b128 v[128:131], v96 offset:0
    ds_read_b128 v[132:135], v96 offset:7888
    ds_read_b128 v[136:139], v96 offset:32
    ds_read_b128 v[140:143], v96 offset:7920
    ds_read_b128 v[144:147], v96 offset:64
    ds_read_b128 v[148:151], v96 offset:7952
    v_lshlrev_b32 v8, 16, v86
    v_lshlrev_b32 v9, 16, v87
    v_lshlrev_b32 v10, 16, v88
    v_lshlrev_b32 v11, 16, v89
    v_lshlrev_b32 v12, 16, v90
    v_lshlrev_b32 v13, 16, v91
    v_mul_f32 v66, v94, v8
    v_mul_f32 v67, v95, v9
    v_mul_f32 v10, v92, v10
    v_mul_f32 v11, v92, v11
    s_waitcnt lgkmcnt(4)
    v_mfma_f32_32x32x16_bf16 v[112:127], v[128:131], v[132:135], v[112:127]
    ds_read_b128 v[152:155], v96 offset:96
    ds_read_b128 v[156:159], v96 offset:7984
    v_mul_f32 v36, v12, v10
    v_mul_f32 v37, v12, v11
    v_mul_f32 v68, 1090519040, v66
    v_mul_f32 v69, 1090519040, v67
    s_waitcnt lgkmcnt(4)
    v_mfma_f32_32x32x16_bf16 v[112:127], v[136:139], v[140:143], v[112:127]
    ds_read_b128 v[160:163], v96 offset:128
    ds_read_b128 v[164:167], v96 offset:8016
    v_mul_f32 v70, 1124073472, v66
    v_mul_f32 v71, 1124073472, v67
    v_fma_f32 v36, -v13, v11, v36
    v_fma_f32 v37, v13, v10, v37
    s_waitcnt lgkmcnt(4)
    v_mfma_f32_32x32x16_bf16 v[112:127], v[144:147], v[148:151], v[112:127]
    ds_read_b128 v[168:171], v96 offset:160
    ds_read_b128 v[172:175], v96 offset:8048
    v_fract_f32 v67, v67
    v_exp_f32 v66, v66
    v_fract_f32 v69, v69
    s_waitcnt lgkmcnt(4)
    v_mfma_f32_32x32x16_bf16 v[112:127], v[152:155], v[156:159], v[112:127]
    s_waitcnt lgkmcnt(2)
    ds_read_b128 v[176:179], v96 offset:192
    ds_read_b128 v[180:183], v96 offset:8080
    v_exp_f32 v68, v68
    v_fract_f32 v71, v71
    v_mfma_f32_32x32x16_bf16 v[112:127], v[160:163], v[164:167], v[112:127]
    s_waitcnt lgkmcnt(2)
    ds_read_b128 v[184:187], v96 offset:224
    ds_read_b128 v[188:191], v96 offset:8112
    v_exp_f32 v70, v70
    v_cos_f32 v30, v67
    v_mfma_f32_32x32x16_bf16 v[112:127], v[168:171], v[172:175], v[112:127]
    s_waitcnt lgkmcnt(2)
    v_sin_f32 v31, v67
    v_cos_f32 v32, v69
    v_sin_f32 v33, v69
    v_mfma_f32_32x32x16_bf16 v[112:127], v[176:179], v[180:183], v[112:127]
    s_waitcnt lgkmcnt(0)
    v_cos_f32 v34, v71
    v_sin_f32 v35, v71
    v_mul_f32 v30, v66, v30
    v_mul_f32 v31, v66, v31
    v_mfma_f32_32x32x16_bf16 v[112:127], v[184:187], v[188:191], v[112:127]
    v_mul_f32 v32, v68, v32
    v_mul_f32 v33, v68, v33
    v_mul_f32 v34, v70, v34
    v_mul_f32 v35, v70, v35
    v_pk_mul_f32 v[64:65], v[34:35], v[34:35] op_sel:[0,0] op_sel_hi:[1,0]
    v_cvt_pk_bf16_f32 v176, v34, v35
    v_cvt_pk_bf16_f32 v128, v36, -v37
    v_pk_fma_f32 v[42:43], v[34:35], v[34:35], v[64:65] op_sel:[1,1,0] op_sel_hi:[0,1,1] neg_lo:[1,0,0]
    v_pk_mul_f32 v[52:53], v[34:35], v[32:33] op_sel:[0,0] op_sel_hi:[1,0]
    v_pk_mul_f32 v[58:59], v[36:37], v[30:31] op_sel:[0,0] op_sel_hi:[1,0]
    v_pk_mul_f32 v[64:65], v[36:37], v[42:43] op_sel:[0,0] op_sel_hi:[1,0]
    v_pk_fma_f32 v[50:51], v[34:35], v[32:33], v[52:53] op_sel:[1,1,0] op_sel_hi:[0,1,1] neg_lo:[1,0,0]
    v_pk_fma_f32 v[56:57], v[36:37], v[30:31], v[58:59] op_sel:[1,1,0] op_sel_hi:[0,1,1] neg_lo:[1,0,0]
    v_pk_fma_f32 v[62:63], v[36:37], v[42:43], v[64:65] op_sel:[1,1,0] op_sel_hi:[0,1,1] neg_lo:[1,0,0]
    v_cvt_pk_bf16_f32 v161, v32, v33
    v_cvt_pk_bf16_f32 v177, v50, v51
    v_cvt_pk_bf16_f32 v129, v56, -v57
    ds_write_addtid_b32 v176 offset:12240
    ds_write_addtid_b32 v128 offset:0
    ds_write_addtid_b32 v161 offset:8160
    ds_write_addtid_b32 v177 offset:12512
    ds_write_addtid_b32 v129 offset:272
    s_add_u32 m0, s13, 149328
    s_mov_b32 s14, 98304
    buffer_load_dwordx4 v224, s[8:11], s14 offen offset:0 lds
    buffer_load_dwordx4 v225, s[8:11], s14 offen offset:1024 lds
    buffer_load_dwordx4 v226, s[8:11], s14 offen offset:2048 lds
    v_cvt_pk_bf16_f32 v144, v62, -v63
    v_pk_mul_f32 v[46:47], v[32:33], v[32:33] op_sel:[0,0] op_sel_hi:[1,0]
    v_pk_mul_f32 v[52:53], v[50:51], v[32:33] op_sel:[0,0] op_sel_hi:[1,0]
    v_pk_mul_f32 v[58:59], v[56:57], v[30:31] op_sel:[0,0] op_sel_hi:[1,0]
    v_pk_mul_f32 v[64:65], v[62:63], v[42:43] op_sel:[0,0] op_sel_hi:[1,0]
    v_pk_fma_f32 v[44:45], v[32:33], v[32:33], v[46:47] op_sel:[1,1,0] op_sel_hi:[0,1,1] neg_lo:[1,0,0]
    v_pk_fma_f32 v[50:51], v[50:51], v[32:33], v[52:53] op_sel:[1,1,0] op_sel_hi:[0,1,1] neg_lo:[1,0,0]
    v_pk_fma_f32 v[56:57], v[56:57], v[30:31], v[58:59] op_sel:[1,1,0] op_sel_hi:[0,1,1] neg_lo:[1,0,0]
    v_pk_fma_f32 v[62:63], v[62:63], v[42:43], v[64:65] op_sel:[1,1,0] op_sel_hi:[0,1,1] neg_lo:[1,0,0]
    v_cvt_pk_bf16_f32 v162, v44, v45
    v_cvt_pk_bf16_f32 v178, v50, v51
    v_cvt_pk_bf16_f32 v130, v56, -v57
    v_cvt_pk_bf16_f32 v146, v62, -v63
    s_mov_b32 m0, s12
    s_nop 0
    ds_write_addtid_b32 v144 offset:4352
    ds_write_addtid_b32 v162 offset:8432
    ds_write_addtid_b32 v178 offset:12784
    ds_write_addtid_b32 v130 offset:544
    ds_write_addtid_b32 v146 offset:4896
    v_pk_mul_f32 v[46:47], v[44:45], v[32:33] op_sel:[0,0] op_sel_hi:[1,0]
    v_pk_mul_f32 v[52:53], v[50:51], v[32:33] op_sel:[0,0] op_sel_hi:[1,0]
    v_pk_mul_f32 v[58:59], v[56:57], v[42:43] op_sel:[0,0] op_sel_hi:[1,0]
    v_pk_mul_f32 v[64:65], v[62:63], v[42:43] op_sel:[0,0] op_sel_hi:[1,0]
    v_pk_fma_f32 v[44:45], v[44:45], v[32:33], v[46:47] op_sel:[1,1,0] op_sel_hi:[0,1,1] neg_lo:[1,0,0]
    v_pk_fma_f32 v[50:51], v[50:51], v[32:33], v[52:53] op_sel:[1,1,0] op_sel_hi:[0,1,1] neg_lo:[1,0,0]
    v_pk_fma_f32 v[60:61], v[56:57], v[42:43], v[58:59] op_sel:[1,1,0] op_sel_hi:[0,1,1] neg_lo:[1,0,0]
    v_pk_fma_f32 v[62:63], v[62:63], v[42:43], v[64:65] op_sel:[1,1,0] op_sel_hi:[0,1,1] neg_lo:[1,0,0]
    v_cvt_pk_bf16_f32 v163, v44, v45
    v_cvt_pk_bf16_f32 v179, v50, v51
    v_cvt_pk_bf16_f32 v145, v60, -v61
    v_cvt_pk_bf16_f32 v150, v62, -v63
    v_pk_mul_f32 v[46:47], v[44:45], v[32:33] op_sel:[0,0] op_sel_hi:[1,0]
    v_pk_mul_f32 v[52:53], v[50:51], v[32:33] op_sel:[0,0] op_sel_hi:[1,0]
    v_pk_mul_f32 v[58:59], v[56:57], v[30:31] op_sel:[0,0] op_sel_hi:[1,0]
    v_pk_mul_f32 v[64:65], v[62:63], v[42:43] op_sel:[0,0] op_sel_hi:[1,0]
    v_pk_fma_f32 v[44:45], v[44:45], v[32:33], v[46:47] op_sel:[1,1,0] op_sel_hi:[0,1,1] neg_lo:[1,0,0]
    v_pk_fma_f32 v[50:51], v[50:51], v[32:33], v[52:53] op_sel:[1,1,0] op_sel_hi:[0,1,1] neg_lo:[1,0,0]
    v_pk_fma_f32 v[56:57], v[56:57], v[30:31], v[58:59] op_sel:[1,1,0] op_sel_hi:[0,1,1] neg_lo:[1,0,0]
    v_pk_fma_f32 v[62:63], v[62:63], v[42:43], v[64:65] op_sel:[1,1,0] op_sel_hi:[0,1,1] neg_lo:[1,0,0]
    v_cvt_pk_bf16_f32 v164, v44, v45
    ds_write_addtid_b32 v163 offset:8704
    ds_write_addtid_b32 v179 offset:13056
    ds_write_addtid_b32 v145 offset:4624
    ds_write_addtid_b32 v150 offset:5984
    ds_write_addtid_b32 v164 offset:8976
    s_add_u32 m0, s13, 66560
    s_mov_b32 s14, 196608
    buffer_load_dwordx4 v224, s[8:11], s14 offen offset:0 lds
    buffer_load_dwordx4 v225, s[8:11], s14 offen offset:1024 lds
    buffer_load_dwordx4 v226, s[8:11], s14 offen offset:2048 lds
    v_cvt_pk_bf16_f32 v180, v50, v51
    v_cvt_pk_bf16_f32 v131, v56, -v57
    v_cvt_pk_bf16_f32 v136, v62, -v63
    v_pk_mul_f32 v[46:47], v[44:45], v[32:33] op_sel:[0,0] op_sel_hi:[1,0]
    v_pk_mul_f32 v[52:53], v[50:51], v[32:33] op_sel:[0,0] op_sel_hi:[1,0]
    v_pk_mul_f32 v[58:59], v[56:57], v[30:31] op_sel:[0,0] op_sel_hi:[1,0]
    v_pk_mul_f32 v[64:65], v[62:63], v[42:43] op_sel:[0,0] op_sel_hi:[1,0]
    v_pk_fma_f32 v[44:45], v[44:45], v[32:33], v[46:47] op_sel:[1,1,0] op_sel_hi:[0,1,1] neg_lo:[1,0,0]
    v_pk_fma_f32 v[50:51], v[50:51], v[32:33], v[52:53] op_sel:[1,1,0] op_sel_hi:[0,1,1] neg_lo:[1,0,0]
    v_pk_fma_f32 v[56:57], v[56:57], v[30:31], v[58:59] op_sel:[1,1,0] op_sel_hi:[0,1,1] neg_lo:[1,0,0]
    v_pk_fma_f32 v[62:63], v[62:63], v[42:43], v[64:65] op_sel:[1,1,0] op_sel_hi:[0,1,1] neg_lo:[1,0,0]
    v_cvt_pk_bf16_f32 v165, v44, v45
    v_cvt_pk_bf16_f32 v181, v50, v51
    s_mov_b32 m0, s12
    s_nop 0
L_pg2:
    s_cbranch_execz L_pg6
    ds_write_addtid_b32 v180 offset:13328
    ds_write_addtid_b32 v131 offset:816
    ds_write_addtid_b32 v136 offset:2176
    ds_write_addtid_b32 v165 offset:9248
    ds_write_addtid_b32 v181 offset:13600
    v_cvt_pk_bf16_f32 v132, v56, -v57
    v_cvt_pk_bf16_f32 v140, v62, -v63
    v_pk_mul_f32 v[46:47], v[44:45], v[32:33] op_sel:[0,0] op_sel_hi:[1,0]
    v_pk_mul_f32 v[52:53], v[50:51], v[32:33] op_sel:[0,0] op_sel_hi:[1,0]
    v_pk_mul_f32 v[58:59], v[56:57], v[42:43] op_sel:[0,0] op_sel_hi:[1,0]
    v_pk_mul_f32 v[64:65], v[62:63], v[42:43] op_sel:[0,0] op_sel_hi:[1,0]
    v_pk_fma_f32 v[44:45], v[44:45], v[32:33], v[46:47] op_sel:[1,1,0] op_sel_hi:[0,1,1] neg_lo:[1,0,0]
    v_pk_fma_f32 v[50:51], v[50:51], v[32:33], v[52:53] op_sel:[1,1,0] op_sel_hi:[0,1,1] neg_lo:[1,0,0]
    v_pk_fma_f32 v[60:61], v[56:57], v[42:43], v[58:59] op_sel:[1,1,0] op_sel_hi:[0,1,1] neg_lo:[1,0,0]
    v_pk_fma_f32 v[62:63], v[62:63], v[42:43], v[64:65] op_sel:[1,1,0] op_sel_hi:[0,1,1] neg_lo:[1,0,0]
    v_cvt_pk_bf16_f32 v166, v44, v45
    v_cvt_pk_bf16_f32 v182, v50, v51
    v_cvt_pk_bf16_f32 v148, v60, -v61
    ds_write_addtid_b32 v132 offset:1088
    ds_write_addtid_b32 v140 offset:3264
    ds_write_addtid_b32 v166 offset:9520
    ds_write_addtid_b32 v182 offset:13872
    ds_write_addtid_b32 v148 offset:5440
    v_cvt_pk_bf16_f32 v137, v62, -v63
    v_pk_mul_f32 v[46:47], v[44:45], v[32:33] op_sel:[0,0] op_sel_hi:[1,0]
    v_pk_mul_f32 v[52:53], v[50:51], v[32:33] op_sel:[0,0] op_sel_hi:[1,0]
    v_pk_mul_f32 v[58:59], v[60:61], v[42:43] op_sel:[0,0] op_sel_hi:[1,0]
    v_pk_mul_f32 v[64:65], v[62:63], v[42:43] op_sel:[0,0] op_sel_hi:[1,0]
    v_pk_fma_f32 v[44:45], v[44:45], v[32:33], v[46:47] op_sel:[1,1,0] op_sel_hi:[0,1,1] neg_lo:[1,0,0]
    v_pk_fma_f32 v[50:51], v[50:51], v[32:33], v[52:53] op_sel:[1,1,0] op_sel_hi:[0,1,1] neg_lo:[1,0,0]
    v_pk_fma_f32 v[60:61], v[60:61], v[42:43], v[58:59] op_sel:[1,1,0] op_sel_hi:[0,1,1] neg_lo:[1,0,0]
    v_pk_fma_f32 v[62:63], v[62:63], v[42:43], v[64:65] op_sel:[1,1,0] op_sel_hi:[0,1,1] neg_lo:[1,0,0]
    v_cvt_pk_bf16_f32 v167, v44, v45
    v_cvt_pk_bf16_f32 v183, v50, v51
    v_cvt_pk_bf16_f32 v147, v60, -v61
    v_cvt_pk_bf16_f32 v141, v62, -v63
    ds_write_addtid_b32 v137 offset:2448
    ds_write_addtid_b32 v167 offset:9792
    ds_write_addtid_b32 v183 offset:14144
    ds_write_addtid_b32 v147 offset:5168
    ds_write_addtid_b32 v141 offset:3536
    v_pk_mul_f32 v[46:47], v[44:45], v[32:33] op_sel:[0,0] op_sel_hi:[1,0]
    v_pk_mul_f32 v[52:53], v[50:51], v[32:33] op_sel:[0,0] op_sel_hi:[1,0]
    v_pk_mul_f32 v[58:59], v[60:61], v[42:43] op_sel:[0,0] op_sel_hi:[1,0]
    v_pk_mul_f32 v[64:65], v[62:63], v[42:43] op_sel:[0,0] op_sel_hi:[1,0]
    v_pk_fma_f32 v[44:45], v[44:45], v[32:33], v[46:47] op_sel:[1,1,0] op_sel_hi:[0,1,1] neg_lo:[1,0,0]
    v_pk_fma_f32 v[50:51], v[50:51], v[32:33], v[52:53] op_sel:[1,1,0] op_sel_hi:[0,1,1] neg_lo:[1,0,0]
    v_pk_fma_f32 v[60:61], v[60:61], v[42:43], v[58:59] op_sel:[1,1,0] op_sel_hi:[0,1,1] neg_lo:[1,0,0]
    v_pk_fma_f32 v[62:63], v[62:63], v[42:43], v[64:65] op_sel:[1,1,0] op_sel_hi:[0,1,1] neg_lo:[1,0,0]
    v_cvt_pk_bf16_f32 v168, v44, v45
    v_cvt_pk_bf16_f32 v184, v50, v51
    v_cvt_pk_bf16_f32 v151, v60, -v61
    v_cvt_pk_bf16_f32 v138, v62, -v63
    v_pk_mul_f32 v[46:47], v[44:45], v[32:33] op_sel:[0,0] op_sel_hi:[1,0]
    v_pk_mul_f32 v[52:53], v[50:51], v[32:33] op_sel:[0,0] op_sel_hi:[1,0]
    v_pk_mul_f32 v[58:59], v[56:57], v[30:31] op_sel:[0,0] op_sel_hi:[1,0]
    v_pk_fma_f32 v[44:45], v[44:45], v[32:33], v[46:47] op_sel:[1,1,0] op_sel_hi:[0,1,1] neg_lo:[1,0,0]
    v_pk_fma_f32 v[50:51], v[50:51], v[32:33], v[52:53] op_sel:[1,1,0] op_sel_hi:[0,1,1] neg_lo:[1,0,0]
    v_pk_fma_f32 v[56:57], v[56:57], v[30:31], v[58:59] op_sel:[1,1,0] op_sel_hi:[0,1,1] neg_lo:[1,0,0]
    v_cvt_pk_bf16_f32 v169, v44, v45
    ds_write_addtid_b32 v168 offset:10064
    ds_write_addtid_b32 v184 offset:14416
    ds_write_addtid_b32 v151 offset:6256
    ds_write_addtid_b32 v138 offset:2720
    ds_write_addtid_b32 v169 offset:10336
    s_mov_b32 s32, 0
    buffer_load_dword v5, v3, s[36:39], s32 offen offset:128 sc1
    v_cvt_pk_bf16_f32 v185, v50, v51
    v_cvt_pk_bf16_f32 v133, v56, -v57
    v_pk_mul_f32 v[46:47], v[44:45], v[32:33] op_sel:[0,0] op_sel_hi:[1,0]
    v_pk_mul_f32 v[52:53], v[50:51], v[32:33] op_sel:[0,0] op_sel_hi:[1,0]
    v_pk_mul_f32 v[58:59], v[56:57], v[30:31] op_sel:[0,0] op_sel_hi:[1,0]
    v_pk_fma_f32 v[44:45], v[44:45], v[32:33], v[46:47] op_sel:[1,1,0] op_sel_hi:[0,1,1] neg_lo:[1,0,0]
    v_pk_fma_f32 v[50:51], v[50:51], v[32:33], v[52:53] op_sel:[1,1,0] op_sel_hi:[0,1,1] neg_lo:[1,0,0]
    v_pk_fma_f32 v[56:57], v[56:57], v[30:31], v[58:59] op_sel:[1,1,0] op_sel_hi:[0,1,1] neg_lo:[1,0,0]
    v_cvt_pk_bf16_f32 v170, v44, v45
    v_cvt_pk_bf16_f32 v186, v50, v51
    v_cvt_pk_bf16_f32 v134, v56, -v57
    ds_write_addtid_b32 v185 offset:14688
    ds_write_addtid_b32 v133 offset:1360
    ds_write_addtid_b32 v170 offset:10608
    ds_write_addtid_b32 v186 offset:14960
    ds_write_addtid_b32 v134 offset:1632
    v_pk_mul_f32 v[46:47], v[44:45], v[32:33] op_sel:[0,0] op_sel_hi:[1,0]
    v_pk_mul_f32 v[52:53], v[50:51], v[32:33] op_sel:[0,0] op_sel_hi:[1,0]
    v_pk_mul_f32 v[58:59], v[56:57], v[42:43] op_sel:[0,0] op_sel_hi:[1,0]
    v_pk_fma_f32 v[44:45], v[44:45], v[32:33], v[46:47] op_sel:[1,1,0] op_sel_hi:[0,1,1] neg_lo:[1,0,0]
    v_pk_fma_f32 v[50:51], v[50:51], v[32:33], v[52:53] op_sel:[1,1,0] op_sel_hi:[0,1,1] neg_lo:[1,0,0]
    v_pk_fma_f32 v[60:61], v[56:57], v[42:43], v[58:59] op_sel:[1,1,0] op_sel_hi:[0,1,1] neg_lo:[1,0,0]
    v_cvt_pk_bf16_f32 v171, v44, v45
    v_cvt_pk_bf16_f32 v187, v50, v51
    v_cvt_pk_bf16_f32 v149, v60, -v61
    v_pk_mul_f32 v[46:47], v[44:45], v[32:33] op_sel:[0,0] op_sel_hi:[1,0]
    v_pk_mul_f32 v[52:53], v[50:51], v[32:33] op_sel:[0,0] op_sel_hi:[1,0]
    v_pk_mul_f32 v[58:59], v[56:57], v[30:31] op_sel:[0,0] op_sel_hi:[1,0]
    v_pk_fma_f32 v[44:45], v[44:45], v[32:33], v[46:47] op_sel:[1,1,0] op_sel_hi:[0,1,1] neg_lo:[1,0,0]
    v_pk_fma_f32 v[50:51], v[50:51], v[32:33], v[52:53] op_sel:[1,1,0] op_sel_hi:[0,1,1] neg_lo:[1,0,0]
    v_pk_fma_f32 v[56:57], v[56:57], v[30:31], v[58:59] op_sel:[1,1,0] op_sel_hi:[0,1,1] neg_lo:[1,0,0]
    v_cvt_pk_bf16_f32 v172, v44, v45
    v_cvt_pk_bf16_f32 v188, v50, v51
    ds_write_addtid_b32 v171 offset:10880
    ds_write_addtid_b32 v187 offset:15232
    ds_write_addtid_b32 v149 offset:5712
    ds_write_addtid_b32 v172 offset:11152
    ds_write_addtid_b32 v188 offset:15504
    v_cvt_pk_bf16_f32 v135, v56, -v57
    v_pk_mul_f32 v[46:47], v[44:45], v[32:33] op_sel:[0,0] op_sel_hi:[1,0]
    v_pk_mul_f32 v[52:53], v[50:51], v[32:33] op_sel:[0,0] op_sel_hi:[1,0]
    v_pk_fma_f32 v[44:45], v[44:45], v[32:33], v[46:47] op_sel:[1,1,0] op_sel_hi:[0,1,1] neg_lo:[1,0,0]
    v_pk_fma_f32 v[50:51], v[50:51], v[32:33], v[52:53] op_sel:[1,1,0] op_sel_hi:[0,1,1] neg_lo:[1,0,0]
    v_cvt_pk_bf16_f32 v173, v44, v45
    v_cvt_pk_bf16_f32 v189, v50, v51
    v_pk_mul_f32 v[46:47], v[44:45], v[32:33] op_sel:[0,0] op_sel_hi:[1,0]
    v_pk_mul_f32 v[52:53], v[50:51], v[32:33] op_sel:[0,0] op_sel_hi:[1,0]
    v_pk_fma_f32 v[44:45], v[44:45], v[32:33], v[46:47] op_sel:[1,1,0] op_sel_hi:[0,1,1] neg_lo:[1,0,0]
    v_pk_fma_f32 v[50:51], v[50:51], v[32:33], v[52:53] op_sel:[1,1,0] op_sel_hi:[0,1,1] neg_lo:[1,0,0]
    v_cvt_pk_bf16_f32 v174, v44, v45
    v_cvt_pk_bf16_f32 v190, v50, v51
    ds_write_addtid_b32 v135 offset:1904
    ds_write_addtid_b32 v173 offset:11424
    ds_write_addtid_b32 v189 offset:15776
    ds_write_addtid_b32 v174 offset:11696
    ds_write_addtid_b32 v190 offset:16048
    v_pk_mul_f32 v[46:47], v[44:45], v[32:33] op_sel:[0,0] op_sel_hi:[1,0]
    v_pk_mul_f32 v[52:53], v[50:51], v[32:33] op_sel:[0,0] op_sel_hi:[1,0]
    v_pk_fma_f32 v[44:45], v[44:45], v[32:33], v[46:47] op_sel:[1,1,0] op_sel_hi:[0,1,1] neg_lo:[1,0,0]
    v_pk_fma_f32 v[50:51], v[50:51], v[32:33], v[52:53] op_sel:[1,1,0] op_sel_hi:[0,1,1] neg_lo:[1,0,0]
    v_cvt_pk_bf16_f32 v175, v44, v45
    v_cvt_pk_bf16_f32 v191, v50, v51
    ds_write_addtid_b32 v175 offset:11968
    ds_write_addtid_b32 v191 offset:16320
    ds_read_b128 v[128:131], v96 offset:0
    ds_read_b128 v[132:135], v96 offset:7888
    ds_read_b128 v[136:139], v96 offset:32
    ds_read_b128 v[140:143], v96 offset:7920
    ds_read_b128 v[144:147], v96 offset:64
    ds_read_b128 v[148:151], v96 offset:7952
    s_waitcnt vmcnt(0)
    v_cmp_gt_u32 vcc, 16, v5
    s_nop 0
    s_and_b64 vcc, vcc, s[58:59]
    s_cbranch_scc1 L_spin_3
L_back_4:
    s_barrier
    s_mul_i32 s57, s2, 32896
    s_lshl_b32 s50, s44, 10
    s_add_u32 s57, s57, s50
    s_add_u32 s57, s57, 1048576
    s_add_u32 m0, s50, 85760
    s_nop 0
    buffer_load_dwordx4 v6, s[36:39], s57 offen sc1 lds
    s_add_u32 m0, m0, 4096
    s_add_u32 s57, s57, 4096
    buffer_load_dwordx4 v6, s[36:39], s57 offen sc1 lds
    s_add_u32 m0, m0, 4096
    s_add_u32 s57, s57, 4096
    buffer_load_dwordx4 v6, s[36:39], s57 offen sc1 lds
    s_add_u32 m0, m0, 4096
    s_add_u32 s57, s57, 4096
    buffer_load_dwordx4 v6, s[36:39], s57 offen sc1 lds
    s_waitcnt lgkmcnt(4)
    v_mfma_f32_32x32x16_bf16 v[112:127], v[128:131], v[132:135], v[112:127]
    s_mov_b32 vcc_lo, -1
    ds_read_b128 v[152:155], v96 offset:96
    ds_read_b128 v[156:159], v96 offset:7984
    s_mov_b32 vcc_hi, 0
    v_mov_b32 v13, 0x3f80
    v_cndmask_b32 v13, v93, v13, vcc
    s_waitcnt lgkmcnt(4)
    v_mfma_f32_32x32x16_bf16 v[112:127], v[136:139], v[140:143], v[112:127]
    s_mov_b64 vcc, 31
    ds_read_b128 v[160:163], v96 offset:128
    ds_read_b128 v[164:167], v96 offset:8016
    v_cndmask_b32_e64 v79, 0, -1, vcc
    s_mov_b32 s51, 0xffff0000
    v_writelane_b32 v79, s51, 5
    s_waitcnt lgkmcnt(4)
    v_mfma_f32_32x32x16_bf16 v[112:127], v[144:147], v[148:151], v[112:127]
    s_mov_b64 vcc, -2
    ds_read_b128 v[168:171], v96 offset:160
    ds_read_b128 v[172:175], v96 offset:8048
    v_mov_b32 v16, 0
    v_mul_u32_u24 v8, v208, v13
    v_mul_u32_u24 v9, v209, v13
    v_mul_u32_u24 v10, v210, v13
    s_waitcnt lgkmcnt(4)
    v_mfma_f32_32x32x16_bf16 v[112:127], v[152:155], v[156:159], v[112:127]
    ds_read_b128 v[176:179], v96 offset:192
    ds_read_b128 v[180:183], v96 offset:8080
    v_mul_u32_u24 v11, v211, v13
    v_add_u32 v227, 1024, v244
    v_add_u32 v228, 2048, v244
    v_add_u32 v229, 3072, v244
    s_waitcnt lgkmcnt(4)
    v_mfma_f32_32x32x16_bf16 v[112:127], v[160:163], v[164:167], v[112:127]
    s_waitcnt lgkmcnt(2)
    ds_read_b128 v[184:187], v96 offset:224
    ds_read_b128 v[188:191], v96 offset:8112
    v_add_u32 v230, 4096, v244
    v_mfma_f32_32x32x16_bf16 v[112:127], v[168:171], v[172:175], v[112:127]
    s_waitcnt lgkmcnt(2)
    v_mfma_f32_32x32x16_bf16 v[112:127], v[176:179], v[180:183], v[112:127]
    s_waitcnt lgkmcnt(0)
    v_mfma_f32_32x32x16_bf16 v[112:127], v[184:187], v[188:191], v[112:127]
    ds_write_b32 v202, v16
    s_nop 10
    v_mov_b32 v24, v115
    v_mov_b32 v25, v115
    v_mov_b32 v26, v120
    v_mov_b32 v27, v120
    v_readfirstlane_b32 s52, v116
    v_permlane32_swap_b32 v24, v25
    v_permlane32_swap_b32 v26, v27
    v_mov_b32_dpp v28, v116 wave_rol:1 row_mask:0xf bank_mask:0xf
    v_cndmask_b32_dpp v29, v115, v120, vcc wave_ror:1 row_mask:0xf bank_mask:0xf
    v_mov_b32_dpp v24, v25 wave_shr:1 row_mask:0x3 bank_mask:0xf bound_ctrl:0
    v_mov_b32_dpp v27, v122 wave_rol:1 row_mask:0x8 bank_mask:0xf
    v_mov_b32_dpp v28, v122 wave_shl:1 row_mask:0xf bank_mask:0xf
    v_cvt_pk_bf16_f32 v41, v113, v112
    v_mov_b32_dpp v27, v26 wave_shl:1 row_mask:0xc bank_mask:0xf
    v_cvt_pk_bf16_f32 v42, v114, v113
    v_cvt_pk_bf16_f32 v43, v115, v114
    v_cvt_pk_bf16_f32 v40, v112, v24
    v_cvt_pk_bf16_f32 v44, v120, v29
    v_cvt_pk_bf16_f32 v45, v120, v120
    v_cvt_pk_bf16_f32 v46, v121, v120
    v_cvt_pk_bf16_f32 v47, v27, v121
    ds_write_b128 v200, v[40:43] offset:64
    ds_write_b128 v200, v[44:47] offset:1088
    v_cvt_pk_bf16_f32 v48, v122, v122
    v_cvt_pk_bf16_f32 v49, v122, v122
    v_cvt_pk_bf16_f32 v50, v122, v122
    v_cvt_pk_bf16_f32 v51, v123, v122
    v_cvt_pk_bf16_f32 v52, v123, v123
    v_cvt_pk_bf16_f32 v53, v123, v123
    v_cvt_pk_bf16_f32 v54, v28, v123
    v_cvt_pk_bf16_f32 v55, v28, v28
    ds_write_b128 v201, v[48:51] offset:2112
    ds_write_b128 v201, v[52:55] offset:2128
    ds_read2_b32 v[96:97], v244 offset0:6 offset1:4
    ds_read2_b32 v[98:99], v244 offset0:2 offset1:0
    ds_read2_b32 v[128:129], v227 offset0:6 offset1:4
    ds_read2_b32 v[130:131], v227 offset0:2 offset1:0
    ds_read2_b32 v[160:161], v228 offset0:6 offset1:4
    ds_read2_b32 v[162:163], v228 offset0:2 offset1:0
    ds_read2_b32 v[192:193], v229 offset0:6 offset1:4
    ds_read2_b32 v[194:195], v229 offset0:2 offset1:0
    v_mov_b32_dpp v76, v117 wave_rol:1 row_mask:0xf bank_mask:0xf
    v_mov_b32_dpp v77, v118 wave_rol:1 row_mask:0xf bank_mask:0xf
    v_cvt_pk_bf16_f32 v78, s52, s52
    v_mov_b32_dpp v76, v116 wave_shl:1 row_mask:0xf bank_mask:0xf
    v_mov_b32_dpp v77, v117 wave_shl:1 row_mask:0xf bank_mask:0xf
    v_and_b32 v78, v78, v79
    v_cvt_pk_bf16_f32 v76, v116, v76
    v_cvt_pk_bf16_f32 v77, v117, v77
    ds_write_b32 v202, v78 offset:4160
    s_mov_b32 exec_lo, 0xaaaaaaaa
    s_mov_b32 exec_hi, 0xaaaaaaaa
    ds_write2_b32 v203, v76, v77 offset0:0 offset1:32
    s_mov_b64 exec, -1
    s_add_u32 m0, m0, 4096
    s_add_u32 s57, s57, 4096
    buffer_load_dwordx4 v6, s[36:39], s57 offen sc1 lds
    s_add_u32 m0, m0, 4096
    s_add_u32 s57, s57, 4096
    buffer_load_dwordx4 v6, s[36:39], s57 offen sc1 lds
    s_add_u32 m0, m0, 4096
    s_add_u32 s57, s57, 4096
    buffer_load_dwordx4 v6, s[36:39], s57 offen sc1 lds
    s_add_u32 m0, m0, 4096
    s_add_u32 s57, s57, 4096
    buffer_load_dwordx4 v6, s[36:39], s57 offen sc1 lds
    s_waitcnt vmcnt(4) lgkmcnt(0)
    s_barrier
    ds_read_b128 v[44:47], v251 offset:0
    ds_read_b128 v[48:51], v251 offset:4096
    ds_read_b128 v[52:55], v251 offset:8192
    ds_read_b128 v[56:59], v251 offset:12288
    ds_read_b128 v[60:63], v246 offset:16384
    ds_read_b128 v[64:67], v246 offset:12288
    s_waitcnt lgkmcnt(5)
    v_mfma_f32_16x16x32_bf16 v[12:15], v[8:11], v[44:47], 0
    s_waitcnt lgkmcnt(4)
    ds_read_b128 v[44:47], v246 offset:8192
    ds_read2_b32 v[100:101], v244 offset0:38 offset1:36
    v_mfma_f32_16x16x32_bf16 v[16:19], v[8:11], v[48:51], 0
    s_waitcnt lgkmcnt(5)
    ds_read_b128 v[48:51], v246 offset:4096
    ds_read2_b32 v[102:103], v244 offset0:34 offset1:32
    s_add_u32 m0, s13, 54256
    v_mfma_f32_16x16x32_bf16 v[20:23], v[8:11], v[52:55], 0
    s_waitcnt lgkmcnt(6)
    ds_read_b128 v[52:55], v249 offset:14336
    ds_read2_b32 v[132:133], v227 offset0:38 offset1:36
    s_mov_b32 s14, 294912
    v_mfma_f32_16x16x32_bf16 v[24:27], v[8:11], v[56:59], 0
    s_waitcnt lgkmcnt(7)
    ds_read_b128 v[56:59], v249 offset:10240
    ds_read2_b32 v[134:135], v227 offset0:34 offset1:32
    v_mfma_f32_16x16x32_bf16 v[24:27], v[96:99], v[60:63], v[24:27]
    s_waitcnt lgkmcnt(8)
    ds_read_b128 v[60:63], v249 offset:6144
    ds_read2_b32 v[164:165], v228 offset0:38 offset1:36
    v_mfma_f32_16x16x32_bf16 v[20:23], v[96:99], v[64:67], v[20:23]
    ds_read2_b32 v[166:167], v228 offset0:34 offset1:32
    ds_read2_b32 v[196:197], v229 offset0:38 offset1:36
    v_mfma_f32_16x16x32_bf16 v[24:27], v[128:131], v[64:67], v[24:27]
    s_waitcnt lgkmcnt(11)
    ds_read_b128 v[64:67], v249 offset:2048
    ds_read2_b32 v[198:199], v229 offset0:34 offset1:32
    v_mfma_f32_16x16x32_bf16 v[20:23], v[128:131], v[44:47], v[20:23]
    buffer_load_dwordx4 v224, s[8:11], s14 offen offset:0 lds
    v_mfma_f32_16x16x32_bf16 v[16:19], v[96:99], v[44:47], v[16:19]
    buffer_load_dwordx4 v225, s[8:11], s14 offen offset:1024 lds
    v_mfma_f32_16x16x32_bf16 v[24:27], v[160:163], v[44:47], v[24:27]
    s_waitcnt lgkmcnt(11)
    ds_read_b128 v[44:47], v248 offset:14336
    v_mfma_f32_16x16x32_bf16 v[20:23], v[160:163], v[48:51], v[20:23]
    ds_read2_b32 v[104:105], v244 offset0:70 offset1:68
    ds_read2_b32 v[106:107], v244 offset0:66 offset1:64
    v_mfma_f32_16x16x32_bf16 v[12:15], v[96:99], v[48:51], v[12:15]
    ds_read2_b32 v[136:137], v227 offset0:70 offset1:68
    ds_read2_b32 v[138:139], v227 offset0:66 offset1:64
    v_mfma_f32_16x16x32_bf16 v[16:19], v[128:131], v[48:51], v[16:19]
    ds_read2_b32 v[168:169], v228 offset0:70 offset1:68
    ds_read2_b32 v[170:171], v228 offset0:66 offset1:64
    v_mfma_f32_16x16x32_bf16 v[24:27], v[192:195], v[48:51], v[24:27]
    s_waitcnt lgkmcnt(13)
    ds_read_b128 v[48:51], v248 offset:10240
    ds_read2_b32 v[200:201], v229 offset0:70 offset1:68
    v_mfma_f32_16x16x32_bf16 v[24:27], v[100:103], v[52:55], v[24:27]
    ds_read_b128 v[52:55], v248 offset:6144
    ds_read2_b32 v[202:203], v229 offset0:66 offset1:64
    v_mfma_f32_16x16x32_bf16 v[20:23], v[100:103], v[56:59], v[20:23]
    buffer_load_dwordx4 v226, s[8:11], s14 offen offset:2048 lds
    v_mfma_f32_16x16x32_bf16 v[24:27], v[132:135], v[56:59], v[24:27]
    s_waitcnt lgkmcnt(14)
    ds_read_b128 v[56:59], v248 offset:2048
    global_load_dwordx4 v[92:95], v6, s[60:61] offset:-4096
    v_mfma_f32_16x16x32_bf16 v[20:23], v[132:135], v[60:63], v[20:23]
    s_add_u32 m0, s13, 41952
    s_mov_b32 s14, 393216
    v_mfma_f32_16x16x32_bf16 v[16:19], v[100:103], v[60:63], v[16:19]
    v_mfma_f32_16x16x32_bf16 v[24:27], v[164:167], v[60:63], v[24:27]
    s_waitcnt lgkmcnt(13)
    ds_read_b128 v[60:63], v247 offset:14336
    buffer_load_dwordx4 v224, s[8:11], s14 offen offset:0 lds
    v_mfma_f32_16x16x32_bf16 v[20:23], v[164:167], v[64:67], v[20:23]
    ds_read2_b32 v[108:109], v244 offset0:102 offset1:100
    ds_read2_b32 v[110:111], v244 offset0:98 offset1:96
    v_mfma_f32_16x16x32_bf16 v[12:15], v[100:103], v[64:67], v[12:15]
    ds_read2_b32 v[140:141], v227 offset0:102 offset1:100
    ds_read2_b32 v[142:143], v227 offset0:98 offset1:96
    v_mfma_f32_16x16x32_bf16 v[16:19], v[132:135], v[64:67], v[16:19]
    s_waitcnt lgkmcnt(13)
    ds_read2_b32 v[172:173], v228 offset0:102 offset1:100
    ds_read2_b32 v[174:175], v228 offset0:98 offset1:96
    v_mfma_f32_16x16x32_bf16 v[24:27], v[196:199], v[64:67], v[24:27]
    ds_read_b128 v[64:67], v247 offset:10240
    ds_read2_b32 v[204:205], v229 offset0:102 offset1:100
    v_mfma_f32_16x16x32_bf16 v[24:27], v[104:107], v[44:47], v[24:27]
    s_waitcnt lgkmcnt(13)
    ds_read_b128 v[44:47], v247 offset:6144
    ds_read2_b32 v[206:207], v229 offset0:98 offset1:96
    v_mfma_f32_16x16x32_bf16 v[20:23], v[104:107], v[48:51], v[20:23]
    buffer_load_dwordx4 v225, s[8:11], s14 offen offset:1024 lds
    v_mfma_f32_16x16x32_bf16 v[24:27], v[136:139], v[48:51], v[24:27]
    s_waitcnt lgkmcnt(13)
    ds_read_b128 v[48:51], v247 offset:2048
    v_mfma_f32_16x16x32_bf16 v[20:23], v[136:139], v[52:55], v[20:23]
    v_mfma_f32_16x16x32_bf16 v[16:19], v[104:107], v[52:55], v[16:19]
    buffer_load_dwordx4 v226, s[8:11], s14 offen offset:2048 lds
    s_add_u32 m0, s13, 29648
    v_mfma_f32_16x16x32_bf16 v[24:27], v[168:171], v[52:55], v[24:27]
    s_waitcnt lgkmcnt(12)
    ds_read_b128 v[52:55], v246 offset:14336
    s_mov_b32 s14, 491520
    v_mfma_f32_16x16x32_bf16 v[20:23], v[168:171], v[56:59], v[20:23]
    ds_read2_b32 v[112:113], v244 offset0:134 offset1:132
    ds_read2_b32 v[114:115], v244 offset0:130 offset1:128
    v_mfma_f32_16x16x32_bf16 v[12:15], v[104:107], v[56:59], v[12:15]
    ds_read2_b32 v[144:145], v227 offset0:134 offset1:132
    ds_read2_b32 v[146:147], v227 offset0:130 offset1:128
    v_mfma_f32_16x16x32_bf16 v[16:19], v[136:139], v[56:59], v[16:19]
    ds_read2_b32 v[176:177], v228 offset0:134 offset1:132
    ds_read2_b32 v[178:179], v228 offset0:130 offset1:128
    v_mfma_f32_16x16x32_bf16 v[24:27], v[200:203], v[56:59], v[24:27]
    s_waitcnt lgkmcnt(13)
    ds_read_b128 v[56:59], v246 offset:10240
    ds_read2_b32 v[208:209], v229 offset0:134 offset1:132
    v_mfma_f32_16x16x32_bf16 v[24:27], v[108:111], v[60:63], v[24:27]
    s_waitcnt lgkmcnt(13)
    ds_read_b128 v[60:63], v246 offset:6144
    ds_read2_b32 v[210:211], v229 offset0:130 offset1:128
    v_mfma_f32_16x16x32_bf16 v[20:23], v[108:111], v[64:67], v[20:23]
    buffer_load_dwordx4 v224, s[8:11], s14 offen offset:0 lds
    v_mfma_f32_16x16x32_bf16 v[24:27], v[140:143], v[64:67], v[24:27]
    s_waitcnt lgkmcnt(13)
    ds_read_b128 v[64:67], v246 offset:2048
    buffer_load_dwordx4 v225, s[8:11], s14 offen offset:1024 lds
    v_mfma_f32_16x16x32_bf16 v[20:23], v[140:143], v[44:47], v[20:23]
    v_mfma_f32_16x16x32_bf16 v[16:19], v[108:111], v[44:47], v[16:19]
    v_mfma_f32_16x16x32_bf16 v[24:27], v[172:175], v[44:47], v[24:27]
    s_waitcnt lgkmcnt(12)
    ds_read_b128 v[44:47], v249 offset:12288
    v_mfma_f32_16x16x32_bf16 v[20:23], v[172:175], v[48:51], v[20:23]
    ds_read2_b32 v[116:117], v244 offset0:166 offset1:164
    ds_read2_b32 v[118:119], v244 offset0:162 offset1:160
    v_mfma_f32_16x16x32_bf16 v[12:15], v[108:111], v[48:51], v[12:15]
    ds_read2_b32 v[148:149], v227 offset0:166 offset1:164
    ds_read2_b32 v[150:151], v227 offset0:162 offset1:160
    v_mfma_f32_16x16x32_bf16 v[16:19], v[140:143], v[48:51], v[16:19]
    ds_read2_b32 v[180:181], v228 offset0:166 offset1:164
    ds_read2_b32 v[182:183], v228 offset0:162 offset1:160
    v_mfma_f32_16x16x32_bf16 v[24:27], v[204:207], v[48:51], v[24:27]
    s_waitcnt lgkmcnt(13)
    ds_read_b128 v[48:51], v249 offset:8192
    ds_read2_b32 v[212:213], v229 offset0:166 offset1:164
    v_mfma_f32_16x16x32_bf16 v[24:27], v[112:115], v[52:55], v[24:27]
    s_waitcnt lgkmcnt(13)
    ds_read_b128 v[52:55], v249 offset:4096
    ds_read2_b32 v[214:215], v229 offset0:162 offset1:160
    v_mfma_f32_16x16x32_bf16 v[20:23], v[112:115], v[56:59], v[20:23]
    buffer_load_dwordx4 v226, s[8:11], s14 offen offset:2048 lds
    s_add_u32 m0, s13, 17344
    v_mfma_f32_16x16x32_bf16 v[24:27], v[144:147], v[56:59], v[24:27]
    s_waitcnt lgkmcnt(13)
    ds_read_b128 v[56:59], v249 offset:0
    s_mov_b32 s14, 589824
    v_mfma_f32_16x16x32_bf16 v[20:23], v[144:147], v[60:63], v[20:23]
    buffer_load_dwordx4 v224, s[8:11], s14 offen offset:0 lds
    v_mov_b32 v7, 1
    v_mfma_f32_16x16x32_bf16 v[16:19], v[112:115], v[60:63], v[16:19]
    s_add_u32 s62, s33, 8192
    buffer_atomic_add v7, v2, s[36:39], s62 offen sc0 sc1
    v_mfma_f32_16x16x32_bf16 v[24:27], v[176:179], v[60:63], v[24:27]
    s_waitcnt lgkmcnt(12)
    ds_read_b128 v[60:63], v248 offset:12288
    buffer_load_dwordx4 v225, s[8:11], s14 offen offset:1024 lds
    v_mfma_f32_16x16x32_bf16 v[20:23], v[176:179], v[64:67], v[20:23]
    s_waitcnt vmcnt(13)
    s_barrier
    ds_read2_b32 v[120:121], v244 offset0:198 offset1:196
    ds_read2_b32 v[122:123], v244 offset0:194 offset1:192
    v_mfma_f32_16x16x32_bf16 v[12:15], v[112:115], v[64:67], v[12:15]
    ds_read2_b32 v[152:153], v227 offset0:198 offset1:196
    ds_read2_b32 v[154:155], v227 offset0:194 offset1:192
    v_mfma_f32_16x16x32_bf16 v[16:19], v[144:147], v[64:67], v[16:19]
    ds_read2_b32 v[184:185], v228 offset0:198 offset1:196
    ds_read2_b32 v[186:187], v228 offset0:194 offset1:192
    v_mfma_f32_16x16x32_bf16 v[24:27], v[208:211], v[64:67], v[24:27]
    s_waitcnt lgkmcnt(13)
    ds_read_b128 v[64:67], v248 offset:8192
    ds_read2_b32 v[216:217], v229 offset0:198 offset1:196
    v_mfma_f32_16x16x32_bf16 v[24:27], v[116:119], v[44:47], v[24:27]
    s_waitcnt lgkmcnt(13)
    ds_read_b128 v[44:47], v248 offset:4096
    ds_read2_b32 v[218:219], v229 offset0:194 offset1:192
    v_mfma_f32_16x16x32_bf16 v[20:23], v[116:119], v[48:51], v[20:23]
    buffer_load_dwordx4 v226, s[8:11], s14 offen offset:2048 lds
    s_add_u32 m0, s13, 5040
    v_mfma_f32_16x16x32_bf16 v[24:27], v[148:151], v[48:51], v[24:27]
    s_waitcnt lgkmcnt(13)
    ds_read_b128 v[48:51], v248 offset:0
    s_mov_b32 s14, 688128
    v_mfma_f32_16x16x32_bf16 v[20:23], v[148:151], v[52:55], v[20:23]
    v_mfma_f32_16x16x32_bf16 v[16:19], v[116:119], v[52:55], v[16:19]
    buffer_load_dwordx4 v224, s[8:11], s14 offen offset:0 lds
    v_mfma_f32_16x16x32_bf16 v[24:27], v[180:183], v[52:55], v[24:27]
    s_waitcnt lgkmcnt(12)
    ds_read_b128 v[52:55], v247 offset:12288
    v_mfma_f32_16x16x32_bf16 v[20:23], v[180:183], v[56:59], v[20:23]
    ds_read2_b32 v[124:125], v244 offset0:230 offset1:228
    ds_read2_b32 v[126:127], v244 offset0:226 offset1:224
    v_mfma_f32_16x16x32_bf16 v[12:15], v[116:119], v[56:59], v[12:15]
    ds_read2_b32 v[156:157], v227 offset0:230 offset1:228
    ds_read2_b32 v[158:159], v227 offset0:226 offset1:224
    v_mfma_f32_16x16x32_bf16 v[16:19], v[148:151], v[56:59], v[16:19]
    ds_read2_b32 v[188:189], v228 offset0:230 offset1:228
    ds_read2_b32 v[190:191], v228 offset0:226 offset1:224
    v_mfma_f32_16x16x32_bf16 v[24:27], v[212:215], v[56:59], v[24:27]
    s_waitcnt lgkmcnt(13)
    ds_read_b128 v[56:59], v247 offset:8192
    ds_read2_b32 v[220:221], v229 offset0:230 offset1:228
    v_mfma_f32_16x16x32_bf16 v[24:27], v[120:123], v[60:63], v[24:27]
    s_waitcnt lgkmcnt(13)
    ds_read_b128 v[60:63], v247 offset:4096
    ds_read2_b32 v[222:223], v229 offset0:226 offset1:224
    v_mfma_f32_16x16x32_bf16 v[20:23], v[120:123], v[64:67], v[20:23]
    buffer_load_dwordx4 v225, s[8:11], s14 offen offset:1024 lds
    v_mfma_f32_16x16x32_bf16 v[24:27], v[152:155], v[64:67], v[24:27]
    s_waitcnt lgkmcnt(13)
    ds_read_b128 v[64:67], v247 offset:0
    v_mfma_f32_16x16x32_bf16 v[20:23], v[152:155], v[44:47], v[20:23]
    buffer_load_dwordx4 v226, s[8:11], s14 offen offset:2048 lds
    v_mfma_f32_16x16x32_bf16 v[16:19], v[120:123], v[44:47], v[16:19]
    v_mfma_f32_16x16x32_bf16 v[24:27], v[184:187], v[44:47], v[24:27]
    s_waitcnt lgkmcnt(12)
    ds_read_b128 v[44:47], v251 offset:16384
    v_mfma_f32_16x16x32_bf16 v[20:23], v[184:187], v[48:51], v[20:23]
    s_and_b32 s49, s2, 1
    s_lshl_b32 s49, s49, 5
    ds_read_b64_tr_b16 a[0:1], v232 offset:0
    s_waitcnt vmcnt(13)
    v_xor_b32 v92, s49, v92
    v_mfma_f32_16x16x32_bf16 v[12:15], v[120:123], v[48:51], v[12:15]
    s_lshl_b32 s49, s2, 9
    ds_read_b64_tr_b16 a[2:3], v232 offset:3072
    ds_read_b64_tr_b16 a[4:5], v232 offset:6160
    v_add_u32 v92, s49, v92
    v_mfma_f32_16x16x32_bf16 v[16:19], v[152:155], v[48:51], v[16:19]
    ds_read_b64_tr_b16 a[6:7], v232 offset:9232
    ds_read_b64_tr_b16 a[8:9], v233 offset:0
    v_mfma_f32_16x16x32_bf16 v[24:27], v[216:219], v[48:51], v[24:27]
    s_waitcnt lgkmcnt(13)
    ds_read_b128 v[48:51], v251 offset:20480
    ds_read_b64_tr_b16 a[10:11], v233 offset:3072
    v_mfma_f32_16x16x32_bf16 v[24:27], v[124:127], v[52:55], v[24:27]
    s_waitcnt lgkmcnt(12)
    ds_read_b128 v[52:55], v251 offset:24576
    ds_read_b64_tr_b16 a[12:13], v232 offset:12304
    v_mfma_f32_16x16x32_bf16 v[20:23], v[124:127], v[56:59], v[20:23]
    ds_read_b64_tr_b16 a[14:15], v232 offset:15376
    ds_read_b64_tr_b16 a[16:17], v232 offset:18464
    v_mfma_f32_16x16x32_bf16 v[24:27], v[156:159], v[56:59], v[24:27]
    s_waitcnt lgkmcnt(13)
    ds_read_b128 v[56:59], v251 offset:28672
    ds_read_b64_tr_b16 a[18:19], v232 offset:21536
    v_mfma_f32_16x16x32_bf16 v[20:23], v[156:159], v[60:63], v[20:23]
    buffer_load_dword v5, v255, s[36:39], s16 offen offset:128 sc1
    ds_read_b64_tr_b16 a[20:21], v233 offset:12304
    v_mfma_f32_16x16x32_bf16 v[16:19], v[124:127], v[60:63], v[16:19]
    ds_read_b64_tr_b16 a[22:23], v233 offset:15376
    ds_read_b64_tr_b16 a[24:25], v234 offset:50176
    v_mfma_f32_16x16x32_bf16 v[24:27], v[188:191], v[60:63], v[24:27]
    s_waitcnt lgkmcnt(13)
    ds_read_b128 v[60:63], v249 offset:30720
    ds_read_b64_tr_b16 a[26:27], v234 offset:53248
    v_mfma_f32_16x16x32_bf16 v[20:23], v[188:191], v[64:67], v[20:23]
    ds_read_b64_tr_b16 a[28:29], v234 offset:56336
    ds_read_b64_tr_b16 a[30:31], v234 offset:59408
    v_mfma_f32_16x16x32_bf16 v[12:15], v[124:127], v[64:67], v[12:15]
    ds_read_b64_tr_b16 a[32:33], v235 offset:50176
    ds_read_b64_tr_b16 a[34:35], v235 offset:53248
    v_mfma_f32_16x16x32_bf16 v[16:19], v[156:159], v[64:67], v[16:19]
    v_mfma_f32_16x16x32_bf16 v[24:27], v[220:223], v[64:67], v[24:27]
    ds_read_b128 v[64:67], v249 offset:26624
    v_mfma_f32_16x16x32_bf16 v[28:31], v[8:11], v[44:47], 0
    s_waitcnt lgkmcnt(14)
    ds_read_b128 v[44:47], v249 offset:22528
    v_mfma_f32_16x16x32_bf16 v[32:35], v[8:11], v[48:51], 0
    ds_read_b128 v[48:51], v249 offset:18432
    v_mfma_f32_16x16x32_bf16 v[36:39], v[8:11], v[52:55], 0
    s_waitcnt lgkmcnt(13)
    ds_read_b128 v[52:55], v249 offset:14336
    v_cvt_pk_bf16_f32 v84, v12, v13
L_pg3:
    s_cbranch_execz L_pg7
    v_cvt_pk_bf16_f32 v85, v14, v15
    v_mfma_f32_16x16x32_bf16 v[40:43], v[8:11], v[56:59], 0
    s_waitcnt lgkmcnt(9)
    ds_read_b128 v[56:59], v249 offset:10240
    v_cvt_pk_bf16_f32 v86, v16, v17
    v_cvt_pk_bf16_f32 v87, v18, v19
    v_mfma_f32_16x16x32_bf16 v[40:43], v[100:103], v[60:63], v[40:43]
    ds_read_b128 v[60:63], v249 offset:6144
    s_waitcnt vmcnt(6)
    v_add_lshl_u32 v7, v7, -9, 26
    v_cvt_pk_bf16_f32 v88, v20, v21
    s_waitcnt lgkmcnt(5)
    v_mfma_f32_16x16x32_bf16 v[36:39], v[100:103], v[64:67], v[36:39]
    buffer_store_dword v4, v7, s[36:39], s62 offen offset:128 sc1
    v_cvt_pk_bf16_f32 v89, v22, v23
    v_mfma_f32_16x16x32_bf16 v[40:43], v[132:135], v[64:67], v[40:43]
    s_waitcnt lgkmcnt(4)
    ds_read_b128 v[64:67], v248 offset:30720
    v_cvt_pk_bf16_f32 v90, v24, v25
    v_cvt_pk_bf16_f32 v91, v26, v27
    v_mfma_f32_16x16x32_bf16 v[36:39], v[132:135], v[44:47], v[36:39]
    s_mov_b32 s56, 6422528
    v_permlane16_swap_b32 v84, v86
    v_mfma_f32_16x16x32_bf16 v[32:35], v[100:103], v[44:47], v[32:35]
    v_permlane16_swap_b32 v85, v87
    v_mfma_f32_16x16x32_bf16 v[40:43], v[164:167], v[44:47], v[40:43]
    s_waitcnt lgkmcnt(4)
    ds_read_b128 v[44:47], v248 offset:26624
    buffer_store_dwordx4 v[84:87], v92, s[36:39], s56 offen sc1
    v_mfma_f32_16x16x32_bf16 v[36:39], v[164:167], v[48:51], v[36:39]
    s_mov_b32 s56, 7078912
    v_permlane16_swap_b32 v88, v90
    v_mfma_f32_16x16x32_bf16 v[28:31], v[100:103], v[48:51], v[28:31]
    v_permlane16_swap_b32 v89, v91
    v_mfma_f32_16x16x32_bf16 v[32:35], v[132:135], v[48:51], v[32:35]
    buffer_store_dwordx4 v[88:91], v92, s[36:39], s56 offen sc1
    v_mfma_f32_16x16x32_bf16 v[40:43], v[196:199], v[48:51], v[40:43]
    s_waitcnt lgkmcnt(4)
    ds_read_b128 v[48:51], v248 offset:22528
    global_load_dwordx4 a[240:243], v6, s[60:61] offset:-3072
    v_mfma_f32_16x16x32_bf16 v[36:39], v[196:199], v[52:55], v[36:39]
    s_lshr_b32 s49, s47, 2
    ds_read2_b32 a[248:249], v230 offset0:6 offset1:4
    v_mfma_f32_16x16x32_bf16 v[28:31], v[132:135], v[52:55], v[28:31]
    s_sub_u32 s49, s49, 0
    ds_read2_b32 a[250:251], v230 offset0:2 offset1:0
    s_lshr_b32 s63, s49, 1
    v_mfma_f32_16x16x32_bf16 v[32:35], v[164:167], v[52:55], v[32:35]
    s_waitcnt lgkmcnt(6)
    ds_read_b128 v[52:55], v248 offset:18432
    v_mfma_f32_16x16x32_bf16 v[28:31], v[164:167], v[56:59], v[28:31]
    s_lshl_b32 s63, s63, 26
    ds_read2_b32 v[68:69], v245 offset0:3 offset1:2
    global_load_dwordx4 a[244:247], v6, s[60:61] offset:-2048
    v_mfma_f32_16x16x32_bf16 v[32:35], v[196:199], v[56:59], v[32:35]
    s_waitcnt lgkmcnt(7)
    ds_read_b128 v[56:59], v248 offset:14336
    s_and_b32 s50, s2, 1
    v_mfma_f32_16x16x32_bf16 v[28:31], v[196:199], v[60:63], v[28:31]
    s_waitcnt lgkmcnt(7)
    ds_read_b128 v[60:63], v248 offset:10240
    s_lshl_b32 s50, s50, 1
    v_mfma_f32_16x16x32_bf16 v[40:43], v[104:107], v[64:67], v[40:43]
    s_waitcnt lgkmcnt(7)
    ds_read_b128 v[64:67], v248 offset:6144
    v_mfma_f32_16x16x32_bf16 v[36:39], v[104:107], v[44:47], v[36:39]
    s_add_u32 s49, s49, s50
    ds_read2_b32 v[70:71], v245 offset0:1 offset1:0
    s_and_b32 s49, s2, 3
    v_mfma_f32_16x16x32_bf16 v[40:43], v[136:139], v[44:47], v[40:43]
    s_waitcnt lgkmcnt(8)
    ds_read_b128 v[44:47], v247 offset:30720
    v_lshrrev_b32 v93, 2, v1
    v_mfma_f32_16x16x32_bf16 v[36:39], v[136:139], v[48:51], v[36:39]
    ds_read2_b32 v[72:73], v245 offset0:19 offset1:18
    v_bfe_u32 v94, v1, 3, 2
    v_mfma_f32_16x16x32_bf16 v[32:35], v[104:107], v[48:51], v[32:35]
    ds_read2_b32 v[74:75], v245 offset0:17 offset1:16
    v_xor_b32 v94, s49, v94
    v_mfma_f32_16x16x32_bf16 v[40:43], v[168:171], v[48:51], v[40:43]
    s_waitcnt lgkmcnt(8)
    ds_read_b128 v[48:51], v247 offset:26624
    v_lshlrev_b32 v94, 4, v94
    v_mfma_f32_16x16x32_bf16 v[36:39], v[168:171], v[52:55], v[36:39]
    s_waitcnt vmcnt(5)
    v_cmp_gt_u32 vcc, 6, v5
    s_nop 0
    s_and_b64 vcc, vcc, s[58:59]
    s_cbranch_scc1 L_spin_9
L_back_10:
    s_barrier
    v_mfma_f32_16x16x32_bf16 v[28:31], v[104:107], v[52:55], v[28:31]
    ds_read2_b32 v[76:77], v245 offset0:35 offset1:34
    buffer_load_dwordx4 a[96:99], v252, s[36:39], s70 offen offset:0 sc1
    v_mfma_f32_16x16x32_bf16 v[32:35], v[136:139], v[52:55], v[32:35]
    ds_read2_b32 v[78:79], v245 offset0:33 offset1:32
    ds_read_b64_tr_b16 a[36:37], v234 offset:37872
    v_mfma_f32_16x16x32_bf16 v[40:43], v[200:203], v[52:55], v[40:43]
    s_waitcnt lgkmcnt(10)
    ds_read_b128 v[52:55], v247 offset:22528
    ds_read_b64_tr_b16 a[38:39], v234 offset:40944
    v_mfma_f32_16x16x32_bf16 v[36:39], v[200:203], v[56:59], v[36:39]
    ds_read2_b32 v[80:81], v245 offset0:51 offset1:50
    ds_read_b64_tr_b16 a[40:41], v234 offset:44032
    v_mfma_f32_16x16x32_bf16 v[28:31], v[136:139], v[56:59], v[28:31]
    ds_read2_b32 v[82:83], v245 offset0:49 offset1:48
    buffer_load_dwordx4 a[100:103], v252, s[36:39], s70 offen offset:1024 sc1
    v_mfma_f32_16x16x32_bf16 v[32:35], v[168:171], v[56:59], v[32:35]
    s_waitcnt lgkmcnt(13)
    ds_read_b128 v[56:59], v247 offset:18432
    ds_read_b64_tr_b16 a[42:43], v234 offset:47104
    v_mfma_f32_16x16x32_bf16 v[28:31], v[168:171], v[60:63], v[28:31]
    ds_read_b64_tr_b16 a[44:45], v235 offset:37872
    ds_read_b64_tr_b16 a[46:47], v235 offset:40944
    v_mfma_f32_16x16x32_bf16 v[32:35], v[200:203], v[60:63], v[32:35]
    ds_read_b128 v[60:63], v247 offset:14336
    ds_read_b64_tr_b16 a[48:49], v234 offset:25568
    v_mfma_f32_16x16x32_bf16 v[28:31], v[200:203], v[64:67], v[28:31]
    s_waitcnt lgkmcnt(13)
    ds_read_b128 v[64:67], v247 offset:10240
    ds_read_b64_tr_b16 a[50:51], v234 offset:28640
    v_mfma_f32_16x16x32_bf16 v[40:43], v[108:111], v[44:47], v[40:43]
    ds_read_b128 v[44:47], v247 offset:6144
    buffer_load_dwordx4 a[104:107], v252, s[36:39], s70 offen offset:2048 sc1
    v_mfma_f32_16x16x32_bf16 v[36:39], v[108:111], v[48:51], v[36:39]
    ds_read_b64_tr_b16 a[52:53], v234 offset:31728
    ds_read_b64_tr_b16 a[54:55], v234 offset:34800
    v_mfma_f32_16x16x32_bf16 v[40:43], v[140:143], v[48:51], v[40:43]
    s_waitcnt lgkmcnt(13)
    ds_read_b128 v[48:51], v246 offset:32768
    ds_read_b64_tr_b16 a[56:57], v235 offset:25568
    v_mfma_f32_16x16x32_bf16 v[36:39], v[140:143], v[52:55], v[36:39]
    ds_read_b64_tr_b16 a[58:59], v235 offset:28640
    ds_read_b64_tr_b16 a[60:61], v234 offset:13264
    v_mfma_f32_16x16x32_bf16 v[32:35], v[108:111], v[52:55], v[32:35]
    buffer_load_dwordx4 a[108:111], v252, s[36:39], s70 offen offset:3072 sc1
    ds_read_b64_tr_b16 a[62:63], v234 offset:16336
    v_mfma_f32_16x16x32_bf16 v[40:43], v[172:175], v[52:55], v[40:43]
    s_waitcnt lgkmcnt(13)
    ds_read_b128 v[52:55], v246 offset:28672
    ds_read_b64_tr_b16 a[64:65], v234 offset:19424
    v_mfma_f32_16x16x32_bf16 v[36:39], v[172:175], v[56:59], v[36:39]
    ds_read_b64_tr_b16 a[66:67], v234 offset:22496
    ds_read_b64_tr_b16 a[68:69], v235 offset:13264
    v_mfma_f32_16x16x32_bf16 v[28:31], v[108:111], v[56:59], v[28:31]
    ds_read_b64_tr_b16 a[70:71], v235 offset:16336
    ds_read_b64_tr_b16 a[72:73], v234 offset:960
    v_mfma_f32_16x16x32_bf16 v[32:35], v[140:143], v[56:59], v[32:35]
    s_waitcnt vmcnt(6)
    s_barrier
    s_add_u32 s62, s33, 16384
    buffer_atomic_add v4, v2, s[36:39], s62 offen offset:128 sc1
    v_mfma_f32_16x16x32_bf16 v[40:43], v[204:207], v[56:59], v[40:43]
    s_waitcnt lgkmcnt(14)
    ds_read_b128 v[56:59], v246 offset:24576
    buffer_load_dwordx4 a[112:115], v252, s[36:39], s71 offen offset:0 sc1
    v_mfma_f32_16x16x32_bf16 v[36:39], v[204:207], v[60:63], v[36:39]
    ds_read_b64_tr_b16 a[74:75], v234 offset:4032
    ds_read_b64_tr_b16 a[76:77], v234 offset:7120
    v_mfma_f32_16x16x32_bf16 v[28:31], v[140:143], v[60:63], v[28:31]
    ds_read_b64_tr_b16 a[78:79], v234 offset:10192
    ds_read_b64_tr_b16 a[80:81], v235 offset:960
    v_mfma_f32_16x16x32_bf16 v[32:35], v[172:175], v[60:63], v[32:35]
    ds_read_b128 v[60:63], v246 offset:20480
    ds_read_b64_tr_b16 a[82:83], v235 offset:4032
    v_mfma_f32_16x16x32_bf16 v[28:31], v[172:175], v[64:67], v[28:31]
    buffer_load_dwordx4 a[116:119], v252, s[36:39], s71 offen offset:1024 sc1
    ds_read_b64_tr_b16 a[84:85], v236 offset:5040
    v_mfma_f32_16x16x32_bf16 v[32:35], v[204:207], v[64:67], v[32:35]
    s_waitcnt lgkmcnt(13)
    ds_read_b128 v[64:67], v246 offset:16384
    ds_read_b64_tr_b16 a[86:87], v236 offset:8112
    v_mfma_f32_16x16x32_bf16 v[28:31], v[204:207], v[44:47], v[28:31]
    ds_read_b128 v[44:47], v246 offset:12288
    ds_read_b64_tr_b16 a[88:89], v236 offset:11200
    v_mfma_f32_16x16x32_bf16 v[40:43], v[96:99], v[48:51], v[40:43]
    ds_read_b128 v[48:51], v246 offset:8192
    ds_read_b64_tr_b16 a[90:91], v236 offset:14272
    v_mfma_f32_16x16x32_bf16 v[36:39], v[96:99], v[52:55], v[36:39]
    ds_read_b64_tr_b16 a[92:93], v237 offset:5040
    ds_read_b64_tr_b16 a[94:95], v237 offset:8112
    v_mfma_f32_16x16x32_bf16 v[40:43], v[128:131], v[52:55], v[40:43]
    s_waitcnt lgkmcnt(14)
    ds_read_b128 v[52:55], v246 offset:4096
    buffer_load_dwordx4 a[120:123], v252, s[36:39], s71 offen offset:2048 sc1
    v_mfma_f32_16x16x32_bf16 v[36:39], v[128:131], v[56:59], v[36:39]
    v_lshl_add_u32 v94, v93, 7, v94
    v_and_b32 v95, 2, v1
    v_mfma_f32_16x16x32_bf16 v[32:35], v[96:99], v[56:59], v[32:35]
    v_lshl_add_u32 v94, v95, 5, v94
    v_and_b32 v95, 1, v1
    v_mfma_f32_16x16x32_bf16 v[40:43], v[160:163], v[56:59], v[40:43]
    s_waitcnt lgkmcnt(11)
    ds_read_b128 v[56:59], v250 offset:0
    v_lshl_add_u32 v94, v95, 3, v94
    v_mfma_f32_16x16x32_bf16 v[36:39], v[160:163], v[60:63], v[36:39]
    s_mul_i32 s50, s44, 20480
    buffer_load_dwordx4 a[124:127], v252, s[36:39], s71 offen offset:3072 sc1
    v_mfma_f32_16x16x32_bf16 v[28:31], v[96:99], v[60:63], v[28:31]
    v_add_u32 v244, s50, v94
    v_mfma_f32_16x16x32_bf16 v[32:35], v[128:131], v[60:63], v[32:35]
    s_lshl_b32 s50, s45, 2
    s_add_u32 s50, s50, s49
    s_lshl_b32 s50, s50, 10
    v_mfma_f32_16x16x32_bf16 v[40:43], v[192:195], v[60:63], v[40:43]
    s_waitcnt lgkmcnt(9)
    ds_read_b128 v[60:63], v250 offset:4096
    v_mfma_f32_16x16x32_bf16 v[36:39], v[192:195], v[64:67], v[36:39]
    s_lshl_b32 s51, s44, 8
    s_add_u32 s50, s50, s51
    v_mfma_f32_16x16x32_bf16 v[28:31], v[128:131], v[64:67], v[28:31]
    s_add_u32 s50, s50, 32768
    buffer_load_dwordx4 a[128:131], v252, s[36:39], s72 offen offset:0 sc1
    v_mfma_f32_16x16x32_bf16 v[40:43], a[248:251], v[64:67], v[40:43]
    s_add_u32 s50, s50, s63
    v_and_b32 v94, 15, v1
    v_lshl_add_u32 v95, v94, 4, s50
    v_mfma_f32_16x16x32_bf16 v[32:35], v[160:163], v[64:67], v[32:35]
    s_waitcnt vmcnt(11)
    v_lshrrev_b32 v94, 2, v94
    v_lshrrev_b32 v93, 4, v1
    v_mfma_f32_16x16x32_bf16 v[196:199], v[64:67], a[240:243], 0
    s_waitcnt lgkmcnt(8)
    ds_read_b128 v[64:67], v250 offset:8192
    v_xor_b32 v93, v93, v94
    v_mfma_f32_16x16x32_bf16 v[28:31], v[160:163], v[44:47], v[28:31]
    buffer_load_dwordx4 a[132:135], v252, s[36:39], s72 offen offset:1024 sc1
    v_mfma_f32_16x16x32_bf16 v[36:39], a[248:251], v[44:47], v[36:39]
    s_mov_b32 s32, 8192
    buffer_load_dword v5, v3, s[36:39], s32 offen offset:128 sc1
    v_mfma_f32_16x16x32_bf16 v[32:35], v[192:195], v[44:47], v[32:35]
    v_lshl_add_u32 v243, v93, 28, v95
    v_mov_b32 v12, 0
    v_mfma_f32_16x16x32_bf16 v[164:167], v[44:47], a[240:243], 0
    s_waitcnt lgkmcnt(7)
    ds_read_b128 v[44:47], v250 offset:12288
    v_mov_b32 v13, 0
    v_mfma_f32_16x16x32_bf16 v[28:31], v[192:195], v[48:51], v[28:31]
    v_mov_b32 v14, 0
    v_mov_b32 v15, 0
    v_mfma_f32_16x16x32_bf16 v[32:35], a[248:251], v[48:51], v[32:35]
    buffer_load_dwordx4 a[136:139], v252, s[36:39], s72 offen offset:2048 sc1
    v_mfma_f32_16x16x32_bf16 v[132:135], v[48:51], a[240:243], 0
    s_waitcnt lgkmcnt(4)
    ds_read_b128 v[48:51], v246 offset:30720
    v_mfma_f32_16x16x32_bf16 v[28:31], a[248:251], v[52:55], v[28:31]
    buffer_store_dwordx4 v[12:15], v243, s[36:39], 0 offen sc1
    v_mfma_f32_16x16x32_bf16 v[100:103], v[52:55], a[240:243], 0
    s_waitcnt vmcnt(14) lgkmcnt(4)
    ds_read_b128 v[52:55], v246 offset:26624
    v_mfma_f32_16x16x32_bf16 v[104:107], v[56:59], a[244:247], 0
    s_waitcnt lgkmcnt(4)
    ds_read_b128 v[56:59], v246 offset:22528
    global_load_dwordx4 v[224:227], v6, s[60:61] offset:-1024
    v_mfma_f32_16x16x32_bf16 v[136:139], v[60:63], a[244:247], 0
    s_waitcnt lgkmcnt(4)
    ds_read_b128 v[60:63], v246 offset:18432
    v_mfma_f32_16x16x32_bf16 v[168:171], v[64:67], a[244:247], 0
    s_waitcnt lgkmcnt(4)
    ds_read_b128 v[64:67], v246 offset:14336
    v_mfma_f32_16x16x32_bf16 v[200:203], v[44:47], a[244:247], 0
    s_waitcnt lgkmcnt(4)
    ds_read_b128 v[44:47], v246 offset:10240
    v_mfma_f32_16x16x32_bf16 v[40:43], v[112:115], v[48:51], v[40:43]
    s_waitcnt lgkmcnt(4)
    ds_read_b128 v[48:51], v246 offset:6144
    v_mfma_f32_16x16x32_bf16 v[36:39], v[112:115], v[52:55], v[36:39]
    global_load_dwordx4 v[228:231], v6, s[60:61] offset:0
    v_mfma_f32_16x16x32_bf16 v[40:43], v[144:147], v[52:55], v[40:43]
    s_waitcnt lgkmcnt(4)
    ds_read_b128 v[52:55], v249 offset:28672
    v_mfma_f32_16x16x32_bf16 v[36:39], v[144:147], v[56:59], v[36:39]
    v_cvt_pk_bf16_f32 v108, v100, v104
    v_cvt_pk_bf16_f32 v109, v101, v105
    v_mfma_f32_16x16x32_bf16 v[32:35], v[112:115], v[56:59], v[32:35]
    v_cvt_pk_bf16_f32 v110, v102, v106
    v_cvt_pk_bf16_f32 v111, v103, v107
    v_mfma_f32_16x16x32_bf16 v[40:43], v[176:179], v[56:59], v[40:43]
    s_waitcnt lgkmcnt(4)
    ds_read_b128 v[56:59], v249 offset:24576
    v_cvt_pk_bf16_f32 v140, v132, v136
    v_mfma_f32_16x16x32_bf16 v[36:39], v[176:179], v[60:63], v[36:39]
    v_cvt_pk_bf16_f32 v141, v133, v137
    v_cvt_pk_bf16_f32 v142, v134, v138
    v_mfma_f32_16x16x32_bf16 v[28:31], v[112:115], v[60:63], v[28:31]
    v_cvt_pk_bf16_f32 v143, v135, v139
    v_cvt_pk_bf16_f32 v172, v164, v168
    v_mfma_f32_16x16x32_bf16 v[32:35], v[144:147], v[60:63], v[32:35]
    v_cvt_pk_bf16_f32 v173, v165, v169
    v_cvt_pk_bf16_f32 v174, v166, v170
    v_mfma_f32_16x16x32_bf16 v[40:43], v[208:211], v[60:63], v[40:43]
    s_waitcnt lgkmcnt(4)
    ds_read_b128 v[60:63], v249 offset:20480
    v_cvt_pk_bf16_f32 v175, v167, v171
    v_mfma_f32_16x16x32_bf16 v[36:39], v[208:211], v[64:67], v[36:39]
    v_cvt_pk_bf16_f32 v204, v196, v200
    v_cvt_pk_bf16_f32 v205, v197, v201
    v_mfma_f32_16x16x32_bf16 v[28:31], v[144:147], v[64:67], v[28:31]
    v_cvt_pk_bf16_f32 v206, v198, v202
    v_cvt_pk_bf16_f32 v207, v199, v203
    v_mfma_f32_16x16x32_bf16 v[32:35], v[176:179], v[64:67], v[32:35]
    s_waitcnt lgkmcnt(4)
    ds_read_b128 v[64:67], v249 offset:16384
    global_load_dwordx4 v[232:235], v6, s[60:61] offset:1024
    v_mfma_f32_16x16x32_bf16 v[28:31], v[176:179], v[44:47], v[28:31]
    global_load_dwordx4 v[236:239], v6, s[60:61] offset:2048
    v_mfma_f32_16x16x32_bf16 v[32:35], v[208:211], v[44:47], v[32:35]
    s_waitcnt lgkmcnt(4)
    ds_read_b128 v[44:47], v249 offset:12288
    v_mfma_f32_16x16x32_bf16 v[28:31], v[208:211], v[48:51], v[28:31]
    s_waitcnt lgkmcnt(4)
    ds_read_b128 v[48:51], v249 offset:8192
    buffer_load_dwordx4 a[140:143], v252, s[36:39], s72 offen offset:3072 sc1
    v_mfma_f32_16x16x32_bf16 v[40:43], v[116:119], v[52:55], v[40:43]
    s_waitcnt lgkmcnt(4)
    ds_read_b128 v[52:55], v249 offset:4096
    v_mfma_f32_16x16x32_bf16 v[36:39], v[116:119], v[56:59], v[36:39]
    buffer_store_dwordx4 v[12:15], v243, s[36:39], s80 offen sc1
    v_mfma_f32_16x16x32_bf16 v[40:43], v[148:151], v[56:59], v[40:43]
    s_waitcnt lgkmcnt(4)
    ds_read_b128 v[56:59], v248 offset:28672
    v_mfma_f32_16x16x32_bf16 v[36:39], v[148:151], v[60:63], v[36:39]
    s_mul_i32 s49, s46, 12
    s_lshl_b32 s12, s49, 8
    v_mfma_f32_16x16x32_bf16 v[32:35], v[116:119], v[60:63], v[32:35]
    s_add_u32 s12, s12, 163840
    buffer_load_dwordx4 a[144:147], v252, s[36:39], s73 offen offset:0 sc1
    v_mfma_f32_16x16x32_bf16 v[40:43], v[180:183], v[60:63], v[40:43]
    s_waitcnt lgkmcnt(4)
    ds_read_b128 v[60:63], v248 offset:24576
    v_mfma_f32_16x16x32_bf16 v[36:39], v[180:183], v[64:67], v[36:39]
    s_mul_i32 s50, s45, 384
    s_add_u32 s49, s49, s50
    v_mfma_f32_16x16x32_bf16 v[28:31], v[116:119], v[64:67], v[28:31]
    s_lshl_b32 s49, s49, 9
    s_add_u32 s34, s49, 16777216
    v_mfma_f32_16x16x32_bf16 v[32:35], v[148:151], v[64:67], v[32:35]
    s_and_b32 s51, s46, 7
    buffer_load_dwordx4 a[148:151], v252, s[36:39], s73 offen offset:1024 sc1
    v_mfma_f32_16x16x32_bf16 v[40:43], v[212:215], v[64:67], v[40:43]
    s_waitcnt lgkmcnt(4)
    ds_read_b128 v[64:67], v248 offset:20480
    v_mfma_f32_16x16x32_bf16 v[36:39], v[212:215], v[44:47], v[36:39]
    s_lshl_b32 s49, s51, 2
    s_add_u32 s49, s49, s44
    v_mfma_f32_16x16x32_bf16 v[28:31], v[148:151], v[44:47], v[28:31]
    s_mul_i32 s49, s49, 61440
    s_add_u32 s49, s49, 14680064
    v_add_u32 v240, s49, v6
    v_mfma_f32_16x16x32_bf16 v[32:35], v[180:183], v[44:47], v[32:35]
    ds_read_b128 v[44:47], v248 offset:16384
    s_waitcnt vmcnt(10)
    v_cmp_gt_u32 vcc, 1, v5
    s_nop 0
    s_and_b64 vcc, vcc, s[58:59]
    s_cbranch_scc1 L_spin_7
L_back_8:
    s_waitcnt lgkmcnt(5)
    v_mfma_f32_16x16x32_bf16 v[28:31], v[180:183], v[48:51], v[28:31]
    s_mov_b32 s32, 16384
    buffer_load_dword v5, v3, s[36:39], s32 offen offset:128 sc1
    v_mfma_f32_16x16x32_bf16 v[32:35], v[212:215], v[48:51], v[32:35]
    s_waitcnt lgkmcnt(4)
    ds_read_b128 v[48:51], v248 offset:12288
    buffer_load_dwordx4 a[152:155], v252, s[36:39], s73 offen offset:2048 sc1
    v_mfma_f32_16x16x32_bf16 v[28:31], v[212:215], v[52:55], v[28:31]
    s_lshl_b32 s3, s45, 12
    s_add_u32 s3, s3, 32768
    v_mfma_f32_16x16x32_bf16 v[28:31], v[108:111], v[68:71], v[28:31]
    s_lshl_b32 s35, s45, 8
    s_add_u32 s35, s35, 20480
    v_mfma_f32_16x16x32_bf16 v[32:35], v[108:111], v[72:75], v[32:35]
    s_mov_b32 s40, s30
    buffer_load_dwordx4 a[156:159], v252, s[36:39], s73 offen offset:3072 sc1
    v_mfma_f32_16x16x32_bf16 v[36:39], v[108:111], v[76:79], v[36:39]
    s_mov_b32 s41, s31
    s_mov_b32 s42, 2621440
    v_mfma_f32_16x16x32_bf16 v[40:43], v[108:111], v[80:83], v[40:43]
    s_mov_b32 s43, 0x20000
    s_lshr_b32 s52, s46, 3
    v_mfma_f32_16x16x32_bf16 v[32:35], v[140:143], v[68:71], v[32:35]
    s_lshl_b32 s49, s45, 1
    s_add_u32 s49, s49, s52
    v_mfma_f32_16x16x32_bf16 v[36:39], v[140:143], v[72:75], v[36:39]
    s_mul_i32 s50, s49, 98304
    s_add_u32 s50, s50, 16777216
    v_mfma_f32_16x16x32_bf16 v[40:43], v[140:143], v[76:79], v[40:43]
    s_mul_i32 s49, s49, 40960
    buffer_load_dwordx4 a[160:163], v252, s[36:39], s74 offen offset:0 sc1
    v_mfma_f32_16x16x32_bf16 v[36:39], v[172:175], v[68:71], v[36:39]
    s_mul_i32 s47, s51, 160
    s_add_u32 s47, s47, s49
    v_mfma_f32_16x16x32_bf16 v[40:43], v[172:175], v[72:75], v[40:43]
    s_mul_i32 s51, s51, 10240
    s_lshl_b32 s52, s52, 5
    v_mfma_f32_16x16x32_bf16 v[40:43], v[204:207], v[68:71], v[40:43]
    s_waitcnt lgkmcnt(4)
    ds_read_b128 v[52:55], v248 offset:8192
    v_mfma_f32_16x16x32_bf16 v[40:43], v[120:123], v[56:59], v[40:43]
    s_waitcnt lgkmcnt(4)
    ds_read_b128 v[56:59], v248 offset:4096
    buffer_load_dwordx4 a[164:167], v252, s[36:39], s74 offen offset:1024 sc1
    v_mfma_f32_16x16x32_bf16 v[36:39], v[120:123], v[60:63], v[36:39]
    v_mfma_f32_16x16x32_bf16 v[40:43], v[152:155], v[60:63], v[40:43]
    s_waitcnt lgkmcnt(4)
    ds_read_b128 v[60:63], v247 offset:28672
    v_mfma_f32_16x16x32_bf16 v[36:39], v[152:155], v[64:67], v[36:39]
    v_mfma_f32_16x16x32_bf16 v[32:35], v[120:123], v[64:67], v[32:35]
    v_mfma_f32_16x16x32_bf16 v[40:43], v[184:187], v[64:67], v[40:43]
    s_waitcnt lgkmcnt(4)
    ds_read_b128 v[64:67], v247 offset:24576
    buffer_load_dwordx4 a[168:171], v252, s[36:39], s74 offen offset:2048 sc1
    v_mfma_f32_16x16x32_bf16 v[36:39], v[184:187], v[44:47], v[36:39]
    v_mfma_f32_16x16x32_bf16 v[28:31], v[120:123], v[44:47], v[28:31]
    v_mfma_f32_16x16x32_bf16 v[32:35], v[152:155], v[44:47], v[32:35]
    v_mfma_f32_16x16x32_bf16 v[40:43], v[216:219], v[44:47], v[40:43]
    s_waitcnt lgkmcnt(4)
    ds_read_b128 v[44:47], v247 offset:20480
    buffer_load_dwordx4 a[172:175], v252, s[36:39], s74 offen offset:3072 sc1
    v_mfma_f32_16x16x32_bf16 v[36:39], v[216:219], v[48:51], v[36:39]
    v_mfma_f32_16x16x32_bf16 v[28:31], v[152:155], v[48:51], v[28:31]
    v_mfma_f32_16x16x32_bf16 v[32:35], v[184:187], v[48:51], v[32:35]
    s_waitcnt lgkmcnt(4)
    ds_read_b128 v[48:51], v247 offset:16384
    v_mfma_f32_16x16x32_bf16 v[28:31], v[184:187], v[52:55], v[28:31]
    v_mfma_f32_16x16x32_bf16 v[32:35], v[216:219], v[52:55], v[32:35]
    s_waitcnt lgkmcnt(4)
    ds_read_b128 v[52:55], v247 offset:12288
    buffer_load_dwordx4 a[176:179], v252, s[36:39], s75 offen offset:0 sc1
    v_mfma_f32_16x16x32_bf16 v[28:31], v[216:219], v[56:59], v[28:31]
    s_waitcnt lgkmcnt(4)
    ds_read_b128 v[56:59], v247 offset:8192
    v_mfma_f32_16x16x32_bf16 v[40:43], v[124:127], v[60:63], v[40:43]
    s_waitcnt lgkmcnt(4)
    ds_read_b128 v[60:63], v247 offset:4096
    v_mfma_f32_16x16x32_bf16 v[36:39], v[124:127], v[64:67], v[36:39]
    v_mfma_f32_16x16x32_bf16 v[40:43], v[156:159], v[64:67], v[40:43]
    s_waitcnt lgkmcnt(4)
    v_mfma_f32_16x16x32_bf16 v[36:39], v[156:159], v[44:47], v[36:39]
    v_mfma_f32_16x16x32_bf16 v[32:35], v[124:127], v[44:47], v[32:35]
    s_waitcnt vmcnt(7)
    v_cmp_gt_u32 vcc, 10, v5
    s_nop 0
    s_and_b64 vcc, vcc, s[58:59]
    s_cbranch_scc1 L_spin_5
L_back_6:
    s_barrier
    v_mfma_f32_16x16x32_bf16 v[40:43], v[188:191], v[44:47], v[40:43]
    s_waitcnt lgkmcnt(3)
    s_lshl_b32 m0, s44, 10
    s_nop 0
    buffer_load_dwordx4 v254, s[36:39], s64 offen sc1 lds
    v_mfma_f32_16x16x32_bf16 v[36:39], v[188:191], v[48:51], v[36:39]
    s_add_u32 m0, m0, 4096
    s_nop 0
    buffer_load_dwordx4 v254, s[36:39], s65 offen sc1 lds
    v_mfma_f32_16x16x32_bf16 v[28:31], v[124:127], v[48:51], v[28:31]
    s_add_u32 m0, m0, 4096
    v_mfma_f32_16x16x32_bf16 v[32:35], v[156:159], v[48:51], v[32:35]
    buffer_load_dwordx4 v254, s[36:39], s66 offen sc1 lds
    s_add_u32 m0, m0, 4096
    v_mfma_f32_16x16x32_bf16 v[40:43], v[220:223], v[48:51], v[40:43]
    s_waitcnt lgkmcnt(2)
    buffer_load_dwordx4 v254, s[36:39], s67 offen sc1 lds
    v_mfma_f32_16x16x32_bf16 v[36:39], v[220:223], v[52:55], v[36:39]
    s_add_u32 m0, m0, 4096
    v_add_u32 v237, s50, v237
    v_xor_b32 v228, s52, v228
    v_add_u32 v228, s51, v228
    v_mfma_f32_16x16x32_bf16 v[28:31], v[156:159], v[52:55], v[28:31]
    v_xor_b32 v229, s52, v229
    v_add_u32 v229, s51, v229
    v_xor_b32 v230, s52, v230
    v_mfma_f32_16x16x32_bf16 v[32:35], v[188:191], v[52:55], v[32:35]
    s_waitcnt lgkmcnt(1)
    buffer_load_dwordx4 v254, s[36:39], s68 offen sc1 lds
    v_add_u32 v230, s51, v230
    v_mfma_f32_16x16x32_bf16 v[28:31], v[188:191], v[56:59], v[28:31]
    v_mfma_f32_16x16x32_bf16 v[32:35], v[220:223], v[56:59], v[32:35]
    s_waitcnt lgkmcnt(0)
    v_mfma_f32_16x16x32_bf16 v[28:31], v[220:223], v[60:63], v[28:31]
    v_mov_b32 v247, v2
    s_nop 6
    v_cvt_pk_bf16_f32 v84, v28, v29
    v_cvt_pk_bf16_f32 v85, v30, v31
    v_cvt_pk_bf16_f32 v86, v32, v33
    v_cvt_pk_bf16_f32 v87, v34, v35
    v_cvt_pk_bf16_f32 v88, v36, v37
    v_cvt_pk_bf16_f32 v89, v38, v39
    v_cvt_pk_bf16_f32 v90, v40, v41
    v_cvt_pk_bf16_f32 v91, v42, v43
    s_mov_b32 s56, 7735296
    v_permlane16_swap_b32 v84, v86
    v_permlane16_swap_b32 v85, v87
    buffer_store_dwordx4 v[84:87], v92, s[36:39], s56 offen sc1
    s_mov_b32 s56, 8391680
    v_permlane16_swap_b32 v88, v90
    v_permlane16_swap_b32 v89, v91
    buffer_store_dwordx4 v[88:91], v92, s[36:39], s56 offen sc1
L_g1:
    s_waitcnt vmcnt(5)
    s_barrier
    ds_read_b64_tr_b16 v[104:105], v224 offset:0
    ds_read_b64_tr_b16 v[106:107], v224 offset:2048
    ds_read_b64_tr_b16 v[108:109], v225 offset:0
    ds_read_b64_tr_b16 v[110:111], v225 offset:2048
    ds_read_b64_tr_b16 v[112:113], v226 offset:0
    ds_read_b64_tr_b16 v[114:115], v226 offset:2048
    ds_read_b64_tr_b16 v[116:117], v227 offset:0
    ds_read_b64_tr_b16 v[118:119], v227 offset:2048
    s_waitcnt lgkmcnt(6)
    v_mfma_f32_16x16x32_bf16 v[8:11], a[0:3], v[104:107], 0
    s_add_u32 m0, m0, 4096
    ds_read_b64_tr_b16 v[120:121], v224 offset:4096
    v_mfma_f32_16x16x32_bf16 v[12:15], a[4:7], v[104:107], 0
    s_waitcnt lgkmcnt(5)
    ds_read_b64_tr_b16 v[122:123], v224 offset:6144
    v_mfma_f32_16x16x32_bf16 v[16:19], a[8:11], v[104:107], 0
    buffer_load_dwordx4 v254, s[36:39], s69 offen sc1 lds
    v_mfma_f32_16x16x32_bf16 v[28:31], a[8:11], v[108:111], 0
    s_add_u32 m0, m0, 4096
    ds_read_b64_tr_b16 v[104:105], v225 offset:4096
    v_mfma_f32_16x16x32_bf16 v[24:27], a[4:7], v[108:111], 0
    s_waitcnt lgkmcnt(5)
    ds_read_b64_tr_b16 v[106:107], v225 offset:6144
    v_mfma_f32_16x16x32_bf16 v[20:23], a[0:3], v[108:111], 0
    buffer_load_dwordx4 v254, s[36:39], s70 offen sc1 lds
    v_mfma_f32_16x16x32_bf16 v[32:35], a[0:3], v[112:115], 0
    s_add_u32 m0, m0, 4096
    ds_read_b64_tr_b16 v[108:109], v226 offset:4096
    v_mfma_f32_16x16x32_bf16 v[36:39], a[4:7], v[112:115], 0
    s_waitcnt lgkmcnt(5)
    ds_read_b64_tr_b16 v[110:111], v226 offset:6144
    v_mfma_f32_16x16x32_bf16 v[40:43], a[8:11], v[112:115], 0
    buffer_load_dwordx4 v254, s[36:39], s71 offen sc1 lds
    v_mfma_f32_16x16x32_bf16 v[52:55], a[8:11], v[116:119], 0
    s_add_u32 m0, m0, 4096
    ds_read_b64_tr_b16 v[112:113], v227 offset:4096
    v_mfma_f32_16x16x32_bf16 v[48:51], a[4:7], v[116:119], 0
    s_waitcnt lgkmcnt(5)
    ds_read_b64_tr_b16 v[114:115], v227 offset:6144
    v_mfma_f32_16x16x32_bf16 v[44:47], a[0:3], v[116:119], 0
    s_waitcnt vmcnt(5)
    s_barrier
    v_mfma_f32_16x16x32_bf16 v[8:11], a[12:15], v[120:123], v[8:11]
    ds_read_b64_tr_b16 v[116:117], v224 offset:8192
    v_mfma_f32_16x16x32_bf16 v[12:15], a[16:19], v[120:123], v[12:15]
    s_waitcnt lgkmcnt(5)
    ds_read_b64_tr_b16 v[118:119], v224 offset:10240
    v_mfma_f32_16x16x32_bf16 v[16:19], a[20:23], v[120:123], v[16:19]
    buffer_load_dwordx4 v254, s[36:39], s72 offen sc1 lds
    v_mfma_f32_16x16x32_bf16 v[28:31], a[20:23], v[104:107], v[28:31]
    s_add_u32 m0, m0, 4096
    ds_read_b64_tr_b16 v[120:121], v225 offset:8192
    v_mfma_f32_16x16x32_bf16 v[24:27], a[16:19], v[104:107], v[24:27]
    s_waitcnt lgkmcnt(5)
    ds_read_b64_tr_b16 v[122:123], v225 offset:10240
    v_mfma_f32_16x16x32_bf16 v[20:23], a[12:15], v[104:107], v[20:23]
    buffer_load_dwordx4 v254, s[36:39], s73 offen sc1 lds
    v_mfma_f32_16x16x32_bf16 v[32:35], a[12:15], v[108:111], v[32:35]
    s_add_u32 m0, m0, 4096
    ds_read_b64_tr_b16 v[104:105], v226 offset:8192
    v_mfma_f32_16x16x32_bf16 v[36:39], a[16:19], v[108:111], v[36:39]
    s_waitcnt lgkmcnt(5)
    ds_read_b64_tr_b16 v[106:107], v226 offset:10240
    v_mfma_f32_16x16x32_bf16 v[40:43], a[20:23], v[108:111], v[40:43]
    buffer_load_dwordx4 v254, s[36:39], s74 offen sc1 lds
    v_mfma_f32_16x16x32_bf16 v[52:55], a[20:23], v[112:115], v[52:55]
    s_add_u32 m0, m0, 4096
    ds_read_b64_tr_b16 v[108:109], v227 offset:8192
    v_mfma_f32_16x16x32_bf16 v[48:51], a[16:19], v[112:115], v[48:51]
    s_waitcnt lgkmcnt(5)
    ds_read_b64_tr_b16 v[110:111], v227 offset:10240
    v_mfma_f32_16x16x32_bf16 v[44:47], a[12:15], v[112:115], v[44:47]
    buffer_load_dwordx4 v254, s[36:39], s75 offen sc1 lds
    v_mfma_f32_16x16x32_bf16 v[8:11], a[24:27], v[116:119], v[8:11]
    s_add_u32 m0, m0, 4096
    ds_read_b64_tr_b16 v[112:113], v224 offset:12288
    v_mfma_f32_16x16x32_bf16 v[12:15], a[28:31], v[116:119], v[12:15]
    s_waitcnt lgkmcnt(5)
    ds_read_b64_tr_b16 v[114:115], v224 offset:14336
    v_mfma_f32_16x16x32_bf16 v[16:19], a[32:35], v[116:119], v[16:19]
    v_mfma_f32_16x16x32_bf16 v[28:31], a[32:35], v[120:123], v[28:31]
    ds_read_b64_tr_b16 v[116:117], v225 offset:12288
    v_mfma_f32_16x16x32_bf16 v[24:27], a[28:31], v[120:123], v[24:27]
    s_waitcnt lgkmcnt(5)
    ds_read_b64_tr_b16 v[118:119], v225 offset:14336
    v_mfma_f32_16x16x32_bf16 v[20:23], a[24:27], v[120:123], v[20:23]
    buffer_load_dwordx4 v254, s[36:39], s76 offen sc1 lds
    v_mfma_f32_16x16x32_bf16 v[32:35], a[24:27], v[104:107], v[32:35]
    s_add_u32 m0, m0, 4096
    ds_read_b64_tr_b16 v[120:121], v226 offset:12288
    v_mfma_f32_16x16x32_bf16 v[36:39], a[28:31], v[104:107], v[36:39]
    s_waitcnt lgkmcnt(5)
    ds_read_b64_tr_b16 v[122:123], v226 offset:14336
    v_mfma_f32_16x16x32_bf16 v[40:43], a[32:35], v[104:107], v[40:43]
L_pg4:
    s_cbranch_execz L_pg8
    buffer_load_dwordx4 v254, s[36:39], s77 offen sc1 lds
    v_mfma_f32_16x16x32_bf16 v[52:55], a[32:35], v[108:111], v[52:55]
    s_add_u32 m0, m0, 4096
    ds_read_b64_tr_b16 v[104:105], v227 offset:12288
    v_mfma_f32_16x16x32_bf16 v[48:51], a[28:31], v[108:111], v[48:51]
    s_waitcnt lgkmcnt(5)
    ds_read_b64_tr_b16 v[106:107], v227 offset:14336
    v_mfma_f32_16x16x32_bf16 v[44:47], a[24:27], v[108:111], v[44:47]
    buffer_load_dwordx4 v254, s[36:39], s78 offen sc1 lds
    v_mfma_f32_16x16x32_bf16 v[8:11], a[36:39], v[112:115], v[8:11]
    s_add_u32 m0, m0, 4096
    ds_read_b64_tr_b16 v[108:109], v224 offset:16384
    v_mfma_f32_16x16x32_bf16 v[12:15], a[40:43], v[112:115], v[12:15]
    s_waitcnt lgkmcnt(5)
    ds_read_b64_tr_b16 v[110:111], v224 offset:18432
    v_mfma_f32_16x16x32_bf16 v[16:19], a[44:47], v[112:115], v[16:19]
    buffer_load_dwordx4 v254, s[36:39], s79 offen sc1 lds
    v_mfma_f32_16x16x32_bf16 v[28:31], a[44:47], v[116:119], v[28:31]
    s_add_u32 m0, m0, 4096
    ds_read_b64_tr_b16 v[112:113], v225 offset:16384
    v_mfma_f32_16x16x32_bf16 v[24:27], a[40:43], v[116:119], v[24:27]
    s_waitcnt lgkmcnt(5)
    ds_read_b64_tr_b16 v[114:115], v225 offset:18432
    v_mfma_f32_16x16x32_bf16 v[20:23], a[36:39], v[116:119], v[20:23]
    v_mfma_f32_16x16x32_bf16 v[32:35], a[36:39], v[120:123], v[32:35]
    ds_read_b64_tr_b16 v[116:117], v226 offset:16384
    v_mfma_f32_16x16x32_bf16 v[36:39], a[40:43], v[120:123], v[36:39]
    s_waitcnt lgkmcnt(5)
    ds_read_b64_tr_b16 v[118:119], v226 offset:18432
    v_mfma_f32_16x16x32_bf16 v[40:43], a[44:47], v[120:123], v[40:43]
    buffer_load_dwordx4 v254, s[36:39], s80 offen sc1 lds
    v_mfma_f32_16x16x32_bf16 v[52:55], a[44:47], v[104:107], v[52:55]
    s_add_u32 m0, m0, 4096
    ds_read_b64_tr_b16 v[120:121], v227 offset:16384
    v_mfma_f32_16x16x32_bf16 v[48:51], a[40:43], v[104:107], v[48:51]
    s_waitcnt lgkmcnt(5)
    ds_read_b64_tr_b16 v[122:123], v227 offset:18432
    v_mfma_f32_16x16x32_bf16 v[44:47], a[36:39], v[104:107], v[44:47]
    s_waitcnt vmcnt(8)
    s_barrier
    s_add_u32 s62, s33, 12288
    buffer_atomic_add v4, v247, s[36:39], s62 offen offset:128 sc1
    v_mfma_f32_16x16x32_bf16 v[8:11], a[48:51], v[108:111], v[8:11]
    ds_read_b64_tr_b16 v[104:105], v224 offset:20480
    v_mfma_f32_16x16x32_bf16 v[12:15], a[52:55], v[108:111], v[12:15]
    s_waitcnt lgkmcnt(5)
    ds_read_b64_tr_b16 v[106:107], v224 offset:22528
    v_mfma_f32_16x16x32_bf16 v[16:19], a[56:59], v[108:111], v[16:19]
    buffer_load_dwordx4 v254, s[36:39], s81 offen sc1 lds
    v_mfma_f32_16x16x32_bf16 v[28:31], a[56:59], v[112:115], v[28:31]
    s_add_u32 m0, m0, 4096
    ds_read_b64_tr_b16 v[108:109], v225 offset:20480
    v_mfma_f32_16x16x32_bf16 v[24:27], a[52:55], v[112:115], v[24:27]
    s_waitcnt lgkmcnt(5)
    ds_read_b64_tr_b16 v[110:111], v225 offset:22528
    v_mfma_f32_16x16x32_bf16 v[20:23], a[48:51], v[112:115], v[20:23]
    buffer_load_dwordx4 v254, s[36:39], s82 offen sc1 lds
    v_mfma_f32_16x16x32_bf16 v[32:35], a[48:51], v[116:119], v[32:35]
    s_add_u32 m0, m0, 4096
    ds_read_b64_tr_b16 v[112:113], v226 offset:20480
    v_mfma_f32_16x16x32_bf16 v[36:39], a[52:55], v[116:119], v[36:39]
    s_waitcnt lgkmcnt(5)
    ds_read_b64_tr_b16 v[114:115], v226 offset:22528
    v_mfma_f32_16x16x32_bf16 v[40:43], a[56:59], v[116:119], v[40:43]
    buffer_load_dwordx4 v254, s[36:39], s83 offen sc1 lds
    v_mfma_f32_16x16x32_bf16 v[52:55], a[56:59], v[120:123], v[52:55]
    ds_read_b64_tr_b16 v[116:117], v227 offset:20480
    v_mfma_f32_16x16x32_bf16 v[48:51], a[52:55], v[120:123], v[48:51]
    s_waitcnt lgkmcnt(5)
    ds_read_b64_tr_b16 v[118:119], v227 offset:22528
    v_mfma_f32_16x16x32_bf16 v[44:47], a[48:51], v[120:123], v[44:47]
    buffer_load_dwordx4 a[180:183], v252, s[36:39], s75 offen offset:1024 sc1
    v_mfma_f32_16x16x32_bf16 v[8:11], a[60:63], v[104:107], v[8:11]
    ds_read_b64_tr_b16 v[120:121], v224 offset:24576
    v_mfma_f32_16x16x32_bf16 v[12:15], a[64:67], v[104:107], v[12:15]
    s_waitcnt lgkmcnt(5)
    ds_read_b64_tr_b16 v[122:123], v224 offset:26624
    v_mfma_f32_16x16x32_bf16 v[16:19], a[68:71], v[104:107], v[16:19]
    buffer_load_dwordx4 a[184:187], v252, s[36:39], s75 offen offset:2048 sc1
    v_mfma_f32_16x16x32_bf16 v[28:31], a[68:71], v[108:111], v[28:31]
    ds_read_b64_tr_b16 v[104:105], v225 offset:24576
    v_mfma_f32_16x16x32_bf16 v[24:27], a[64:67], v[108:111], v[24:27]
    s_waitcnt lgkmcnt(5)
    ds_read_b64_tr_b16 v[106:107], v225 offset:26624
    v_mfma_f32_16x16x32_bf16 v[20:23], a[60:63], v[108:111], v[20:23]
    v_mfma_f32_16x16x32_bf16 v[32:35], a[60:63], v[112:115], v[32:35]
    ds_read_b64_tr_b16 v[108:109], v226 offset:24576
    v_mfma_f32_16x16x32_bf16 v[36:39], a[64:67], v[112:115], v[36:39]
    s_waitcnt lgkmcnt(5)
    ds_read_b64_tr_b16 v[110:111], v226 offset:26624
    v_mfma_f32_16x16x32_bf16 v[40:43], a[68:71], v[112:115], v[40:43]
    buffer_load_dwordx4 a[188:191], v252, s[36:39], s75 offen offset:3072 sc1
    v_mfma_f32_16x16x32_bf16 v[52:55], a[68:71], v[116:119], v[52:55]
    ds_read_b64_tr_b16 v[112:113], v227 offset:24576
    v_mfma_f32_16x16x32_bf16 v[48:51], a[64:67], v[116:119], v[48:51]
    s_waitcnt lgkmcnt(5)
    ds_read_b64_tr_b16 v[114:115], v227 offset:26624
    v_mfma_f32_16x16x32_bf16 v[44:47], a[60:63], v[116:119], v[44:47]
    buffer_load_dwordx4 a[192:195], v252, s[36:39], s76 offen offset:0 sc1
    v_mfma_f32_16x16x32_bf16 v[8:11], a[72:75], v[120:123], v[8:11]
    ds_read_b64_tr_b16 v[116:117], v224 offset:28672
    v_mfma_f32_16x16x32_bf16 v[12:15], a[76:79], v[120:123], v[12:15]
    s_waitcnt lgkmcnt(5)
    ds_read_b64_tr_b16 v[118:119], v224 offset:30720
    v_mfma_f32_16x16x32_bf16 v[16:19], a[80:83], v[120:123], v[16:19]
    buffer_load_dwordx4 a[196:199], v252, s[36:39], s76 offen offset:1024 sc1
    v_mfma_f32_16x16x32_bf16 v[28:31], a[80:83], v[104:107], v[28:31]
    ds_read_b64_tr_b16 v[120:121], v225 offset:28672
    v_mfma_f32_16x16x32_bf16 v[24:27], a[76:79], v[104:107], v[24:27]
    s_waitcnt lgkmcnt(5)
    ds_read_b64_tr_b16 v[122:123], v225 offset:30720
    v_mfma_f32_16x16x32_bf16 v[20:23], a[72:75], v[104:107], v[20:23]
    v_mfma_f32_16x16x32_bf16 v[32:35], a[72:75], v[108:111], v[32:35]
    ds_read_b64_tr_b16 v[104:105], v226 offset:28672
    v_mfma_f32_16x16x32_bf16 v[36:39], a[76:79], v[108:111], v[36:39]
    s_waitcnt lgkmcnt(5)
    ds_read_b64_tr_b16 v[106:107], v226 offset:30720
    v_mfma_f32_16x16x32_bf16 v[40:43], a[80:83], v[108:111], v[40:43]
    buffer_load_dwordx4 a[200:203], v252, s[36:39], s76 offen offset:2048 sc1
    v_mfma_f32_16x16x32_bf16 v[52:55], a[80:83], v[112:115], v[52:55]
    ds_read_b64_tr_b16 v[108:109], v227 offset:28672
    v_mfma_f32_16x16x32_bf16 v[48:51], a[76:79], v[112:115], v[48:51]
    s_waitcnt lgkmcnt(5)
    ds_read_b64_tr_b16 v[110:111], v227 offset:30720
    v_mfma_f32_16x16x32_bf16 v[44:47], a[72:75], v[112:115], v[44:47]
    v_mov_b32 v204, s53
    v_mov_b32 v205, s53
    v_mov_b32 v206, s53
    v_mfma_f32_16x16x32_bf16 v[8:11], a[84:87], v[116:119], v[8:11]
    ds_read_b64_tr_b16 v[112:113], v224 offset:32768
    v_mov_b32 v207, s53
    s_mov_b32 s4, 0xaaaaaaaa
    v_mfma_f32_16x16x32_bf16 v[12:15], a[88:91], v[116:119], v[12:15]
    s_waitcnt lgkmcnt(5)
    ds_read_b64_tr_b16 v[114:115], v224 offset:34816
    s_mov_b32 s5, 0xaaaaaaaa
    v_mfma_f32_16x16x32_bf16 v[16:19], a[92:95], v[116:119], v[16:19]
    s_mov_b32 s6, 0xcccccccc
    s_mov_b32 s7, 0xcccccccc
    v_mfma_f32_16x16x32_bf16 v[28:31], a[92:95], v[120:123], v[28:31]
    ds_read_b64_tr_b16 v[116:117], v225 offset:32768
    v_mfma_f32_16x16x32_bf16 v[24:27], a[88:91], v[120:123], v[24:27]
    s_waitcnt lgkmcnt(5)
    ds_read_b64_tr_b16 v[118:119], v225 offset:34816
    v_mfma_f32_16x16x32_bf16 v[20:23], a[84:87], v[120:123], v[20:23]
    buffer_load_dwordx4 a[204:207], v252, s[36:39], s76 offen offset:3072 sc1
    v_mfma_f32_16x16x32_bf16 v[32:35], a[84:87], v[104:107], v[32:35]
    ds_read_b64_tr_b16 v[120:121], v226 offset:32768
    v_mfma_f32_16x16x32_bf16 v[36:39], a[88:91], v[104:107], v[36:39]
    s_waitcnt lgkmcnt(5)
    ds_read_b64_tr_b16 v[122:123], v226 offset:34816
    v_mfma_f32_16x16x32_bf16 v[40:43], a[92:95], v[104:107], v[40:43]
    buffer_load_dwordx4 a[208:211], v252, s[36:39], s77 offen offset:0 sc1
    v_mfma_f32_16x16x32_bf16 v[52:55], a[92:95], v[108:111], v[52:55]
    ds_read_b64_tr_b16 v[104:105], v227 offset:32768
    v_mfma_f32_16x16x32_bf16 v[48:51], a[88:91], v[108:111], v[48:51]
    s_waitcnt lgkmcnt(5)
    ds_read_b64_tr_b16 v[106:107], v227 offset:34816
    v_mfma_f32_16x16x32_bf16 v[44:47], a[84:87], v[108:111], v[44:47]
    s_waitcnt vmcnt(8)
    s_barrier
    v_mfma_f32_16x16x32_bf16 v[8:11], a[96:99], v[112:115], v[8:11]
    ds_read_b64_tr_b16 v[108:109], v224 offset:36864
    ds_read_b64_tr_b16 v[184:185], v244 offset:0
    v_mfma_f32_16x16x32_bf16 v[12:15], a[100:103], v[112:115], v[12:15]
    s_waitcnt lgkmcnt(6)
    ds_read_b64_tr_b16 v[110:111], v224 offset:38912
    ds_read_b64_tr_b16 v[186:187], v244 offset:2048
    v_mfma_f32_16x16x32_bf16 v[16:19], a[104:107], v[112:115], v[16:19]
    ds_read_b64_tr_b16 v[188:189], v244 offset:4096
    ds_read_b64_tr_b16 v[190:191], v244 offset:6144
    v_mfma_f32_16x16x32_bf16 v[28:31], a[104:107], v[116:119], v[28:31]
    ds_read_b64_tr_b16 v[112:113], v225 offset:36864
    ds_read_b64_tr_b16 v[192:193], v244 offset:8192
    v_mfma_f32_16x16x32_bf16 v[24:27], a[100:103], v[116:119], v[24:27]
    s_waitcnt lgkmcnt(10)
    ds_read_b64_tr_b16 v[114:115], v225 offset:38912
    ds_read_b64_tr_b16 v[194:195], v244 offset:10240
    v_mfma_f32_16x16x32_bf16 v[20:23], a[96:99], v[116:119], v[20:23]
    s_mov_b32 s32, 12288
    buffer_load_dword v5, v3, s[36:39], s32 offen offset:128 sc1
    ds_read_b64_tr_b16 v[196:197], v244 offset:12288
    v_mfma_f32_16x16x32_bf16 v[32:35], a[96:99], v[120:123], v[32:35]
    ds_read_b64_tr_b16 v[116:117], v226 offset:36864
    ds_read_b64_tr_b16 v[198:199], v244 offset:14336
    v_mfma_f32_16x16x32_bf16 v[36:39], a[100:103], v[120:123], v[36:39]
    s_waitcnt lgkmcnt(13)
    ds_read_b64_tr_b16 v[118:119], v226 offset:38912
    ds_read_b64_tr_b16 v[200:201], v244 offset:16384
    v_mfma_f32_16x16x32_bf16 v[40:43], a[104:107], v[120:123], v[40:43]
    ds_read_b64_tr_b16 v[202:203], v244 offset:18432
    v_mfma_f32_16x16x32_bf16 v[52:55], a[104:107], v[104:107], v[52:55]
    ds_read_b64_tr_b16 v[120:121], v227 offset:36864
    v_mfma_f32_16x16x32_bf16 v[48:51], a[100:103], v[104:107], v[48:51]
    s_waitcnt lgkmcnt(14)
    ds_read_b64_tr_b16 v[122:123], v227 offset:38912
    v_mfma_f32_16x16x32_bf16 v[44:47], a[96:99], v[104:107], v[44:47]
    buffer_load_dwordx4 a[212:215], v252, s[36:39], s77 offen offset:1024 sc1
    v_mfma_f32_16x16x32_bf16 v[8:11], a[108:111], v[108:111], v[8:11]
    ds_read_b64_tr_b16 v[104:105], v224 offset:40960
    v_mfma_f32_16x16x32_bf16 v[12:15], a[112:115], v[108:111], v[12:15]
    s_waitcnt lgkmcnt(10)
    ds_read_b64_tr_b16 v[106:107], v224 offset:43008
    v_mfma_f32_16x16x32_bf16 v[16:19], a[116:119], v[108:111], v[16:19]
    buffer_load_dwordx4 a[216:219], v252, s[36:39], s77 offen offset:2048 sc1
    v_mfma_f32_16x16x32_bf16 v[28:31], a[116:119], v[112:115], v[28:31]
    ds_read_b64_tr_b16 v[108:109], v225 offset:40960
    v_mfma_f32_16x16x32_bf16 v[24:27], a[112:115], v[112:115], v[24:27]
    s_waitcnt lgkmcnt(7)
    ds_read_b64_tr_b16 v[110:111], v225 offset:43008
    v_mfma_f32_16x16x32_bf16 v[20:23], a[108:111], v[112:115], v[20:23]
    buffer_load_dwordx4 a[220:223], v252, s[36:39], s77 offen offset:3072 sc1
    v_mfma_f32_16x16x32_bf16 v[32:35], a[108:111], v[116:119], v[32:35]
    ds_read_b64_tr_b16 v[112:113], v226 offset:40960
    v_mfma_f32_16x16x32_bf16 v[36:39], a[112:115], v[116:119], v[36:39]
    s_waitcnt lgkmcnt(5)
    ds_read_b64_tr_b16 v[114:115], v226 offset:43008
    v_mfma_f32_16x16x32_bf16 v[40:43], a[116:119], v[116:119], v[40:43]
    buffer_load_dwordx4 a[224:227], v252, s[36:39], s78 offen offset:0 sc1
    v_mfma_f32_16x16x32_bf16 v[208:211], v[184:187], v[184:187], 0
    buffer_load_dwordx4 a[228:231], v252, s[36:39], s78 offen offset:1024 sc1
    v_mfma_f32_16x16x32_bf16 v[212:215], v[204:207], v[184:187], 0
    ds_read_b64_tr_b16 v[124:125], v228
    v_mfma_f32_16x16x32_bf16 v[208:211], v[188:191], v[188:191], v[208:211]
    ds_read_b64_tr_b16 v[126:127], v229
    v_mfma_f32_16x16x32_bf16 v[212:215], v[204:207], v[188:191], v[212:215]
    ds_read_b64_tr_b16 v[128:129], v230
    v_mfma_f32_16x16x32_bf16 v[208:211], v[192:195], v[192:195], v[208:211]
    buffer_load_dwordx4 a[232:235], v252, s[36:39], s78 offen offset:2048 sc1
    v_mfma_f32_16x16x32_bf16 v[212:215], v[204:207], v[192:195], v[212:215]
    v_mfma_f32_16x16x32_bf16 v[208:211], v[196:199], v[196:199], v[208:211]
    v_mfma_f32_16x16x32_bf16 v[212:215], v[204:207], v[196:199], v[212:215]
    v_mfma_f32_16x16x32_bf16 v[208:211], v[200:203], v[200:203], v[208:211]
    buffer_load_dwordx4 a[236:239], v252, s[36:39], s78 offen offset:3072 sc1
    v_mfma_f32_16x16x32_bf16 v[212:215], v[204:207], v[200:203], v[212:215]
    v_mfma_f32_16x16x32_bf16 v[52:55], a[116:119], v[120:123], v[52:55]
    ds_read_b64_tr_b16 v[116:117], v227 offset:40960
    v_mfma_f32_16x16x32_bf16 v[48:51], a[112:115], v[120:123], v[48:51]
    s_waitcnt lgkmcnt(8)
    ds_read_b64_tr_b16 v[118:119], v227 offset:43008
    v_mfma_f32_16x16x32_bf16 v[44:47], a[108:111], v[120:123], v[44:47]
    v_mfma_f32_16x16x32_bf16 v[8:11], a[120:123], v[104:107], v[8:11]
    ds_read_b64_tr_b16 v[120:121], v224 offset:45056
    v_cndmask_b32 v208, v208, v209, s[4:5]
    v_cndmask_b32 v210, v210, v211, s[4:5]
    v_mfma_f32_16x16x32_bf16 v[12:15], a[124:127], v[104:107], v[12:15]
    s_waitcnt lgkmcnt(8)
    ds_read_b64_tr_b16 v[122:123], v224 offset:47104
    v_cndmask_b32 v208, v208, v210, s[6:7]
    v_or_b32 v213, 0x80000000, v208
    v_mfma_f32_16x16x32_bf16 v[16:19], a[128:131], v[104:107], v[16:19]
    buffer_store_dwordx4 v[212:215], v243, s[36:39], s64 offen sc1
    v_mfma_f32_16x16x32_bf16 v[28:31], a[128:131], v[108:111], v[28:31]
    ds_read_b64_tr_b16 v[104:105], v225 offset:45056
    v_mfma_f32_16x16x32_bf16 v[24:27], a[124:127], v[108:111], v[24:27]
    s_waitcnt lgkmcnt(8)
    ds_read_b64_tr_b16 v[106:107], v225 offset:47104
    v_mfma_f32_16x16x32_bf16 v[20:23], a[120:123], v[108:111], v[20:23]
    v_mfma_f32_16x16x32_bf16 v[32:35], a[120:123], v[112:115], v[32:35]
    ds_read_b64_tr_b16 v[108:109], v226 offset:45056
    v_mfma_f32_16x16x32_bf16 v[36:39], a[124:127], v[112:115], v[36:39]
    s_waitcnt lgkmcnt(5)
    ds_read_b64_tr_b16 v[110:111], v226 offset:47104
    v_mfma_f32_16x16x32_bf16 v[40:43], a[128:131], v[112:115], v[40:43]
    v_mfma_f32_16x16x32_bf16 v[52:55], a[128:131], v[116:119], v[52:55]
    ds_read_b64_tr_b16 v[112:113], v227 offset:45056
    v_mfma_f32_16x16x32_bf16 v[48:51], a[124:127], v[116:119], v[48:51]
    s_waitcnt lgkmcnt(5)
    ds_read_b64_tr_b16 v[114:115], v227 offset:47104
    v_mfma_f32_16x16x32_bf16 v[44:47], a[120:123], v[116:119], v[44:47]
    v_mfma_f32_16x16x32_bf16 v[8:11], a[132:135], v[120:123], v[8:11]
    ds_read_b64_tr_b16 v[116:117], v224 offset:49152
    v_mfma_f32_16x16x32_bf16 v[12:15], a[136:139], v[120:123], v[12:15]
    s_waitcnt lgkmcnt(5)
    ds_read_b64_tr_b16 v[118:119], v224 offset:51200
    v_mfma_f32_16x16x32_bf16 v[16:19], a[140:143], v[120:123], v[16:19]
    v_mfma_f32_16x16x32_bf16 v[28:31], a[140:143], v[104:107], v[28:31]
    ds_read_b64_tr_b16 v[120:121], v225 offset:49152
    v_mfma_f32_16x16x32_bf16 v[24:27], a[136:139], v[104:107], v[24:27]
    s_waitcnt lgkmcnt(5)
    ds_read_b64_tr_b16 v[122:123], v225 offset:51200
    v_mfma_f32_16x16x32_bf16 v[20:23], a[132:135], v[104:107], v[20:23]
    v_mfma_f32_16x16x32_bf16 v[32:35], a[132:135], v[108:111], v[32:35]
    ds_read_b64_tr_b16 v[104:105], v226 offset:49152
    v_mfma_f32_16x16x32_bf16 v[36:39], a[136:139], v[108:111], v[36:39]
    s_waitcnt lgkmcnt(5)
    ds_read_b64_tr_b16 v[106:107], v226 offset:51200
    v_mfma_f32_16x16x32_bf16 v[40:43], a[140:143], v[108:111], v[40:43]
    v_mfma_f32_16x16x32_bf16 v[52:55], a[140:143], v[112:115], v[52:55]
    ds_read_b64_tr_b16 v[108:109], v227 offset:49152
    v_mfma_f32_16x16x32_bf16 v[48:51], a[136:139], v[112:115], v[48:51]
    s_waitcnt lgkmcnt(5)
    ds_read_b64_tr_b16 v[110:111], v227 offset:51200
    v_mfma_f32_16x16x32_bf16 v[44:47], a[132:135], v[112:115], v[44:47]
    s_waitcnt vmcnt(8)
    v_cmp_gt_u32 vcc, 16, v5
    s_nop 0
    s_and_b64 vcc, vcc, s[58:59]
    s_cbranch_scc1 L_spin_23
L_back_24:
    s_barrier
    v_mfma_f32_16x16x32_bf16 v[8:11], a[144:147], v[116:119], v[8:11]
    ds_read_b64_tr_b16 v[112:113], v224 offset:53248
    v_mfma_f32_16x16x32_bf16 v[12:15], a[148:151], v[116:119], v[12:15]
    s_waitcnt lgkmcnt(5)
    ds_read_b64_tr_b16 v[114:115], v224 offset:55296
    v_mfma_f32_16x16x32_bf16 v[16:19], a[152:155], v[116:119], v[16:19]
    buffer_load_dwordx4 v[136:139], v231, s[36:39], s12 offen offset:0 sc1
    v_mfma_f32_16x16x32_bf16 v[28:31], a[152:155], v[120:123], v[28:31]
    ds_read_b64_tr_b16 v[116:117], v225 offset:53248
    v_mfma_f32_16x16x32_bf16 v[24:27], a[148:151], v[120:123], v[24:27]
    s_waitcnt lgkmcnt(5)
    ds_read_b64_tr_b16 v[118:119], v225 offset:55296
    v_mfma_f32_16x16x32_bf16 v[20:23], a[144:147], v[120:123], v[20:23]
    buffer_load_dwordx4 v[140:143], v231, s[36:39], s12 offen offset:256 sc1
    v_mfma_f32_16x16x32_bf16 v[32:35], a[144:147], v[104:107], v[32:35]
    ds_read_b64_tr_b16 v[120:121], v226 offset:53248
    v_mfma_f32_16x16x32_bf16 v[36:39], a[148:151], v[104:107], v[36:39]
    s_waitcnt lgkmcnt(5)
    ds_read_b64_tr_b16 v[122:123], v226 offset:55296
    v_mfma_f32_16x16x32_bf16 v[40:43], a[152:155], v[104:107], v[40:43]
    v_mfma_f32_16x16x32_bf16 v[52:55], a[152:155], v[108:111], v[52:55]
    ds_read_b64_tr_b16 v[104:105], v227 offset:53248
    v_mfma_f32_16x16x32_bf16 v[48:51], a[148:151], v[108:111], v[48:51]
    s_waitcnt lgkmcnt(5)
    ds_read_b64_tr_b16 v[106:107], v227 offset:55296
    v_mfma_f32_16x16x32_bf16 v[44:47], a[144:147], v[108:111], v[44:47]
    buffer_load_dwordx4 v[144:147], v231, s[36:39], s12 offen offset:512 sc1
    v_mfma_f32_16x16x32_bf16 v[8:11], a[156:159], v[112:115], v[8:11]
    ds_read_b64_tr_b16 v[108:109], v224 offset:57344
    v_add_u32 v254, 1312768, v254
    v_mfma_f32_16x16x32_bf16 v[12:15], a[160:163], v[112:115], v[12:15]
    s_waitcnt lgkmcnt(5)
    ds_read_b64_tr_b16 v[110:111], v224 offset:59392
    v_mfma_f32_16x16x32_bf16 v[16:19], a[164:167], v[112:115], v[16:19]
    s_add_u32 m0, m0, 4096
    s_nop 0
    buffer_load_dwordx4 v254, s[36:39], s64 offen sc1 lds
    v_mfma_f32_16x16x32_bf16 v[28:31], a[164:167], v[116:119], v[28:31]
    s_add_u32 m0, m0, 4096
    ds_read_b64_tr_b16 v[112:113], v225 offset:57344
    v_mfma_f32_16x16x32_bf16 v[24:27], a[160:163], v[116:119], v[24:27]
    s_waitcnt lgkmcnt(5)
    ds_read_b64_tr_b16 v[114:115], v225 offset:59392
    v_mfma_f32_16x16x32_bf16 v[20:23], a[156:159], v[116:119], v[20:23]
    buffer_load_dwordx2 v[164:165], v235, s[36:39], s3 offen offset:0 sc1
    v_mfma_f32_16x16x32_bf16 v[32:35], a[156:159], v[120:123], v[32:35]
    ds_read_b64_tr_b16 v[116:117], v226 offset:57344
    v_mfma_f32_16x16x32_bf16 v[36:39], a[160:163], v[120:123], v[36:39]
    s_waitcnt lgkmcnt(5)
    ds_read_b64_tr_b16 v[118:119], v226 offset:59392
    v_mfma_f32_16x16x32_bf16 v[40:43], a[164:167], v[120:123], v[40:43]
    buffer_load_dwordx2 v[166:167], v235, s[36:39], s3 offen offset:256 sc1
    v_mfma_f32_16x16x32_bf16 v[52:55], a[164:167], v[104:107], v[52:55]
    ds_read_b64_tr_b16 v[120:121], v227 offset:57344
    v_mfma_f32_16x16x32_bf16 v[48:51], a[160:163], v[104:107], v[48:51]
    s_waitcnt lgkmcnt(5)
    ds_read_b64_tr_b16 v[122:123], v227 offset:59392
    v_mfma_f32_16x16x32_bf16 v[44:47], a[156:159], v[104:107], v[44:47]
    buffer_load_dwordx2 v[168:169], v235, s[36:39], s3 offen offset:512 sc1
    v_mfma_f32_16x16x32_bf16 v[8:11], a[168:171], v[108:111], v[8:11]
    ds_read_b64_tr_b16 v[104:105], v224 offset:61440
    v_mfma_f32_16x16x32_bf16 v[12:15], a[172:175], v[108:111], v[12:15]
    s_waitcnt lgkmcnt(5)
    ds_read_b64_tr_b16 v[106:107], v224 offset:63488
    v_mfma_f32_16x16x32_bf16 v[16:19], a[176:179], v[108:111], v[16:19]
    buffer_load_dwordx2 v[170:171], v235, s[36:39], s3 offen offset:768 sc1
    v_mfma_f32_16x16x32_bf16 v[28:31], a[176:179], v[112:115], v[28:31]
    ds_read_b64_tr_b16 v[108:109], v225 offset:61440
    v_mfma_f32_16x16x32_bf16 v[24:27], a[172:175], v[112:115], v[24:27]
    s_waitcnt lgkmcnt(5)
    ds_read_b64_tr_b16 v[110:111], v225 offset:63488
    v_mfma_f32_16x16x32_bf16 v[20:23], a[168:171], v[112:115], v[20:23]
    buffer_load_dwordx4 v254, s[36:39], s65 offen sc1 lds
    v_mfma_f32_16x16x32_bf16 v[32:35], a[168:171], v[116:119], v[32:35]
    s_add_u32 m0, m0, 4096
    ds_read_b64_tr_b16 v[112:113], v226 offset:61440
    v_mfma_f32_16x16x32_bf16 v[36:39], a[172:175], v[116:119], v[36:39]
    s_waitcnt lgkmcnt(5)
    ds_read_b64_tr_b16 v[114:115], v226 offset:63488
    v_mfma_f32_16x16x32_bf16 v[40:43], a[176:179], v[116:119], v[40:43]
    buffer_load_dwordx4 v254, s[36:39], s66 offen sc1 lds
    v_mfma_f32_16x16x32_bf16 v[52:55], a[176:179], v[120:123], v[52:55]
    s_add_u32 m0, m0, 4096
    ds_read_b64_tr_b16 v[116:117], v227 offset:61440
    v_mfma_f32_16x16x32_bf16 v[48:51], a[172:175], v[120:123], v[48:51]
    s_waitcnt lgkmcnt(5)
    ds_read_b64_tr_b16 v[118:119], v227 offset:63488
    v_add_u32 v224, 0x10000, v224
    v_mfma_f32_16x16x32_bf16 v[44:47], a[168:171], v[120:123], v[44:47]
    buffer_load_dwordx4 v254, s[36:39], s67 offen sc1 lds
    v_mfma_f32_16x16x32_bf16 v[8:11], a[180:183], v[104:107], v[8:11]
    s_add_u32 m0, m0, 4096
    ds_read_b64_tr_b16 v[120:121], v224 offset:0
    v_mfma_f32_16x16x32_bf16 v[12:15], a[184:187], v[104:107], v[12:15]
    s_waitcnt lgkmcnt(5)
    ds_read_b64_tr_b16 v[122:123], v224 offset:2048
    v_add_u32 v225, 0x10000, v225
    v_mfma_f32_16x16x32_bf16 v[16:19], a[188:191], v[104:107], v[16:19]
    buffer_load_dwordx4 v254, s[36:39], s68 offen sc1 lds
    v_mfma_f32_16x16x32_bf16 v[28:31], a[188:191], v[108:111], v[28:31]
    s_add_u32 m0, m0, 4096
    ds_read_b64_tr_b16 v[104:105], v225 offset:0
    v_mfma_f32_16x16x32_bf16 v[24:27], a[184:187], v[108:111], v[24:27]
    s_waitcnt lgkmcnt(5)
    ds_read_b64_tr_b16 v[106:107], v225 offset:2048
    v_add_u32 v226, 0x10000, v226
    v_mfma_f32_16x16x32_bf16 v[20:23], a[180:183], v[108:111], v[20:23]
    s_waitcnt vmcnt(11)
    v_add_f32_dpp v136, v136, v136 row_ror:1 row_mask:0xf bank_mask:0xf
    v_add_f32_dpp v137, v137, v137 row_ror:1 row_mask:0xf bank_mask:0xf
    v_add_f32_dpp v138, v138, v138 row_ror:1 row_mask:0xf bank_mask:0xf
    v_mfma_f32_16x16x32_bf16 v[32:35], a[180:183], v[112:115], v[32:35]
    ds_read_b64_tr_b16 v[108:109], v226 offset:0
    v_add_f32_dpp v139, v139, v139 row_ror:1 row_mask:0xf bank_mask:0xf
    s_waitcnt vmcnt(10)
    v_add_f32_dpp v140, v140, v140 row_ror:1 row_mask:0xf bank_mask:0xf
    v_mfma_f32_16x16x32_bf16 v[36:39], a[184:187], v[112:115], v[36:39]
    s_waitcnt lgkmcnt(5)
    ds_read_b64_tr_b16 v[110:111], v226 offset:2048
    v_add_u32 v227, 0x10000, v227
    v_add_f32_dpp v141, v141, v141 row_ror:1 row_mask:0xf bank_mask:0xf
    v_mfma_f32_16x16x32_bf16 v[40:43], a[188:191], v[112:115], v[40:43]
    buffer_load_dwordx4 v254, s[36:39], s69 offen sc1 lds
    v_add_f32_dpp v142, v142, v142 row_ror:1 row_mask:0xf bank_mask:0xf
    v_mfma_f32_16x16x32_bf16 v[52:55], a[188:191], v[116:119], v[52:55]
    s_add_u32 m0, m0, 4096
    ds_read_b64_tr_b16 v[112:113], v227 offset:0
    v_add_f32_dpp v143, v143, v143 row_ror:1 row_mask:0xf bank_mask:0xf
    s_waitcnt vmcnt(10)
    v_add_f32_dpp v144, v144, v144 row_ror:1 row_mask:0xf bank_mask:0xf
    v_mfma_f32_16x16x32_bf16 v[48:51], a[184:187], v[116:119], v[48:51]
    s_waitcnt lgkmcnt(5)
    ds_read_b64_tr_b16 v[114:115], v227 offset:2048
    v_add_f32_dpp v145, v145, v145 row_ror:1 row_mask:0xf bank_mask:0xf
    v_add_f32_dpp v146, v146, v146 row_ror:1 row_mask:0xf bank_mask:0xf
    v_mfma_f32_16x16x32_bf16 v[44:47], a[180:183], v[116:119], v[44:47]
    buffer_load_dwordx4 v254, s[36:39], s70 offen sc1 lds
    v_add_f32_dpp v147, v147, v147 row_ror:1 row_mask:0xf bank_mask:0xf
    v_mfma_f32_16x16x32_bf16 v[8:11], a[192:195], v[120:123], v[8:11]
    s_add_u32 m0, m0, 4096
    ds_read_b64_tr_b16 v[116:117], v224 offset:4096
    v_add_f32_dpp v136, v136, v136 row_ror:2 row_mask:0xf bank_mask:0xf
    v_add_f32_dpp v137, v137, v137 row_ror:2 row_mask:0xf bank_mask:0xf
    v_mfma_f32_16x16x32_bf16 v[12:15], a[196:199], v[120:123], v[12:15]
    s_waitcnt lgkmcnt(5)
    ds_read_b64_tr_b16 v[118:119], v224 offset:6144
    v_add_f32_dpp v138, v138, v138 row_ror:2 row_mask:0xf bank_mask:0xf
    v_add_f32_dpp v139, v139, v139 row_ror:2 row_mask:0xf bank_mask:0xf
    v_mfma_f32_16x16x32_bf16 v[16:19], a[200:203], v[120:123], v[16:19]
    v_add_f32_dpp v140, v140, v140 row_ror:2 row_mask:0xf bank_mask:0xf
    v_add_f32_dpp v141, v141, v141 row_ror:2 row_mask:0xf bank_mask:0xf
    v_add_f32_dpp v142, v142, v142 row_ror:2 row_mask:0xf bank_mask:0xf
    v_mfma_f32_16x16x32_bf16 v[28:31], a[200:203], v[104:107], v[28:31]
    ds_read_b64_tr_b16 v[120:121], v225 offset:4096
    v_add_f32_dpp v143, v143, v143 row_ror:2 row_mask:0xf bank_mask:0xf
    v_add_f32_dpp v144, v144, v144 row_ror:2 row_mask:0xf bank_mask:0xf
    v_mfma_f32_16x16x32_bf16 v[24:27], a[196:199], v[104:107], v[24:27]
    s_waitcnt lgkmcnt(5)
    ds_read_b64_tr_b16 v[122:123], v225 offset:6144
    v_add_f32_dpp v145, v145, v145 row_ror:2 row_mask:0xf bank_mask:0xf
    v_add_f32_dpp v146, v146, v146 row_ror:2 row_mask:0xf bank_mask:0xf
    v_mfma_f32_16x16x32_bf16 v[20:23], a[192:195], v[104:107], v[20:23]
    buffer_load_dwordx4 v254, s[36:39], s71 offen sc1 lds
    v_add_f32_dpp v147, v147, v147 row_ror:2 row_mask:0xf bank_mask:0xf
    v_mfma_f32_16x16x32_bf16 v[32:35], a[192:195], v[108:111], v[32:35]
    s_add_u32 m0, m0, 4096
    ds_read_b64_tr_b16 v[104:105], v226 offset:4096
    v_add_f32_dpp v136, v136, v136 row_ror:4 row_mask:0xf bank_mask:0xf
    v_add_f32_dpp v137, v137, v137 row_ror:4 row_mask:0xf bank_mask:0xf
    v_mfma_f32_16x16x32_bf16 v[36:39], a[196:199], v[108:111], v[36:39]
    s_waitcnt lgkmcnt(5)
    ds_read_b64_tr_b16 v[106:107], v226 offset:6144
    v_add_f32_dpp v138, v138, v138 row_ror:4 row_mask:0xf bank_mask:0xf
    v_add_f32_dpp v139, v139, v139 row_ror:4 row_mask:0xf bank_mask:0xf
    v_mfma_f32_16x16x32_bf16 v[40:43], a[200:203], v[108:111], v[40:43]
    buffer_load_dwordx4 v254, s[36:39], s72 offen sc1 lds
    v_add_f32_dpp v140, v140, v140 row_ror:4 row_mask:0xf bank_mask:0xf
    v_mfma_f32_16x16x32_bf16 v[52:55], a[200:203], v[112:115], v[52:55]
    s_add_u32 m0, m0, 4096
    ds_read_b64_tr_b16 v[108:109], v227 offset:4096
    v_add_f32_dpp v141, v141, v141 row_ror:4 row_mask:0xf bank_mask:0xf
    v_add_f32_dpp v142, v142, v142 row_ror:4 row_mask:0xf bank_mask:0xf
    v_mfma_f32_16x16x32_bf16 v[48:51], a[196:199], v[112:115], v[48:51]
    s_waitcnt lgkmcnt(5)
    ds_read_b64_tr_b16 v[110:111], v227 offset:6144
    v_add_f32_dpp v143, v143, v143 row_ror:4 row_mask:0xf bank_mask:0xf
    v_add_f32_dpp v144, v144, v144 row_ror:4 row_mask:0xf bank_mask:0xf
    v_mfma_f32_16x16x32_bf16 v[44:47], a[192:195], v[112:115], v[44:47]
    v_add_f32_dpp v145, v145, v145 row_ror:4 row_mask:0xf bank_mask:0xf
    v_add_f32_dpp v146, v146, v146 row_ror:4 row_mask:0xf bank_mask:0xf
    v_add_f32_dpp v147, v147, v147 row_ror:4 row_mask:0xf bank_mask:0xf
    v_mfma_f32_16x16x32_bf16 v[8:11], a[204:207], v[116:119], v[8:11]
    ds_read_b64_tr_b16 v[112:113], v224 offset:8192
    v_mfma_f32_16x16x32_bf16 v[12:15], a[208:211], v[116:119], v[12:15]
    s_waitcnt lgkmcnt(5)
    ds_read_b64_tr_b16 v[114:115], v224 offset:10240
    v_mfma_f32_16x16x32_bf16 v[16:19], a[212:215], v[116:119], v[16:19]
    buffer_load_dwordx4 v254, s[36:39], s73 offen sc1 lds
    v_mfma_f32_16x16x32_bf16 v[28:31], a[212:215], v[120:123], v[28:31]
    s_add_u32 m0, m0, 4096
    ds_read_b64_tr_b16 v[116:117], v225 offset:8192
    v_mfma_f32_16x16x32_bf16 v[24:27], a[208:211], v[120:123], v[24:27]
    s_waitcnt lgkmcnt(5)
    ds_read_b64_tr_b16 v[118:119], v225 offset:10240
    v_mfma_f32_16x16x32_bf16 v[20:23], a[204:207], v[120:123], v[20:23]
    buffer_load_dwordx4 v254, s[36:39], s74 offen sc1 lds
    v_mfma_f32_16x16x32_bf16 v[32:35], a[204:207], v[104:107], v[32:35]
    s_add_u32 m0, m0, 4096
    ds_read_b64_tr_b16 v[120:121], v226 offset:8192
    v_mfma_f32_16x16x32_bf16 v[36:39], a[208:211], v[104:107], v[36:39]
    s_waitcnt lgkmcnt(5)
    ds_read_b64_tr_b16 v[122:123], v226 offset:10240
    v_mfma_f32_16x16x32_bf16 v[40:43], a[212:215], v[104:107], v[40:43]
    s_waitcnt vmcnt(12)
    v_and_b32 v162, v165, v167
    s_waitcnt vmcnt(10)
    v_and_b32 v163, v169, v171
    v_and_b32 v162, v162, v163
    v_cmp_le_i32 vcc, 0, v162
    s_nop 0
    s_cmp_lg_u64 vcc, 0
    s_cbranch_scc1 L_spin_25
L_back_26:
    v_mfma_f32_16x16x32_bf16 v[52:55], a[212:215], v[108:111], v[52:55]
    s_add_u32 s3, s3, 0x10000
    ds_read_b64_tr_b16 v[104:105], v227 offset:8192
    v_add_f32 v164, v164, v166
    v_add_f32 v168, v168, v170
    v_mfma_f32_16x16x32_bf16 v[48:51], a[208:211], v[108:111], v[48:51]
    s_waitcnt lgkmcnt(5)
    ds_read_b64_tr_b16 v[106:107], v227 offset:10240
    v_add_f32 v165, v165, v167
    v_add_f32 v169, v169, v171
    v_mfma_f32_16x16x32_bf16 v[44:47], a[204:207], v[108:111], v[44:47]
    buffer_load_dwordx4 v254, s[36:39], s75 offen sc1 lds
    v_add_f32 v164, v164, v168
    v_mfma_f32_16x16x32_bf16 v[8:11], a[216:219], v[112:115], v[8:11]
    s_add_u32 m0, m0, 4096
    ds_read_b64_tr_b16 v[108:109], v224 offset:12288
    v_add_f32 v165, v165, v169
    v_mul_f32 v148, 3133983949, v164
    v_mfma_f32_16x16x32_bf16 v[12:15], a[220:223], v[112:115], v[12:15]
    s_waitcnt lgkmcnt(5)
    ds_read_b64_tr_b16 v[110:111], v224 offset:14336
    v_mul_f32 v165, 3133983949, v165
    v_fma_f32 v165, -v148, v148, v165
    v_mfma_f32_16x16x32_bf16 v[16:19], a[224:227], v[112:115], v[16:19]
    buffer_load_dwordx4 v254, s[36:39], s76 offen sc1 lds
    v_max_f32 v165, 0, v165
    v_mfma_f32_16x16x32_bf16 v[28:31], a[224:227], v[116:119], v[28:31]
    s_add_u32 m0, m0, 4096
    ds_read_b64_tr_b16 v[112:113], v225 offset:12288
    v_add_f32 v156, 925353388, v165
    v_mfma_f32_16x16x32_bf16 v[24:27], a[220:223], v[116:119], v[24:27]
    s_waitcnt lgkmcnt(5)
    ds_read_b64_tr_b16 v[114:115], v225 offset:14336
    v_rsq_f32 v166, v156
    v_mfma_f32_16x16x32_bf16 v[20:23], a[216:219], v[116:119], v[20:23]
    v_mul_f32 v152, 3216550459, v166
    v_mov_b32 v150, v148
    v_mov_b32 v158, v156
    v_mfma_f32_16x16x32_bf16 v[32:35], a[216:219], v[120:123], v[32:35]
L_pg5:
    s_cbranch_execz L_pgback
    ds_read_b64_tr_b16 v[116:117], v226 offset:12288
    v_mov_b32 v154, v152
    v_mfma_f32_16x16x32_bf16 v[36:39], a[220:223], v[120:123], v[36:39]
    s_waitcnt lgkmcnt(5)
    ds_read_b64_tr_b16 v[118:119], v226 offset:14336
    v_permlane32_swap_b32 v148, v150
    v_mfma_f32_16x16x32_bf16 v[40:43], a[224:227], v[120:123], v[40:43]
    buffer_load_dwordx4 v254, s[36:39], s77 offen sc1 lds
    v_mfma_f32_16x16x32_bf16 v[52:55], a[224:227], v[104:107], v[52:55]
    s_add_u32 m0, m0, 4096
    ds_read_b64_tr_b16 v[120:121], v227 offset:12288
    v_permlane32_swap_b32 v156, v158
    v_mfma_f32_16x16x32_bf16 v[48:51], a[220:223], v[104:107], v[48:51]
    s_waitcnt lgkmcnt(5)
    ds_read_b64_tr_b16 v[122:123], v227 offset:14336
    v_permlane32_swap_b32 v152, v154
    v_mfma_f32_16x16x32_bf16 v[44:47], a[216:219], v[104:107], v[44:47]
    s_waitcnt vmcnt(10)
    s_barrier
    v_mov_b32 v149, v148
    v_mov_b32 v157, v156
    v_mfma_f32_16x16x32_bf16 v[8:11], a[228:231], v[108:111], v[8:11]
    ds_read_b64_tr_b16 v[104:105], v224 offset:16384
    v_mov_b32 v153, v152
    v_mov_b32 v151, v150
    v_mfma_f32_16x16x32_bf16 v[12:15], a[232:235], v[108:111], v[12:15]
    s_waitcnt lgkmcnt(5)
    ds_read_b64_tr_b16 v[106:107], v224 offset:18432
    v_mov_b32 v159, v158
    v_mov_b32 v155, v154
    v_mfma_f32_16x16x32_bf16 v[16:19], a[236:239], v[108:111], v[16:19]
    buffer_load_dwordx4 v254, s[36:39], s78 offen sc1 lds
    v_mfma_f32_16x16x32_bf16 v[28:31], a[236:239], v[112:115], v[28:31]
    s_add_u32 m0, m0, 4096
    ds_read_b64_tr_b16 v[108:109], v225 offset:16384
    v_permlane16_swap_b32 v148, v149
    v_mfma_f32_16x16x32_bf16 v[24:27], a[232:235], v[112:115], v[24:27]
    s_waitcnt lgkmcnt(5)
    ds_read_b64_tr_b16 v[110:111], v225 offset:18432
    v_permlane16_swap_b32 v156, v157
    v_mfma_f32_16x16x32_bf16 v[20:23], a[228:231], v[112:115], v[20:23]
    buffer_load_dwordx4 v254, s[36:39], s79 offen sc1 lds
    v_mfma_f32_16x16x32_bf16 v[32:35], a[228:231], v[116:119], v[32:35]
    s_add_u32 m0, m0, 4096
    ds_read_b64_tr_b16 v[112:113], v226 offset:16384
    v_permlane16_swap_b32 v152, v153
    v_mfma_f32_16x16x32_bf16 v[36:39], a[232:235], v[116:119], v[36:39]
    s_waitcnt lgkmcnt(5)
    ds_read_b64_tr_b16 v[114:115], v226 offset:18432
    v_permlane16_swap_b32 v150, v151
    v_mfma_f32_16x16x32_bf16 v[40:43], a[236:239], v[116:119], v[40:43]
    buffer_load_dwordx4 v254, s[36:39], s80 offen sc1 lds
    v_mfma_f32_16x16x32_bf16 v[52:55], a[236:239], v[120:123], v[52:55]
    s_add_u32 m0, m0, 4096
    ds_read_b64_tr_b16 v[116:117], v227 offset:16384
    v_permlane16_swap_b32 v158, v159
    v_mfma_f32_16x16x32_bf16 v[48:51], a[232:235], v[120:123], v[48:51]
    s_waitcnt lgkmcnt(5)
    ds_read_b64_tr_b16 v[118:119], v227 offset:18432
    v_permlane16_swap_b32 v154, v155
    v_mfma_f32_16x16x32_bf16 v[44:47], a[228:231], v[120:123], v[44:47]
    v_mfma_f32_16x16x32_bf16 v[56:59], a[0:3], v[104:107], 0
    ds_read_b64_tr_b16 v[120:121], v224 offset:20480
    v_mfma_f32_16x16x32_bf16 v[60:63], a[4:7], v[104:107], 0
    s_waitcnt lgkmcnt(5)
    ds_read_b64_tr_b16 v[122:123], v224 offset:22528
    v_mfma_f32_16x16x32_bf16 v[64:67], a[8:11], v[104:107], 0
    buffer_load_dwordx4 v254, s[36:39], s81 offen sc1 lds
    v_mfma_f32_16x16x32_bf16 v[76:79], a[8:11], v[108:111], 0
    s_add_u32 m0, m0, 4096
    ds_read_b64_tr_b16 v[104:105], v225 offset:20480
    v_mfma_f32_16x16x32_bf16 v[72:75], a[4:7], v[108:111], 0
    s_waitcnt lgkmcnt(5)
    ds_read_b64_tr_b16 v[106:107], v225 offset:22528
    v_fmac_f32 v8, v148, v136
    v_mfma_f32_16x16x32_bf16 v[68:71], a[0:3], v[108:111], 0
    buffer_load_dwordx4 v254, s[36:39], s82 offen sc1 lds
    v_fmac_f32 v9, v148, v137
    v_mfma_f32_16x16x32_bf16 v[80:83], a[0:3], v[112:115], 0
    s_add_u32 m0, m0, 4096
    ds_read_b64_tr_b16 v[108:109], v226 offset:20480
    v_mul_f32 v160, v8, v152
    v_exp_f32 v160, v160
    v_mfma_f32_16x16x32_bf16 v[84:87], a[4:7], v[112:115], 0
    s_waitcnt lgkmcnt(5)
    ds_read_b64_tr_b16 v[110:111], v226 offset:22528
    v_mul_f32 v161, v9, v152
    v_fmac_f32 v12, v148, v140
    v_fmac_f32 v20, v149, v136
    v_mfma_f32_16x16x32_bf16 v[88:91], a[8:11], v[112:115], 0
    v_exp_f32 v161, v161
    v_fmac_f32 v21, v149, v137
    v_mfma_f32_16x16x32_bf16 v[100:103], a[8:11], v[116:119], 0
    ds_read_b64_tr_b16 v[112:113], v227 offset:20480
    v_fma_f32 v160, v160, v156, v156
    v_fmac_f32 v13, v148, v141
    v_mul_f32 v162, v20, v153
    v_mfma_f32_16x16x32_bf16 v[96:99], a[4:7], v[116:119], 0
    s_waitcnt lgkmcnt(5)
    ds_read_b64_tr_b16 v[114:115], v227 offset:22528
    v_rcp_f32 v160, v160
    v_fmac_f32 v32, v150, v136
    v_mfma_f32_16x16x32_bf16 v[92:95], a[0:3], v[116:119], 0
    buffer_load_dwordx4 v254, s[36:39], s83 offen sc1 lds
    v_fma_f32 v161, v161, v156, v156
    v_mfma_f32_16x16x32_bf16 v[56:59], a[12:15], v[120:123], v[56:59]
    ds_read_b64_tr_b16 v[116:117], v224 offset:24576
    v_exp_f32 v162, v162
    v_mul_f32 v8, v8, v12
    v_mfma_f32_16x16x32_bf16 v[60:63], a[16:19], v[120:123], v[60:63]
    s_waitcnt lgkmcnt(5)
    ds_read_b64_tr_b16 v[118:119], v224 offset:26624
    v_rcp_f32 v161, v161
    v_mul_f32 v163, v21, v153
    v_mfma_f32_16x16x32_bf16 v[64:67], a[20:23], v[120:123], v[64:67]
    buffer_load_dwordx4 a[0:3], v240, s[36:39], s64 offen offset:0 sc1
    v_mul_f32 v9, v9, v13
    v_mfma_f32_16x16x32_bf16 v[76:79], a[20:23], v[104:107], v[76:79]
    ds_read_b64_tr_b16 v[120:121], v225 offset:24576
    v_mul_f32 v8, v8, v160
    v_mul_f32 v9, v9, v161
    v_cvt_pk_bf16_f32 v172, v8, v9
    v_mfma_f32_16x16x32_bf16 v[72:75], a[16:19], v[104:107], v[72:75]
    s_waitcnt lgkmcnt(5)
    ds_read_b64_tr_b16 v[122:123], v225 offset:26624
    v_fmac_f32 v24, v149, v140
    v_exp_f32 v163, v163
    v_mfma_f32_16x16x32_bf16 v[68:71], a[12:15], v[104:107], v[68:71]
    v_fma_f32 v162, v162, v157, v157
    v_fmac_f32 v25, v149, v141
    v_rcp_f32 v162, v162
    v_mfma_f32_16x16x32_bf16 v[80:83], a[12:15], v[108:111], v[80:83]
    ds_read_b64_tr_b16 v[104:105], v226 offset:24576
    v_fma_f32 v163, v163, v157, v157
    v_mul_f32 v20, v20, v24
    v_mfma_f32_16x16x32_bf16 v[84:87], a[16:19], v[108:111], v[84:87]
    s_waitcnt lgkmcnt(5)
    ds_read_b64_tr_b16 v[106:107], v226 offset:26624
    v_rcp_f32 v163, v163
    v_fmac_f32 v33, v150, v137
    v_mfma_f32_16x16x32_bf16 v[88:91], a[20:23], v[108:111], v[88:91]
    buffer_load_dwordx4 a[4:7], v240, s[36:39], s64 offen offset:1024 sc1
    v_mul_f32 v21, v21, v25
    v_mul_f32 v20, v20, v162
    v_mfma_f32_16x16x32_bf16 v[100:103], a[20:23], v[112:115], v[100:103]
    ds_read_b64_tr_b16 v[108:109], v227 offset:24576
    v_mul_f32 v21, v21, v163
    v_cvt_pk_bf16_f32 v173, v20, v21
    v_mfma_f32_16x16x32_bf16 v[96:99], a[16:19], v[112:115], v[96:99]
    s_waitcnt lgkmcnt(5)
    ds_read_b64_tr_b16 v[110:111], v227 offset:26624
    v_mul_f32 v216, v32, v154
    v_exp_f32 v216, v216
    v_mfma_f32_16x16x32_bf16 v[92:95], a[12:15], v[112:115], v[92:95]
    v_add_u32 v244, 81920, v244
    v_mul_f32 v217, v33, v154
    v_fmac_f32 v36, v150, v140
    v_fmac_f32 v44, v151, v136
    v_mfma_f32_16x16x32_bf16 v[56:59], a[24:27], v[116:119], v[56:59]
    ds_read_b64_tr_b16 v[112:113], v224 offset:28672
    v_exp_f32 v217, v217
    v_mfma_f32_16x16x32_bf16 v[60:63], a[28:31], v[116:119], v[60:63]
    s_waitcnt lgkmcnt(5)
    ds_read_b64_tr_b16 v[114:115], v224 offset:30720
    v_fma_f32 v216, v216, v158, v158
    v_fmac_f32 v37, v150, v141
    v_fmac_f32 v45, v151, v137
    v_mfma_f32_16x16x32_bf16 v[64:67], a[32:35], v[116:119], v[64:67]
    buffer_load_dwordx4 a[8:11], v240, s[36:39], s64 offen offset:2048 sc1
    v_rcp_f32 v216, v216
    v_mfma_f32_16x16x32_bf16 v[76:79], a[32:35], v[120:123], v[76:79]
    ds_read_b64_tr_b16 v[116:117], v225 offset:28672
    v_fma_f32 v217, v217, v158, v158
    v_mul_f32 v32, v32, v36
    v_mul_f32 v160, v44, v155
    v_mfma_f32_16x16x32_bf16 v[72:75], a[28:31], v[120:123], v[72:75]
    s_waitcnt lgkmcnt(5)
    ds_read_b64_tr_b16 v[118:119], v225 offset:30720
    v_rcp_f32 v217, v217
    v_mfma_f32_16x16x32_bf16 v[68:71], a[24:27], v[120:123], v[68:71]
    buffer_load_dwordx4 a[12:15], v240, s[36:39], s64 offen offset:3072 sc1
    v_exp_f32 v160, v160
    v_mfma_f32_16x16x32_bf16 v[80:83], a[24:27], v[104:107], v[80:83]
    ds_read_b64_tr_b16 v[120:121], v226 offset:28672
    v_mul_f32 v33, v33, v37
    v_mul_f32 v32, v32, v216
    v_mul_f32 v33, v33, v217
    v_mfma_f32_16x16x32_bf16 v[84:87], a[28:31], v[104:107], v[84:87]
    s_waitcnt lgkmcnt(5)
    ds_read_b64_tr_b16 v[122:123], v226 offset:30720
    v_cvt_pk_bf16_f32 v174, v32, v33
    v_mul_f32 v161, v45, v155
    v_mfma_f32_16x16x32_bf16 v[88:91], a[32:35], v[104:107], v[88:91]
    buffer_load_dwordx4 a[16:19], v240, s[36:39], s65 offen offset:0 sc1
    v_fmac_f32 v48, v151, v140
    v_fmac_f32 v10, v148, v138
    v_mfma_f32_16x16x32_bf16 v[100:103], a[32:35], v[108:111], v[100:103]
    ds_read_b64_tr_b16 v[104:105], v227 offset:28672
    v_exp_f32 v161, v161
    v_fmac_f32 v11, v148, v139
    v_mfma_f32_16x16x32_bf16 v[96:99], a[28:31], v[108:111], v[96:99]
    s_waitcnt lgkmcnt(5)
    ds_read_b64_tr_b16 v[106:107], v227 offset:30720
    v_fma_f32 v160, v160, v159, v159
    v_fmac_f32 v49, v151, v141
    v_mfma_f32_16x16x32_bf16 v[92:95], a[24:27], v[108:111], v[92:95]
    s_waitcnt vmcnt(5)
    s_barrier
    v_rcp_f32 v160, v160
    v_mul_f32 v162, v10, v152
    v_mfma_f32_16x16x32_bf16 v[56:59], a[36:39], v[112:115], v[56:59]
    ds_read_b64_tr_b16 v[108:109], v224 offset:32768
    ds_read_b64_tr_b16 v[184:185], v244 offset:0
    v_exp_f32 v162, v162
    v_mfma_f32_16x16x32_bf16 v[60:63], a[40:43], v[112:115], v[60:63]
    s_waitcnt lgkmcnt(6)
    ds_read_b64_tr_b16 v[110:111], v224 offset:34816
    ds_read_b64_tr_b16 v[186:187], v244 offset:2048
    v_fma_f32 v161, v161, v159, v159
    v_mul_f32 v44, v44, v48
    v_mfma_f32_16x16x32_bf16 v[64:67], a[44:47], v[112:115], v[64:67]
    ds_read_b64_tr_b16 v[188:189], v244 offset:4096
    ds_read_b64_tr_b16 v[190:191], v244 offset:6144
    v_mul_f32 v163, v11, v152
    v_mfma_f32_16x16x32_bf16 v[76:79], a[44:47], v[116:119], v[76:79]
    ds_read_b64_tr_b16 v[112:113], v225 offset:32768
    ds_read_b64_tr_b16 v[192:193], v244 offset:8192
    v_rcp_f32 v161, v161
    v_mfma_f32_16x16x32_bf16 v[72:75], a[40:43], v[116:119], v[72:75]
    s_waitcnt lgkmcnt(10)
    ds_read_b64_tr_b16 v[114:115], v225 offset:34816
    ds_read_b64_tr_b16 v[194:195], v244 offset:10240
    v_mul_f32 v45, v45, v49
    v_mul_f32 v44, v44, v160
    v_mfma_f32_16x16x32_bf16 v[68:71], a[36:39], v[116:119], v[68:71]
    ds_read_b64_tr_b16 v[196:197], v244 offset:12288
    ds_read_b64_tr_b16 v[198:199], v244 offset:14336
    v_mul_f32 v45, v45, v161
    v_mfma_f32_16x16x32_bf16 v[80:83], a[36:39], v[120:123], v[80:83]
    ds_read_b64_tr_b16 v[116:117], v226 offset:32768
    ds_read_b64_tr_b16 v[200:201], v244 offset:16384
    v_cvt_pk_bf16_f32 v175, v44, v45
    v_fmac_f32 v14, v148, v142
    v_mfma_f32_16x16x32_bf16 v[84:87], a[40:43], v[120:123], v[84:87]
    s_waitcnt lgkmcnt(14)
    ds_read_b64_tr_b16 v[118:119], v226 offset:34816
    ds_read_b64_tr_b16 v[202:203], v244 offset:18432
    v_permlane32_swap_b32 v172, v174
    v_mfma_f32_16x16x32_bf16 v[88:91], a[44:47], v[120:123], v[88:91]
    buffer_load_dwordx4 a[20:23], v240, s[36:39], s65 offen offset:1024 sc1
    v_fmac_f32 v22, v149, v138
    v_mfma_f32_16x16x32_bf16 v[100:103], a[44:47], v[104:107], v[100:103]
    ds_read_b64_tr_b16 v[120:121], v227 offset:32768
    v_permlane32_swap_b32 v173, v175
    v_fmac_f32 v23, v149, v139
    v_mfma_f32_16x16x32_bf16 v[96:99], a[40:43], v[104:107], v[96:99]
    s_waitcnt lgkmcnt(14)
    ds_read_b64_tr_b16 v[122:123], v227 offset:34816
    v_permlane16_swap_b32 v172, v173
    v_mul_f32 v216, v22, v153
    v_mfma_f32_16x16x32_bf16 v[92:95], a[36:39], v[104:107], v[92:95]
    buffer_load_dwordx4 a[24:27], v240, s[36:39], s65 offen offset:2048 sc1
    v_permlane16_swap_b32 v174, v175
    v_mfma_f32_16x16x32_bf16 v[56:59], a[48:51], v[108:111], v[56:59]
    ds_read_b64_tr_b16 v[104:105], v224 offset:36864
    buffer_store_dwordx4 v[172:175], v236, s[36:39], s34 offen offset:0 sc1
    v_mfma_f32_16x16x32_bf16 v[60:63], a[52:55], v[108:111], v[60:63]
    s_waitcnt lgkmcnt(10)
    ds_read_b64_tr_b16 v[106:107], v224 offset:38912
    v_exp_f32 v163, v163
    v_fmac_f32 v34, v150, v138
    v_mfma_f32_16x16x32_bf16 v[64:67], a[56:59], v[108:111], v[64:67]
    buffer_load_dwordx4 a[28:31], v240, s[36:39], s65 offen offset:3072 sc1
    v_exp_f32 v216, v216
    v_mfma_f32_16x16x32_bf16 v[76:79], a[56:59], v[112:115], v[76:79]
    ds_read_b64_tr_b16 v[108:109], v225 offset:36864
    v_fma_f32 v162, v162, v156, v156
    v_fmac_f32 v15, v148, v143
    v_mfma_f32_16x16x32_bf16 v[72:75], a[52:55], v[112:115], v[72:75]
    s_waitcnt lgkmcnt(6)
    ds_read_b64_tr_b16 v[110:111], v225 offset:38912
    v_rcp_f32 v162, v162
    v_mul_f32 v217, v23, v153
    v_mfma_f32_16x16x32_bf16 v[68:71], a[48:51], v[112:115], v[68:71]
    buffer_load_dwordx4 a[32:35], v240, s[36:39], s66 offen offset:0 sc1
    v_fma_f32 v163, v163, v156, v156
    v_mul_f32 v10, v10, v14
    v_mfma_f32_16x16x32_bf16 v[80:83], a[48:51], v[116:119], v[80:83]
    ds_read_b64_tr_b16 v[112:113], v226 offset:36864
    v_rcp_f32 v163, v163
    v_mfma_f32_16x16x32_bf16 v[84:87], a[52:55], v[116:119], v[84:87]
    s_waitcnt lgkmcnt(5)
    ds_read_b64_tr_b16 v[114:115], v226 offset:38912
    v_mul_f32 v11, v11, v15
    v_mul_f32 v10, v10, v162
    v_mul_f32 v11, v11, v163
    v_mfma_f32_16x16x32_bf16 v[88:91], a[56:59], v[116:119], v[88:91]
    buffer_load_dwordx4 a[36:39], v240, s[36:39], s66 offen offset:1024 sc1
    v_cvt_pk_bf16_f32 v176, v10, v11
    v_fmac_f32 v26, v149, v142
    v_mfma_f32_16x16x32_bf16 v[208:211], v[184:187], v[184:187], 0
    v_add_u32 v228, 81920, v228
    v_exp_f32 v217, v217
    v_fmac_f32 v35, v150, v139
    v_mfma_f32_16x16x32_bf16 v[212:215], v[204:207], v[184:187], 0
    ds_read_b64_tr_b16 v[130:131], v228
    v_add_u32 v229, 81920, v229
    v_fma_f32 v216, v216, v157, v157
    v_mfma_f32_16x16x32_bf16 v[208:211], v[188:191], v[188:191], v[208:211]
    ds_read_b64_tr_b16 v[132:133], v229
    v_add_u32 v230, 81920, v230
    v_fmac_f32 v27, v149, v143
    v_mul_f32 v160, v34, v154
    v_mfma_f32_16x16x32_bf16 v[212:215], v[204:207], v[188:191], v[212:215]
    ds_read_b64_tr_b16 v[134:135], v230
    v_rcp_f32 v216, v216
    v_fmac_f32 v46, v151, v138
    v_mfma_f32_16x16x32_bf16 v[208:211], v[192:195], v[192:195], v[208:211]
    buffer_load_dwordx4 a[40:43], v240, s[36:39], s66 offen offset:2048 sc1
    v_fma_f32 v217, v217, v157, v157
    v_mfma_f32_16x16x32_bf16 v[212:215], v[204:207], v[192:195], v[212:215]
    v_exp_f32 v160, v160
    v_mul_f32 v22, v22, v26
    v_mul_f32 v161, v35, v154
    v_mfma_f32_16x16x32_bf16 v[208:211], v[196:199], v[196:199], v[208:211]
    v_rcp_f32 v217, v217
    v_fmac_f32 v38, v150, v142
    v_mul_f32 v23, v23, v27
    v_mfma_f32_16x16x32_bf16 v[212:215], v[204:207], v[196:199], v[212:215]
    v_exp_f32 v161, v161
    v_mul_f32 v22, v22, v216
    v_mfma_f32_16x16x32_bf16 v[208:211], v[200:203], v[200:203], v[208:211]
    v_mul_f32 v23, v23, v217
    v_cvt_pk_bf16_f32 v177, v22, v23
    v_fma_f32 v160, v160, v158, v158
    v_fmac_f32 v39, v150, v143
    v_mfma_f32_16x16x32_bf16 v[212:215], v[204:207], v[200:203], v[212:215]
    buffer_load_dwordx4 a[44:47], v240, s[36:39], s66 offen offset:3072 sc1
    v_rcp_f32 v160, v160
    v_mfma_f32_16x16x32_bf16 v[100:103], a[56:59], v[120:123], v[100:103]
    ds_read_b64_tr_b16 v[116:117], v227 offset:36864
    v_fma_f32 v161, v161, v158, v158
    v_mul_f32 v34, v34, v38
    v_fmac_f32 v47, v151, v139
    v_mfma_f32_16x16x32_bf16 v[96:99], a[52:55], v[120:123], v[96:99]
    s_waitcnt lgkmcnt(8)
    ds_read_b64_tr_b16 v[118:119], v227 offset:38912
    v_rcp_f32 v161, v161
    v_mfma_f32_16x16x32_bf16 v[92:95], a[48:51], v[120:123], v[92:95]
    v_mul_f32 v35, v35, v39
    v_mul_f32 v34, v34, v160
    v_mul_f32 v35, v35, v161
    v_cvt_pk_bf16_f32 v178, v34, v35
    v_mfma_f32_16x16x32_bf16 v[56:59], a[60:63], v[104:107], v[56:59]
    ds_read_b64_tr_b16 v[120:121], v224 offset:40960
    v_cndmask_b32 v208, v208, v209, s[4:5]
    v_cndmask_b32 v210, v210, v211, s[4:5]
    v_mul_f32 v162, v46, v155
    v_mfma_f32_16x16x32_bf16 v[60:63], a[64:67], v[104:107], v[60:63]
    s_waitcnt lgkmcnt(8)
    ds_read_b64_tr_b16 v[122:123], v224 offset:43008
    v_cndmask_b32 v208, v208, v210, s[6:7]
    v_or_b32 v213, 0x80000000, v208
    v_fmac_f32 v16, v148, v144
    v_mfma_f32_16x16x32_bf16 v[64:67], a[68:71], v[104:107], v[64:67]
    buffer_store_dwordx4 v[212:215], v243, s[36:39], s80 offen sc1
    v_exp_f32 v162, v162
    v_mfma_f32_16x16x32_bf16 v[76:79], a[68:71], v[108:111], v[76:79]
    ds_read_b64_tr_b16 v[104:105], v225 offset:40960
    v_mul_f32 v163, v47, v155
    v_fmac_f32 v50, v151, v142
    v_fmac_f32 v18, v148, v146
    v_mfma_f32_16x16x32_bf16 v[72:75], a[64:67], v[108:111], v[72:75]
    s_waitcnt lgkmcnt(8)
    ds_read_b64_tr_b16 v[106:107], v225 offset:43008
    v_exp_f32 v163, v163
    v_fmac_f32 v17, v148, v145
    v_mfma_f32_16x16x32_bf16 v[68:71], a[60:63], v[108:111], v[68:71]
    buffer_load_dwordx4 a[48:51], v240, s[36:39], s67 offen offset:0 sc1
    v_fma_f32 v162, v162, v159, v159
    v_mfma_f32_16x16x32_bf16 v[80:83], a[60:63], v[112:115], v[80:83]
    ds_read_b64_tr_b16 v[108:109], v226 offset:40960
    v_fmac_f32 v51, v151, v143
    v_rcp_f32 v162, v162
    v_mfma_f32_16x16x32_bf16 v[84:87], a[64:67], v[112:115], v[84:87]
    s_waitcnt lgkmcnt(5)
    ds_read_b64_tr_b16 v[110:111], v226 offset:43008
    v_fma_f32 v163, v163, v159, v159
    v_mul_f32 v46, v46, v50
    v_fmac_f32 v19, v148, v147
    v_mfma_f32_16x16x32_bf16 v[88:91], a[68:71], v[112:115], v[88:91]
    buffer_load_dwordx4 a[52:55], v240, s[36:39], s67 offen offset:1024 sc1
    v_fmac_f32 v28, v149, v144
    v_mfma_f32_16x16x32_bf16 v[100:103], a[68:71], v[116:119], v[100:103]
    ds_read_b64_tr_b16 v[112:113], v227 offset:40960
    v_rcp_f32 v163, v163
    v_fmac_f32 v30, v149, v146
    v_mfma_f32_16x16x32_bf16 v[96:99], a[64:67], v[116:119], v[96:99]
    s_waitcnt lgkmcnt(5)
    ds_read_b64_tr_b16 v[114:115], v227 offset:43008
    v_permlane32_swap_b32 v16, v18
    v_mul_f32 v47, v47, v51
    v_mfma_f32_16x16x32_bf16 v[92:95], a[60:63], v[116:119], v[92:95]
    buffer_load_dwordx4 a[56:59], v240, s[36:39], s67 offen offset:2048 sc1
    v_mul_f32 v46, v46, v162
    v_mfma_f32_16x16x32_bf16 v[56:59], a[72:75], v[120:123], v[56:59]
    ds_read_b64_tr_b16 v[116:117], v224 offset:45056
    v_permlane32_swap_b32 v17, v19
    v_mul_f32 v47, v47, v163
    v_mfma_f32_16x16x32_bf16 v[60:63], a[76:79], v[120:123], v[60:63]
    s_waitcnt lgkmcnt(5)
    ds_read_b64_tr_b16 v[118:119], v224 offset:47104
    v_cvt_pk_bf16_f32 v179, v46, v47
    v_mul_f32 v216, v16, v152
    v_fmac_f32 v29, v149, v145
    v_mfma_f32_16x16x32_bf16 v[64:67], a[80:83], v[120:123], v[64:67]
    buffer_load_dwordx4 a[60:63], v240, s[36:39], s67 offen offset:3072 sc1
    v_permlane32_swap_b32 v176, v178
    v_mfma_f32_16x16x32_bf16 v[76:79], a[80:83], v[104:107], v[76:79]
    ds_read_b64_tr_b16 v[120:121], v225 offset:45056
    v_permlane32_swap_b32 v177, v179
    v_mfma_f32_16x16x32_bf16 v[72:75], a[76:79], v[104:107], v[72:75]
    s_waitcnt lgkmcnt(5)
    ds_read_b64_tr_b16 v[122:123], v225 offset:47104
    v_permlane16_swap_b32 v176, v177
    v_fmac_f32 v31, v149, v147
    v_mfma_f32_16x16x32_bf16 v[68:71], a[72:75], v[104:107], v[68:71]
    v_permlane16_swap_b32 v178, v179
    v_exp_f32 v216, v216
    v_mfma_f32_16x16x32_bf16 v[80:83], a[72:75], v[108:111], v[80:83]
    ds_read_b64_tr_b16 v[104:105], v226 offset:45056
    buffer_store_dwordx4 v[176:179], v236, s[36:39], s34 offen offset:512 sc1
    v_mfma_f32_16x16x32_bf16 v[84:87], a[76:79], v[108:111], v[84:87]
    s_waitcnt lgkmcnt(5)
    ds_read_b64_tr_b16 v[106:107], v226 offset:47104
    v_permlane32_swap_b32 v28, v30
    v_mul_f32 v217, v17, v152
    v_mfma_f32_16x16x32_bf16 v[88:91], a[80:83], v[108:111], v[88:91]
    buffer_load_dwordx4 a[64:67], v240, s[36:39], s68 offen offset:0 sc1
    v_exp_f32 v217, v217
    v_mfma_f32_16x16x32_bf16 v[100:103], a[80:83], v[112:115], v[100:103]
    ds_read_b64_tr_b16 v[108:109], v227 offset:45056
    v_permlane32_swap_b32 v29, v31
    v_mfma_f32_16x16x32_bf16 v[96:99], a[76:79], v[112:115], v[96:99]
    s_waitcnt lgkmcnt(5)
    ds_read_b64_tr_b16 v[110:111], v227 offset:47104
    v_fma_f32 v216, v216, v156, v156
    v_rcp_f32 v216, v216
    v_mfma_f32_16x16x32_bf16 v[92:95], a[72:75], v[112:115], v[92:95]
    buffer_load_dwordx4 a[68:71], v240, s[36:39], s68 offen offset:1024 sc1
    v_fma_f32 v217, v217, v156, v156
    v_mul_f32 v16, v16, v18
    v_mfma_f32_16x16x32_bf16 v[56:59], a[84:87], v[116:119], v[56:59]
    ds_read_b64_tr_b16 v[112:113], v224 offset:49152
    v_rcp_f32 v217, v217
    v_mul_f32 v160, v28, v153
    v_mfma_f32_16x16x32_bf16 v[60:63], a[88:91], v[116:119], v[60:63]
    s_waitcnt lgkmcnt(5)
    ds_read_b64_tr_b16 v[114:115], v224 offset:51200
    v_exp_f32 v160, v160
    v_mfma_f32_16x16x32_bf16 v[64:67], a[92:95], v[116:119], v[64:67]
    v_mul_f32 v17, v17, v19
    v_mul_f32 v16, v16, v216
    v_mul_f32 v17, v17, v217
    v_cvt_pk_bf16_f32 v180, v16, v17
    v_mfma_f32_16x16x32_bf16 v[76:79], a[92:95], v[120:123], v[76:79]
    ds_read_b64_tr_b16 v[116:117], v225 offset:49152
    v_mul_f32 v161, v29, v153
    v_exp_f32 v161, v161
    v_mfma_f32_16x16x32_bf16 v[72:75], a[88:91], v[120:123], v[72:75]
    s_waitcnt lgkmcnt(5)
    ds_read_b64_tr_b16 v[118:119], v225 offset:51200
    v_fma_f32 v160, v160, v157, v157
    v_fmac_f32 v40, v150, v144
    v_mfma_f32_16x16x32_bf16 v[68:71], a[84:87], v[120:123], v[68:71]
    buffer_load_dwordx4 a[72:75], v240, s[36:39], s68 offen offset:2048 sc1
    v_rcp_f32 v160, v160
    v_mfma_f32_16x16x32_bf16 v[80:83], a[84:87], v[104:107], v[80:83]
    ds_read_b64_tr_b16 v[120:121], v226 offset:49152
    v_fma_f32 v161, v161, v157, v157
    v_mul_f32 v28, v28, v30
    v_fmac_f32 v42, v150, v146
    v_mfma_f32_16x16x32_bf16 v[84:87], a[88:91], v[104:107], v[84:87]
    s_waitcnt lgkmcnt(5)
    ds_read_b64_tr_b16 v[122:123], v226 offset:51200
    v_rcp_f32 v161, v161
    v_mfma_f32_16x16x32_bf16 v[88:91], a[92:95], v[104:107], v[88:91]
    buffer_load_dwordx4 a[76:79], v240, s[36:39], s68 offen offset:3072 sc1
    v_mul_f32 v29, v29, v31
    v_mul_f32 v28, v28, v160
    v_mfma_f32_16x16x32_bf16 v[100:103], a[92:95], v[108:111], v[100:103]
    ds_read_b64_tr_b16 v[104:105], v227 offset:49152
    v_mul_f32 v29, v29, v161
    v_cvt_pk_bf16_f32 v181, v28, v29
    v_fmac_f32 v41, v150, v145
    v_mfma_f32_16x16x32_bf16 v[96:99], a[88:91], v[108:111], v[96:99]
    s_waitcnt lgkmcnt(5)
    ds_read_b64_tr_b16 v[106:107], v227 offset:51200
    v_fmac_f32 v43, v150, v147
    v_permlane32_swap_b32 v40, v42
    v_mfma_f32_16x16x32_bf16 v[92:95], a[84:87], v[108:111], v[92:95]
    v_permlane32_swap_b32 v41, v43
    v_fmac_f32 v52, v151, v144
    v_mfma_f32_16x16x32_bf16 v[56:59], a[96:99], v[112:115], v[56:59]
    ds_read_b64_tr_b16 v[108:109], v224 offset:53248
    v_mul_f32 v162, v40, v154
    v_exp_f32 v162, v162
    v_mfma_f32_16x16x32_bf16 v[60:63], a[100:103], v[112:115], v[60:63]
    s_waitcnt lgkmcnt(5)
    ds_read_b64_tr_b16 v[110:111], v224 offset:55296
    v_mul_f32 v163, v41, v154
    v_exp_f32 v163, v163
    v_mfma_f32_16x16x32_bf16 v[64:67], a[104:107], v[112:115], v[64:67]
    buffer_load_dwordx4 a[80:83], v240, s[36:39], s69 offen offset:0 sc1
    v_fma_f32 v162, v162, v158, v158
    v_mfma_f32_16x16x32_bf16 v[76:79], a[104:107], v[116:119], v[76:79]
    ds_read_b64_tr_b16 v[112:113], v225 offset:53248
    v_rcp_f32 v162, v162
    v_fmac_f32 v54, v151, v146
    v_mfma_f32_16x16x32_bf16 v[72:75], a[100:103], v[116:119], v[72:75]
    s_waitcnt lgkmcnt(5)
    ds_read_b64_tr_b16 v[114:115], v225 offset:55296
    v_fma_f32 v163, v163, v158, v158
    v_mul_f32 v40, v40, v42
    v_fmac_f32 v53, v151, v145
    v_mfma_f32_16x16x32_bf16 v[68:71], a[96:99], v[116:119], v[68:71]
    v_rcp_f32 v163, v163
    v_fmac_f32 v55, v151, v147
    v_mfma_f32_16x16x32_bf16 v[80:83], a[96:99], v[120:123], v[80:83]
    ds_read_b64_tr_b16 v[116:117], v226 offset:53248
    v_permlane32_swap_b32 v52, v54
    v_mul_f32 v41, v41, v43
    v_mfma_f32_16x16x32_bf16 v[84:87], a[100:103], v[120:123], v[84:87]
    s_waitcnt lgkmcnt(5)
    ds_read_b64_tr_b16 v[118:119], v226 offset:55296
    v_permlane32_swap_b32 v53, v55
    v_mul_f32 v40, v40, v162
    v_mfma_f32_16x16x32_bf16 v[88:91], a[104:107], v[120:123], v[88:91]
    buffer_load_dwordx4 a[84:87], v240, s[36:39], s69 offen offset:1024 sc1
    v_mul_f32 v41, v41, v163
    v_cvt_pk_bf16_f32 v182, v40, v41
    v_mfma_f32_16x16x32_bf16 v[100:103], a[104:107], v[104:107], v[100:103]
    ds_read_b64_tr_b16 v[120:121], v227 offset:53248
    v_mul_f32 v216, v52, v155
    v_mfma_f32_16x16x32_bf16 v[96:99], a[100:103], v[104:107], v[96:99]
    s_waitcnt lgkmcnt(5)
    ds_read_b64_tr_b16 v[122:123], v227 offset:55296
    v_exp_f32 v216, v216
    v_mfma_f32_16x16x32_bf16 v[92:95], a[96:99], v[104:107], v[92:95]
    buffer_load_dwordx4 a[88:91], v240, s[36:39], s69 offen offset:2048 sc1
    v_mul_f32 v217, v53, v155
    v_mfma_f32_16x16x32_bf16 v[56:59], a[108:111], v[108:111], v[56:59]
    ds_read_b64_tr_b16 v[104:105], v224 offset:57344
    v_exp_f32 v217, v217
    v_mfma_f32_16x16x32_bf16 v[60:63], a[112:115], v[108:111], v[60:63]
    s_waitcnt lgkmcnt(5)
    ds_read_b64_tr_b16 v[106:107], v224 offset:59392
    v_fma_f32 v216, v216, v159, v159
    v_rcp_f32 v216, v216
    v_mfma_f32_16x16x32_bf16 v[64:67], a[116:119], v[108:111], v[64:67]
    v_fma_f32 v217, v217, v159, v159
    v_mul_f32 v52, v52, v54
    v_rcp_f32 v217, v217
    v_mfma_f32_16x16x32_bf16 v[76:79], a[116:119], v[112:115], v[76:79]
    ds_read_b64_tr_b16 v[108:109], v225 offset:57344
    v_mul_f32 v53, v53, v55
    v_mul_f32 v52, v52, v216
    v_mul_f32 v53, v53, v217
    v_mfma_f32_16x16x32_bf16 v[72:75], a[112:115], v[112:115], v[72:75]
    s_waitcnt lgkmcnt(5)
    ds_read_b64_tr_b16 v[110:111], v225 offset:59392
    v_cvt_pk_bf16_f32 v183, v52, v53
    v_mfma_f32_16x16x32_bf16 v[68:71], a[108:111], v[112:115], v[68:71]
    buffer_load_dwordx4 a[92:95], v240, s[36:39], s69 offen offset:3072 sc1
    v_permlane32_swap_b32 v180, v182
    v_mfma_f32_16x16x32_bf16 v[80:83], a[108:111], v[116:119], v[80:83]
    ds_read_b64_tr_b16 v[112:113], v226 offset:57344
    v_permlane32_swap_b32 v181, v183
    v_mfma_f32_16x16x32_bf16 v[84:87], a[112:115], v[116:119], v[84:87]
    s_waitcnt lgkmcnt(5)
    ds_read_b64_tr_b16 v[114:115], v226 offset:59392
    v_permlane16_swap_b32 v180, v181
    v_mfma_f32_16x16x32_bf16 v[88:91], a[116:119], v[116:119], v[88:91]
    buffer_load_dwordx4 a[96:99], v240, s[36:39], s70 offen offset:0 sc1
    v_permlane16_swap_b32 v182, v183
    v_mfma_f32_16x16x32_bf16 v[100:103], a[116:119], v[120:123], v[100:103]
    ds_read_b64_tr_b16 v[116:117], v227 offset:57344
    buffer_store_dwordx4 v[180:183], v236, s[36:39], s34 offen offset:1024 sc1
    v_mfma_f32_16x16x32_bf16 v[96:99], a[112:115], v[120:123], v[96:99]
    s_waitcnt lgkmcnt(5)
    ds_read_b64_tr_b16 v[118:119], v227 offset:59392
    v_mfma_f32_16x16x32_bf16 v[92:95], a[108:111], v[120:123], v[92:95]
    v_mfma_f32_16x16x32_bf16 v[56:59], a[120:123], v[104:107], v[56:59]
    ds_read_b64_tr_b16 v[120:121], v224 offset:61440
    v_mfma_f32_16x16x32_bf16 v[60:63], a[124:127], v[104:107], v[60:63]
    s_waitcnt lgkmcnt(5)
    ds_read_b64_tr_b16 v[122:123], v224 offset:63488
    v_mfma_f32_16x16x32_bf16 v[64:67], a[128:131], v[104:107], v[64:67]
    buffer_load_dwordx2 v[164:165], v235, s[36:39], s3 offen offset:0 sc1
    v_mfma_f32_16x16x32_bf16 v[76:79], a[128:131], v[108:111], v[76:79]
    ds_read_b64_tr_b16 v[104:105], v225 offset:61440
    v_mfma_f32_16x16x32_bf16 v[72:75], a[124:127], v[108:111], v[72:75]
    s_waitcnt lgkmcnt(5)
    ds_read_b64_tr_b16 v[106:107], v225 offset:63488
    v_mfma_f32_16x16x32_bf16 v[68:71], a[120:123], v[108:111], v[68:71]
    buffer_load_dwordx2 v[166:167], v235, s[36:39], s3 offen offset:256 sc1
    v_mfma_f32_16x16x32_bf16 v[80:83], a[120:123], v[112:115], v[80:83]
    ds_read_b64_tr_b16 v[108:109], v226 offset:61440
    v_mfma_f32_16x16x32_bf16 v[84:87], a[124:127], v[112:115], v[84:87]
    s_waitcnt lgkmcnt(5)
    ds_read_b64_tr_b16 v[110:111], v226 offset:63488
    v_mfma_f32_16x16x32_bf16 v[88:91], a[128:131], v[112:115], v[88:91]
    buffer_load_dwordx2 v[168:169], v235, s[36:39], s3 offen offset:512 sc1
    v_mfma_f32_16x16x32_bf16 v[100:103], a[128:131], v[116:119], v[100:103]
    ds_read_b64_tr_b16 v[112:113], v227 offset:61440
    v_mfma_f32_16x16x32_bf16 v[96:99], a[124:127], v[116:119], v[96:99]
    s_waitcnt lgkmcnt(5)
    ds_read_b64_tr_b16 v[114:115], v227 offset:63488
    v_add_u32 v224, 0x10000, v224
    v_mfma_f32_16x16x32_bf16 v[92:95], a[120:123], v[116:119], v[92:95]
    buffer_load_dwordx2 v[170:171], v235, s[36:39], s3 offen offset:768 sc1
    v_mfma_f32_16x16x32_bf16 v[56:59], a[132:135], v[120:123], v[56:59]
    ds_read_b64_tr_b16 v[116:117], v224 offset:0
    v_mfma_f32_16x16x32_bf16 v[60:63], a[136:139], v[120:123], v[60:63]
    s_waitcnt lgkmcnt(5)
    ds_read_b64_tr_b16 v[118:119], v224 offset:2048
    v_add_u32 v225, 0x10000, v225
    v_mfma_f32_16x16x32_bf16 v[64:67], a[140:143], v[120:123], v[64:67]
    buffer_load_dwordx4 a[100:103], v240, s[36:39], s70 offen offset:1024 sc1
    v_mfma_f32_16x16x32_bf16 v[76:79], a[140:143], v[104:107], v[76:79]
    ds_read_b64_tr_b16 v[120:121], v225 offset:0
    v_mfma_f32_16x16x32_bf16 v[72:75], a[136:139], v[104:107], v[72:75]
    s_waitcnt lgkmcnt(5)
    ds_read_b64_tr_b16 v[122:123], v225 offset:2048
    v_add_u32 v226, 0x10000, v226
    v_mfma_f32_16x16x32_bf16 v[68:71], a[132:135], v[104:107], v[68:71]
    buffer_load_dwordx4 a[104:107], v240, s[36:39], s70 offen offset:2048 sc1
    v_mfma_f32_16x16x32_bf16 v[80:83], a[132:135], v[108:111], v[80:83]
    ds_read_b64_tr_b16 v[104:105], v226 offset:0
    v_mfma_f32_16x16x32_bf16 v[84:87], a[136:139], v[108:111], v[84:87]
    s_waitcnt lgkmcnt(5)
    ds_read_b64_tr_b16 v[106:107], v226 offset:2048
    v_add_u32 v227, 0x10000, v227
    v_mfma_f32_16x16x32_bf16 v[88:91], a[140:143], v[108:111], v[88:91]
L_pg6:
    s_cbranch_execz L_pgback
    buffer_load_dwordx4 a[108:111], v240, s[36:39], s70 offen offset:3072 sc1
    v_mfma_f32_16x16x32_bf16 v[100:103], a[140:143], v[112:115], v[100:103]
    ds_read_b64_tr_b16 v[108:109], v227 offset:0
    v_mfma_f32_16x16x32_bf16 v[96:99], a[136:139], v[112:115], v[96:99]
    s_waitcnt lgkmcnt(5)
    ds_read_b64_tr_b16 v[110:111], v227 offset:2048
    v_mfma_f32_16x16x32_bf16 v[92:95], a[132:135], v[112:115], v[92:95]
    buffer_load_dwordx4 a[112:115], v240, s[36:39], s71 offen offset:0 sc1
    v_mfma_f32_16x16x32_bf16 v[56:59], a[144:147], v[116:119], v[56:59]
    ds_read_b64_tr_b16 v[112:113], v224 offset:4096
    v_mfma_f32_16x16x32_bf16 v[60:63], a[148:151], v[116:119], v[60:63]
    s_waitcnt lgkmcnt(5)
    ds_read_b64_tr_b16 v[114:115], v224 offset:6144
    v_mfma_f32_16x16x32_bf16 v[64:67], a[152:155], v[116:119], v[64:67]
    buffer_load_dwordx4 a[116:119], v240, s[36:39], s71 offen offset:1024 sc1
    v_mfma_f32_16x16x32_bf16 v[76:79], a[152:155], v[120:123], v[76:79]
    ds_read_b64_tr_b16 v[116:117], v225 offset:4096
    v_mfma_f32_16x16x32_bf16 v[72:75], a[148:151], v[120:123], v[72:75]
    s_waitcnt lgkmcnt(5)
    ds_read_b64_tr_b16 v[118:119], v225 offset:6144
    v_mfma_f32_16x16x32_bf16 v[68:71], a[144:147], v[120:123], v[68:71]
    v_mfma_f32_16x16x32_bf16 v[80:83], a[144:147], v[104:107], v[80:83]
    ds_read_b64_tr_b16 v[120:121], v226 offset:4096
    v_mfma_f32_16x16x32_bf16 v[84:87], a[148:151], v[104:107], v[84:87]
    s_waitcnt lgkmcnt(5)
    ds_read_b64_tr_b16 v[122:123], v226 offset:6144
    v_mfma_f32_16x16x32_bf16 v[88:91], a[152:155], v[104:107], v[88:91]
    buffer_load_dwordx4 a[120:123], v240, s[36:39], s71 offen offset:2048 sc1
    v_mfma_f32_16x16x32_bf16 v[100:103], a[152:155], v[108:111], v[100:103]
    ds_read_b64_tr_b16 v[104:105], v227 offset:4096
    v_mfma_f32_16x16x32_bf16 v[96:99], a[148:151], v[108:111], v[96:99]
    s_waitcnt lgkmcnt(5)
    ds_read_b64_tr_b16 v[106:107], v227 offset:6144
    v_mfma_f32_16x16x32_bf16 v[92:95], a[144:147], v[108:111], v[92:95]
    v_mfma_f32_16x16x32_bf16 v[56:59], a[156:159], v[112:115], v[56:59]
    ds_read_b64_tr_b16 v[108:109], v224 offset:8192
    v_mfma_f32_16x16x32_bf16 v[60:63], a[160:163], v[112:115], v[60:63]
    s_waitcnt lgkmcnt(5)
    ds_read_b64_tr_b16 v[110:111], v224 offset:10240
    v_mfma_f32_16x16x32_bf16 v[64:67], a[164:167], v[112:115], v[64:67]
    buffer_load_dwordx4 a[124:127], v240, s[36:39], s71 offen offset:3072 sc1
    v_mfma_f32_16x16x32_bf16 v[76:79], a[164:167], v[116:119], v[76:79]
    ds_read_b64_tr_b16 v[112:113], v225 offset:8192
    v_mfma_f32_16x16x32_bf16 v[72:75], a[160:163], v[116:119], v[72:75]
    s_waitcnt lgkmcnt(5)
    ds_read_b64_tr_b16 v[114:115], v225 offset:10240
    v_mfma_f32_16x16x32_bf16 v[68:71], a[156:159], v[116:119], v[68:71]
    s_waitcnt vmcnt(11)
    s_barrier
    s_add_u32 s34, s34, 3145728
    buffer_atomic_add v4, v2, s[36:39], s35 offen offset:128 sc1
    v_mfma_f32_16x16x32_bf16 v[80:83], a[156:159], v[120:123], v[80:83]
    ds_read_b64_tr_b16 v[116:117], v226 offset:8192
    v_mfma_f32_16x16x32_bf16 v[84:87], a[160:163], v[120:123], v[84:87]
    s_waitcnt lgkmcnt(5)
    ds_read_b64_tr_b16 v[118:119], v226 offset:10240
    v_mfma_f32_16x16x32_bf16 v[88:91], a[164:167], v[120:123], v[88:91]
    buffer_load_dwordx4 a[128:131], v240, s[36:39], s72 offen offset:0 sc1
    v_mfma_f32_16x16x32_bf16 v[100:103], a[164:167], v[104:107], v[100:103]
    ds_read_b64_tr_b16 v[120:121], v227 offset:8192
    v_mfma_f32_16x16x32_bf16 v[96:99], a[160:163], v[104:107], v[96:99]
    s_waitcnt lgkmcnt(5)
    ds_read_b64_tr_b16 v[122:123], v227 offset:10240
    v_mfma_f32_16x16x32_bf16 v[92:95], a[156:159], v[104:107], v[92:95]
    buffer_load_dwordx4 a[132:135], v240, s[36:39], s72 offen offset:1024 sc1
    v_mfma_f32_16x16x32_bf16 v[56:59], a[168:171], v[108:111], v[56:59]
    ds_read_b64_tr_b16 v[104:105], v224 offset:12288
    v_mfma_f32_16x16x32_bf16 v[60:63], a[172:175], v[108:111], v[60:63]
    s_waitcnt lgkmcnt(5)
    ds_read_b64_tr_b16 v[106:107], v224 offset:14336
    v_mfma_f32_16x16x32_bf16 v[64:67], a[176:179], v[108:111], v[64:67]
    buffer_load_dwordx4 a[136:139], v240, s[36:39], s72 offen offset:2048 sc1
    v_mfma_f32_16x16x32_bf16 v[76:79], a[176:179], v[112:115], v[76:79]
    ds_read_b64_tr_b16 v[108:109], v225 offset:12288
    v_mfma_f32_16x16x32_bf16 v[72:75], a[172:175], v[112:115], v[72:75]
    s_waitcnt lgkmcnt(5)
    ds_read_b64_tr_b16 v[110:111], v225 offset:14336
    v_mfma_f32_16x16x32_bf16 v[68:71], a[168:171], v[112:115], v[68:71]
    s_waitcnt vmcnt(13)
    v_and_b32 v162, v165, v167
    s_waitcnt vmcnt(11)
    v_and_b32 v163, v169, v171
    v_and_b32 v162, v162, v163
    v_cmp_le_i32 vcc, 0, v162
    s_nop 0
    s_cmp_lg_u64 vcc, 0
    s_cbranch_scc1 L_spin_27
L_back_28:
    v_mfma_f32_16x16x32_bf16 v[80:83], a[168:171], v[116:119], v[80:83]
    ds_read_b64_tr_b16 v[112:113], v226 offset:12288
    s_add_u32 s3, s3, 0x10000
    v_mfma_f32_16x16x32_bf16 v[84:87], a[172:175], v[116:119], v[84:87]
    s_waitcnt lgkmcnt(5)
    ds_read_b64_tr_b16 v[114:115], v226 offset:14336
    v_add_f32 v164, v164, v166
    v_mfma_f32_16x16x32_bf16 v[88:91], a[176:179], v[116:119], v[88:91]
    buffer_load_dwordx4 a[140:143], v240, s[36:39], s72 offen offset:3072 sc1
    v_mfma_f32_16x16x32_bf16 v[100:103], a[176:179], v[120:123], v[100:103]
    ds_read_b64_tr_b16 v[116:117], v227 offset:12288
    v_add_f32 v168, v168, v170
    v_mfma_f32_16x16x32_bf16 v[96:99], a[172:175], v[120:123], v[96:99]
    s_waitcnt lgkmcnt(5)
    ds_read_b64_tr_b16 v[118:119], v227 offset:14336
    v_add_f32 v165, v165, v167
    v_mfma_f32_16x16x32_bf16 v[92:95], a[168:171], v[120:123], v[92:95]
    buffer_load_dwordx4 a[144:147], v240, s[36:39], s73 offen offset:0 sc1
    v_mfma_f32_16x16x32_bf16 v[56:59], a[180:183], v[104:107], v[56:59]
    ds_read_b64_tr_b16 v[120:121], v224 offset:16384
    v_add_f32 v169, v169, v171
    v_mfma_f32_16x16x32_bf16 v[60:63], a[184:187], v[104:107], v[60:63]
    s_waitcnt lgkmcnt(5)
    ds_read_b64_tr_b16 v[122:123], v224 offset:18432
    v_add_f32 v164, v164, v168
    v_mfma_f32_16x16x32_bf16 v[64:67], a[188:191], v[104:107], v[64:67]
    v_add_f32 v165, v165, v169
    v_mul_f32 v148, 3133983949, v164
    v_mfma_f32_16x16x32_bf16 v[76:79], a[188:191], v[108:111], v[76:79]
    ds_read_b64_tr_b16 v[104:105], v225 offset:16384
    v_mul_f32 v165, 3133983949, v165
    v_mfma_f32_16x16x32_bf16 v[72:75], a[184:187], v[108:111], v[72:75]
    s_waitcnt lgkmcnt(5)
    ds_read_b64_tr_b16 v[106:107], v225 offset:18432
    v_fma_f32 v165, -v148, v148, v165
    v_mfma_f32_16x16x32_bf16 v[68:71], a[180:183], v[108:111], v[68:71]
    buffer_load_dwordx4 a[148:151], v240, s[36:39], s73 offen offset:1024 sc1
    v_max_f32 v165, 0, v165
    v_mfma_f32_16x16x32_bf16 v[80:83], a[180:183], v[112:115], v[80:83]
    ds_read_b64_tr_b16 v[108:109], v226 offset:16384
    v_add_f32 v156, 925353388, v165
    v_mfma_f32_16x16x32_bf16 v[84:87], a[184:187], v[112:115], v[84:87]
    s_waitcnt lgkmcnt(5)
    ds_read_b64_tr_b16 v[110:111], v226 offset:18432
    v_mfma_f32_16x16x32_bf16 v[88:91], a[188:191], v[112:115], v[88:91]
    buffer_load_dwordx4 a[152:155], v240, s[36:39], s73 offen offset:2048 sc1
    v_mfma_f32_16x16x32_bf16 v[100:103], a[188:191], v[116:119], v[100:103]
    ds_read_b64_tr_b16 v[112:113], v227 offset:16384
    v_mfma_f32_16x16x32_bf16 v[96:99], a[184:187], v[116:119], v[96:99]
    s_waitcnt lgkmcnt(5)
    ds_read_b64_tr_b16 v[114:115], v227 offset:18432
    v_mfma_f32_16x16x32_bf16 v[92:95], a[180:183], v[116:119], v[92:95]
    v_rsq_f32 v166, v156
    v_mfma_f32_16x16x32_bf16 v[56:59], a[192:195], v[120:123], v[56:59]
    ds_read_b64_tr_b16 v[116:117], v224 offset:20480
    v_mul_f32 v152, 3216550459, v166
    v_mfma_f32_16x16x32_bf16 v[60:63], a[196:199], v[120:123], v[60:63]
    s_waitcnt lgkmcnt(5)
    ds_read_b64_tr_b16 v[118:119], v224 offset:22528
    v_mov_b32 v150, v148
    v_mfma_f32_16x16x32_bf16 v[64:67], a[200:203], v[120:123], v[64:67]
    buffer_load_dwordx4 a[156:159], v240, s[36:39], s73 offen offset:3072 sc1
    v_mfma_f32_16x16x32_bf16 v[76:79], a[200:203], v[104:107], v[76:79]
    ds_read_b64_tr_b16 v[120:121], v225 offset:20480
    v_permlane32_swap_b32 v148, v150
    v_mfma_f32_16x16x32_bf16 v[72:75], a[196:199], v[104:107], v[72:75]
    s_waitcnt lgkmcnt(5)
    ds_read_b64_tr_b16 v[122:123], v225 offset:22528
    v_mov_b32 v149, v148
    v_mfma_f32_16x16x32_bf16 v[68:71], a[192:195], v[104:107], v[68:71]
    buffer_load_dwordx4 a[160:163], v240, s[36:39], s74 offen offset:0 sc1
    v_mfma_f32_16x16x32_bf16 v[80:83], a[192:195], v[108:111], v[80:83]
    ds_read_b64_tr_b16 v[104:105], v226 offset:20480
    v_mov_b32 v151, v150
    v_mfma_f32_16x16x32_bf16 v[84:87], a[196:199], v[108:111], v[84:87]
    s_waitcnt lgkmcnt(5)
    ds_read_b64_tr_b16 v[106:107], v226 offset:22528
    v_mov_b32 v158, v156
    v_mfma_f32_16x16x32_bf16 v[88:91], a[200:203], v[108:111], v[88:91]
    v_permlane16_swap_b32 v148, v149
    v_mfma_f32_16x16x32_bf16 v[100:103], a[200:203], v[112:115], v[100:103]
    ds_read_b64_tr_b16 v[108:109], v227 offset:20480
    v_mov_b32 v154, v152
    v_mfma_f32_16x16x32_bf16 v[96:99], a[196:199], v[112:115], v[96:99]
    s_waitcnt lgkmcnt(5)
    ds_read_b64_tr_b16 v[110:111], v227 offset:22528
    v_mfma_f32_16x16x32_bf16 v[92:95], a[192:195], v[112:115], v[92:95]
    buffer_load_dwordx4 a[164:167], v240, s[36:39], s74 offen offset:1024 sc1
    v_mfma_f32_16x16x32_bf16 v[56:59], a[204:207], v[116:119], v[56:59]
    ds_read_b64_tr_b16 v[112:113], v224 offset:24576
    v_mfma_f32_16x16x32_bf16 v[60:63], a[208:211], v[116:119], v[60:63]
    s_waitcnt lgkmcnt(5)
    ds_read_b64_tr_b16 v[114:115], v224 offset:26624
    v_permlane16_swap_b32 v150, v151
    v_mfma_f32_16x16x32_bf16 v[64:67], a[212:215], v[116:119], v[64:67]
    buffer_load_dwordx4 a[168:171], v240, s[36:39], s74 offen offset:2048 sc1
    v_mfma_f32_16x16x32_bf16 v[76:79], a[212:215], v[120:123], v[76:79]
    ds_read_b64_tr_b16 v[116:117], v225 offset:24576
    v_mfma_f32_16x16x32_bf16 v[72:75], a[208:211], v[120:123], v[72:75]
    s_waitcnt lgkmcnt(5)
    ds_read_b64_tr_b16 v[118:119], v225 offset:26624
    v_mfma_f32_16x16x32_bf16 v[68:71], a[204:207], v[120:123], v[68:71]
    v_permlane32_swap_b32 v156, v158
    v_mfma_f32_16x16x32_bf16 v[80:83], a[204:207], v[104:107], v[80:83]
    ds_read_b64_tr_b16 v[120:121], v226 offset:24576
    v_mov_b32 v157, v156
    v_mfma_f32_16x16x32_bf16 v[84:87], a[208:211], v[104:107], v[84:87]
    s_waitcnt lgkmcnt(5)
    ds_read_b64_tr_b16 v[122:123], v226 offset:26624
    v_mov_b32 v159, v158
    v_mfma_f32_16x16x32_bf16 v[88:91], a[212:215], v[104:107], v[88:91]
    buffer_load_dword v5, v255, s[36:39], s35 offen offset:128 sc1
    v_mfma_f32_16x16x32_bf16 v[100:103], a[212:215], v[108:111], v[100:103]
    ds_read_b64_tr_b16 v[104:105], v227 offset:24576
    v_mfma_f32_16x16x32_bf16 v[96:99], a[208:211], v[108:111], v[96:99]
    s_waitcnt lgkmcnt(5)
    ds_read_b64_tr_b16 v[106:107], v227 offset:26624
    v_mfma_f32_16x16x32_bf16 v[92:95], a[204:207], v[108:111], v[92:95]
    buffer_load_dwordx4 a[172:175], v240, s[36:39], s74 offen offset:3072 sc1
    v_mfma_f32_16x16x32_bf16 v[56:59], a[216:219], v[112:115], v[56:59]
    ds_read_b64_tr_b16 v[108:109], v224 offset:28672
    v_permlane16_swap_b32 v156, v157
    v_mfma_f32_16x16x32_bf16 v[60:63], a[220:223], v[112:115], v[60:63]
    s_waitcnt lgkmcnt(5)
    ds_read_b64_tr_b16 v[110:111], v224 offset:30720
    v_mfma_f32_16x16x32_bf16 v[64:67], a[224:227], v[112:115], v[64:67]
    buffer_load_dwordx4 a[176:179], v240, s[36:39], s75 offen offset:0 sc1
    v_mfma_f32_16x16x32_bf16 v[76:79], a[224:227], v[116:119], v[76:79]
    ds_read_b64_tr_b16 v[112:113], v225 offset:28672
    v_mfma_f32_16x16x32_bf16 v[72:75], a[220:223], v[116:119], v[72:75]
    s_waitcnt lgkmcnt(5)
    ds_read_b64_tr_b16 v[114:115], v225 offset:30720
    v_mfma_f32_16x16x32_bf16 v[68:71], a[216:219], v[116:119], v[68:71]
    buffer_load_dwordx4 a[180:183], v240, s[36:39], s75 offen offset:1024 sc1
    v_mfma_f32_16x16x32_bf16 v[80:83], a[216:219], v[120:123], v[80:83]
    ds_read_b64_tr_b16 v[116:117], v226 offset:28672
    v_mfma_f32_16x16x32_bf16 v[84:87], a[220:223], v[120:123], v[84:87]
    s_waitcnt lgkmcnt(5)
    ds_read_b64_tr_b16 v[118:119], v226 offset:30720
    v_mfma_f32_16x16x32_bf16 v[88:91], a[224:227], v[120:123], v[88:91]
    v_permlane16_swap_b32 v158, v159
    v_mfma_f32_16x16x32_bf16 v[100:103], a[224:227], v[104:107], v[100:103]
    ds_read_b64_tr_b16 v[120:121], v227 offset:28672
    v_mfma_f32_16x16x32_bf16 v[96:99], a[220:223], v[104:107], v[96:99]
    s_waitcnt lgkmcnt(5)
    ds_read_b64_tr_b16 v[122:123], v227 offset:30720
    v_permlane32_swap_b32 v152, v154
    v_mfma_f32_16x16x32_bf16 v[92:95], a[216:219], v[104:107], v[92:95]
    buffer_load_dwordx4 a[184:187], v240, s[36:39], s75 offen offset:2048 sc1
    v_mfma_f32_16x16x32_bf16 v[56:59], a[228:231], v[108:111], v[56:59]
    v_mov_b32 v153, v152
    v_mov_b32 v155, v154
    v_mfma_f32_16x16x32_bf16 v[60:63], a[232:235], v[108:111], v[60:63]
    s_waitcnt lgkmcnt(4)
    buffer_load_dwordx4 a[188:191], v240, s[36:39], s75 offen offset:3072 sc1
    v_mfma_f32_16x16x32_bf16 v[64:67], a[236:239], v[108:111], v[64:67]
    v_permlane16_swap_b32 v152, v153
    v_mfma_f32_16x16x32_bf16 v[76:79], a[236:239], v[112:115], v[76:79]
    v_permlane16_swap_b32 v154, v155
    v_mfma_f32_16x16x32_bf16 v[72:75], a[232:235], v[112:115], v[72:75]
    s_waitcnt lgkmcnt(2)
    v_mfma_f32_16x16x32_bf16 v[68:71], a[228:231], v[112:115], v[68:71]
    v_mfma_f32_16x16x32_bf16 v[80:83], a[228:231], v[116:119], v[80:83]
    v_mfma_f32_16x16x32_bf16 v[84:87], a[232:235], v[116:119], v[84:87]
    s_waitcnt lgkmcnt(0)
    v_mfma_f32_16x16x32_bf16 v[88:91], a[236:239], v[116:119], v[88:91]
    v_mfma_f32_16x16x32_bf16 v[100:103], a[236:239], v[120:123], v[100:103]
    v_mfma_f32_16x16x32_bf16 v[96:99], a[232:235], v[120:123], v[96:99]
    v_mfma_f32_16x16x32_bf16 v[92:95], a[228:231], v[120:123], v[92:95]
    buffer_load_dwordx4 a[192:195], v240, s[36:39], s76 offen offset:0 sc1
    buffer_load_dwordx4 a[196:199], v240, s[36:39], s76 offen offset:1024 sc1
    buffer_load_dwordx4 a[200:203], v240, s[36:39], s76 offen offset:2048 sc1
    buffer_load_dwordx4 a[204:207], v240, s[36:39], s76 offen offset:3072 sc1
    v_pk_fma_f32 v[64:65], v[148:149], v[144:145], v[64:65] op_sel:[0,0,0] op_sel_hi:[0,1,1]
    v_pk_fma_f32 v[76:77], v[148:149], v[144:145], v[76:77] op_sel:[1,0,0] op_sel_hi:[1,1,1]
    v_pk_fma_f32 v[88:89], v[150:151], v[144:145], v[88:89] op_sel:[0,0,0] op_sel_hi:[0,1,1]
    v_pk_fma_f32 v[100:101], v[150:151], v[144:145], v[100:101] op_sel:[1,0,0] op_sel_hi:[1,1,1]
    v_pk_fma_f32 v[66:67], v[148:149], v[146:147], v[66:67] op_sel:[0,0,0] op_sel_hi:[0,1,1]
    v_pk_fma_f32 v[78:79], v[148:149], v[146:147], v[78:79] op_sel:[1,0,0] op_sel_hi:[1,1,1]
    v_pk_fma_f32 v[90:91], v[150:151], v[146:147], v[90:91] op_sel:[0,0,0] op_sel_hi:[0,1,1]
    v_pk_fma_f32 v[102:103], v[150:151], v[146:147], v[102:103] op_sel:[1,0,0] op_sel_hi:[1,1,1]
    v_permlane32_swap_b32 v64, v66
    v_permlane32_swap_b32 v76, v78
    v_permlane32_swap_b32 v88, v90
    v_permlane32_swap_b32 v100, v102
    v_permlane32_swap_b32 v65, v67
    v_permlane32_swap_b32 v77, v79
    v_permlane32_swap_b32 v89, v91
    v_permlane32_swap_b32 v101, v103
    v_pk_mul_f32 v[160:161], v[64:65], v[152:153] op_sel:[0,0] op_sel_hi:[1,0]
    v_pk_mul_f32 v[162:163], v[76:77], v[152:153] op_sel:[0,1] op_sel_hi:[1,1]
    v_pk_mul_f32 v[164:165], v[88:89], v[154:155] op_sel:[0,0] op_sel_hi:[1,0]
    v_pk_mul_f32 v[166:167], v[100:101], v[154:155] op_sel:[0,1] op_sel_hi:[1,1]
    v_pk_mul_f32 v[64:65], v[64:65], v[66:67]
    v_pk_mul_f32 v[76:77], v[76:77], v[78:79]
    v_pk_mul_f32 v[88:89], v[88:89], v[90:91]
    v_pk_mul_f32 v[100:101], v[100:101], v[102:103]
    v_exp_f32 v160, v160
    v_exp_f32 v162, v162
    v_exp_f32 v164, v164
    v_exp_f32 v166, v166
    v_exp_f32 v161, v161
    v_exp_f32 v163, v163
    v_exp_f32 v165, v165
    v_exp_f32 v167, v167
    v_pk_fma_f32 v[160:161], v[160:161], v[156:157], v[156:157] op_sel:[0,0,0] op_sel_hi:[1,0,0]
    v_pk_fma_f32 v[162:163], v[162:163], v[156:157], v[156:157] op_sel:[0,1,1] op_sel_hi:[1,1,1]
    v_pk_fma_f32 v[164:165], v[164:165], v[158:159], v[158:159] op_sel:[0,0,0] op_sel_hi:[1,0,0]
    v_pk_fma_f32 v[166:167], v[166:167], v[158:159], v[158:159] op_sel:[0,1,1] op_sel_hi:[1,1,1]
    v_rcp_f32 v160, v160
    v_rcp_f32 v162, v162
    v_rcp_f32 v164, v164
    v_rcp_f32 v166, v166
    v_rcp_f32 v161, v161
    v_rcp_f32 v163, v163
    v_rcp_f32 v165, v165
    v_rcp_f32 v167, v167
    v_pk_mul_f32 v[64:65], v[64:65], v[160:161]
    v_pk_mul_f32 v[76:77], v[76:77], v[162:163]
    v_pk_mul_f32 v[88:89], v[88:89], v[164:165]
    v_pk_mul_f32 v[100:101], v[100:101], v[166:167]
    v_cvt_pk_bf16_f32 v180, v64, v65
    v_cvt_pk_bf16_f32 v181, v76, v77
    v_cvt_pk_bf16_f32 v182, v88, v89
    v_cvt_pk_bf16_f32 v183, v100, v101
    v_pk_fma_f32 v[56:57], v[148:149], v[136:137], v[56:57] op_sel:[0,0,0] op_sel_hi:[0,1,1]
    v_pk_fma_f32 v[68:69], v[148:149], v[136:137], v[68:69] op_sel:[1,0,0] op_sel_hi:[1,1,1]
    v_permlane32_swap_b32 v180, v182
    v_permlane32_swap_b32 v181, v183
    v_pk_fma_f32 v[80:81], v[150:151], v[136:137], v[80:81] op_sel:[0,0,0] op_sel_hi:[0,1,1]
    v_pk_fma_f32 v[92:93], v[150:151], v[136:137], v[92:93] op_sel:[1,0,0] op_sel_hi:[1,1,1]
    v_permlane16_swap_b32 v180, v181
    v_permlane16_swap_b32 v182, v183
    v_pk_fma_f32 v[60:61], v[148:149], v[140:141], v[60:61] op_sel:[0,0,0] op_sel_hi:[0,1,1]
    buffer_store_dwordx4 v[180:183], v236, s[36:39], s34 offen offset:1024 sc1
    s_waitcnt vmcnt(10)
    v_cmp_gt_u32 vcc, 16, v5
    s_nop 0
    s_and_b64 vcc, vcc, s[58:59]
    s_cbranch_scc1 L_spin_29
L_back_30:
    s_barrier
    buffer_load_dwordx4 v[8:11], v237, s[36:39], s64 offen offset:0 sc1
    buffer_load_dwordx4 v[12:15], v237, s[36:39], s64 offen offset:256 sc1
    buffer_load_dwordx4 v[16:19], v237, s[36:39], s64 offen offset:2048 sc1
    buffer_load_dwordx4 v[20:23], v237, s[36:39], s64 offen offset:2304 sc1
    v_pk_fma_f32 v[72:73], v[148:149], v[140:141], v[72:73] op_sel:[1,0,0] op_sel_hi:[1,1,1]
    v_pk_fma_f32 v[84:85], v[150:151], v[140:141], v[84:85] op_sel:[0,0,0] op_sel_hi:[0,1,1]
    v_pk_fma_f32 v[96:97], v[150:151], v[140:141], v[96:97] op_sel:[1,0,0] op_sel_hi:[1,1,1]
    v_pk_mul_f32 v[160:161], v[56:57], v[152:153] op_sel:[0,0] op_sel_hi:[1,0]
    v_pk_mul_f32 v[162:163], v[68:69], v[152:153] op_sel:[0,1] op_sel_hi:[1,1]
    v_pk_mul_f32 v[164:165], v[80:81], v[154:155] op_sel:[0,0] op_sel_hi:[1,0]
    v_pk_mul_f32 v[166:167], v[92:93], v[154:155] op_sel:[0,1] op_sel_hi:[1,1]
    v_pk_mul_f32 v[56:57], v[56:57], v[60:61]
    v_pk_mul_f32 v[68:69], v[68:69], v[72:73]
    v_pk_mul_f32 v[80:81], v[80:81], v[84:85]
    v_pk_mul_f32 v[92:93], v[92:93], v[96:97]
    v_exp_f32 v160, v160
    v_exp_f32 v162, v162
    v_exp_f32 v164, v164
    v_exp_f32 v166, v166
    v_exp_f32 v161, v161
    v_exp_f32 v163, v163
    v_exp_f32 v165, v165
    v_exp_f32 v167, v167
    v_pk_fma_f32 v[160:161], v[160:161], v[156:157], v[156:157] op_sel:[0,0,0] op_sel_hi:[1,0,0]
    v_pk_fma_f32 v[162:163], v[162:163], v[156:157], v[156:157] op_sel:[0,1,1] op_sel_hi:[1,1,1]
    v_pk_fma_f32 v[164:165], v[164:165], v[158:159], v[158:159] op_sel:[0,0,0] op_sel_hi:[1,0,0]
    v_pk_fma_f32 v[166:167], v[166:167], v[158:159], v[158:159] op_sel:[0,1,1] op_sel_hi:[1,1,1]
    v_rcp_f32 v160, v160
    v_rcp_f32 v162, v162
    v_rcp_f32 v164, v164
    v_rcp_f32 v166, v166
    v_rcp_f32 v161, v161
    v_rcp_f32 v163, v163
    v_rcp_f32 v165, v165
    v_rcp_f32 v167, v167
    v_pk_mul_f32 v[56:57], v[56:57], v[160:161]
    v_pk_mul_f32 v[68:69], v[68:69], v[162:163]
    v_pk_mul_f32 v[80:81], v[80:81], v[164:165]
    v_pk_mul_f32 v[92:93], v[92:93], v[166:167]
    v_cvt_pk_bf16_f32 v172, v56, v57
    v_cvt_pk_bf16_f32 v173, v68, v69
    v_cvt_pk_bf16_f32 v174, v80, v81
    v_cvt_pk_bf16_f32 v175, v92, v93
    v_pk_fma_f32 v[58:59], v[148:149], v[138:139], v[58:59] op_sel:[0,0,0] op_sel_hi:[0,1,1]
    v_pk_fma_f32 v[70:71], v[148:149], v[138:139], v[70:71] op_sel:[1,0,0] op_sel_hi:[1,1,1]
    v_permlane32_swap_b32 v172, v174
    v_permlane32_swap_b32 v173, v175
    v_pk_fma_f32 v[82:83], v[150:151], v[138:139], v[82:83] op_sel:[0,0,0] op_sel_hi:[0,1,1]
    v_pk_fma_f32 v[94:95], v[150:151], v[138:139], v[94:95] op_sel:[1,0,0] op_sel_hi:[1,1,1]
    v_permlane16_swap_b32 v172, v173
    v_permlane16_swap_b32 v174, v175
    v_pk_fma_f32 v[62:63], v[148:149], v[142:143], v[62:63] op_sel:[0,0,0] op_sel_hi:[0,1,1]
    buffer_store_dwordx4 v[172:175], v236, s[36:39], s34 offen offset:0 sc1
    buffer_load_dwordx4 v[24:27], v237, s[36:39], s65 offen offset:0 sc1
    buffer_load_dwordx4 v[28:31], v237, s[36:39], s65 offen offset:256 sc1
    buffer_load_dwordx4 v[32:35], v237, s[36:39], s65 offen offset:2048 sc1
    buffer_load_dwordx4 v[36:39], v237, s[36:39], s65 offen offset:2304 sc1
    v_pk_fma_f32 v[74:75], v[148:149], v[142:143], v[74:75] op_sel:[1,0,0] op_sel_hi:[1,1,1]
    v_pk_fma_f32 v[86:87], v[150:151], v[142:143], v[86:87] op_sel:[0,0,0] op_sel_hi:[0,1,1]
    v_pk_fma_f32 v[98:99], v[150:151], v[142:143], v[98:99] op_sel:[1,0,0] op_sel_hi:[1,1,1]
    v_pk_mul_f32 v[160:161], v[58:59], v[152:153] op_sel:[0,0] op_sel_hi:[1,0]
    v_pk_mul_f32 v[162:163], v[70:71], v[152:153] op_sel:[0,1] op_sel_hi:[1,1]
    v_pk_mul_f32 v[164:165], v[82:83], v[154:155] op_sel:[0,0] op_sel_hi:[1,0]
    v_pk_mul_f32 v[166:167], v[94:95], v[154:155] op_sel:[0,1] op_sel_hi:[1,1]
    v_pk_mul_f32 v[58:59], v[58:59], v[62:63]
    v_pk_mul_f32 v[70:71], v[70:71], v[74:75]
    v_pk_mul_f32 v[82:83], v[82:83], v[86:87]
    v_pk_mul_f32 v[94:95], v[94:95], v[98:99]
    v_exp_f32 v160, v160
    v_exp_f32 v162, v162
    v_exp_f32 v164, v164
    v_exp_f32 v166, v166
    v_exp_f32 v161, v161
    v_exp_f32 v163, v163
    v_exp_f32 v165, v165
    v_exp_f32 v167, v167
    v_pk_fma_f32 v[160:161], v[160:161], v[156:157], v[156:157] op_sel:[0,0,0] op_sel_hi:[1,0,0]
    v_pk_fma_f32 v[162:163], v[162:163], v[156:157], v[156:157] op_sel:[0,1,1] op_sel_hi:[1,1,1]
    v_pk_fma_f32 v[164:165], v[164:165], v[158:159], v[158:159] op_sel:[0,0,0] op_sel_hi:[1,0,0]
    v_pk_fma_f32 v[166:167], v[166:167], v[158:159], v[158:159] op_sel:[0,1,1] op_sel_hi:[1,1,1]
    v_rcp_f32 v160, v160
    v_rcp_f32 v162, v162
    v_rcp_f32 v164, v164
    v_rcp_f32 v166, v166
    v_rcp_f32 v161, v161
    v_rcp_f32 v163, v163
    v_rcp_f32 v165, v165
    v_rcp_f32 v167, v167
    v_pk_mul_f32 v[58:59], v[58:59], v[160:161]
    v_pk_mul_f32 v[70:71], v[70:71], v[162:163]
    v_pk_mul_f32 v[82:83], v[82:83], v[164:165]
    v_pk_mul_f32 v[94:95], v[94:95], v[166:167]
    v_cvt_pk_bf16_f32 v176, v58, v59
    v_cvt_pk_bf16_f32 v177, v70, v71
    v_cvt_pk_bf16_f32 v178, v82, v83
    v_cvt_pk_bf16_f32 v179, v94, v95
    s_nop 0
    v_permlane32_swap_b32 v176, v178
    v_permlane32_swap_b32 v177, v179
    s_nop 1
    v_permlane16_swap_b32 v176, v177
    v_permlane16_swap_b32 v178, v179
    buffer_store_dwordx4 v[176:179], v236, s[36:39], s34 offen offset:512 sc1
    s_waitcnt vmcnt(9)
    v_mfma_f32_16x16x32_bf16 v[56:59], a[0:3], v[8:11], 0
    buffer_load_dwordx4 v[40:43], v237, s[36:39], s66 offen offset:0 sc1
    v_mfma_f32_16x16x32_bf16 v[60:63], a[4:7], v[8:11], 0
    v_mfma_f32_16x16x32_bf16 v[64:67], a[8:11], v[8:11], 0
    v_mfma_f32_16x16x32_bf16 v[68:71], a[12:15], v[8:11], 0
    buffer_load_dwordx4 v[44:47], v237, s[36:39], s66 offen offset:256 sc1
    v_mfma_f32_16x16x32_bf16 v[72:75], a[16:19], v[8:11], 0
    s_waitcnt vmcnt(10)
    v_mfma_f32_16x16x32_bf16 v[92:95], a[16:19], v[12:15], 0
    v_mfma_f32_16x16x32_bf16 v[88:91], a[12:15], v[12:15], 0
    v_mfma_f32_16x16x32_bf16 v[84:87], a[8:11], v[12:15], 0
    buffer_load_dwordx4 v[48:51], v237, s[36:39], s66 offen offset:2048 sc1
    v_mfma_f32_16x16x32_bf16 v[80:83], a[4:7], v[12:15], 0
    v_mfma_f32_16x16x32_bf16 v[76:79], a[0:3], v[12:15], 0
    s_waitcnt vmcnt(10)
    v_mfma_f32_16x16x32_bf16 v[56:59], a[20:23], v[16:19], v[56:59]
    buffer_load_dwordx4 v[52:55], v237, s[36:39], s66 offen offset:2304 sc1
    v_mfma_f32_16x16x32_bf16 v[60:63], a[24:27], v[16:19], v[60:63]
    v_mfma_f32_16x16x32_bf16 v[64:67], a[28:31], v[16:19], v[64:67]
    v_mfma_f32_16x16x32_bf16 v[68:71], a[32:35], v[16:19], v[68:71]
    v_mfma_f32_16x16x32_bf16 v[72:75], a[36:39], v[16:19], v[72:75]
    s_waitcnt vmcnt(10)
    buffer_load_dwordx4 v[184:187], v237, s[36:39], s67 offen offset:0 sc1
    v_mfma_f32_16x16x32_bf16 v[92:95], a[36:39], v[20:23], v[92:95]
    v_mfma_f32_16x16x32_bf16 v[88:91], a[32:35], v[20:23], v[88:91]
    v_mfma_f32_16x16x32_bf16 v[84:87], a[28:31], v[20:23], v[84:87]
    buffer_load_dwordx4 v[188:191], v237, s[36:39], s67 offen offset:256 sc1
    v_mfma_f32_16x16x32_bf16 v[80:83], a[24:27], v[20:23], v[80:83]
    v_mfma_f32_16x16x32_bf16 v[76:79], a[20:23], v[20:23], v[76:79]
    s_waitcnt vmcnt(10)
    v_mfma_f32_16x16x32_bf16 v[56:59], a[40:43], v[24:27], v[56:59]
    v_mfma_f32_16x16x32_bf16 v[60:63], a[44:47], v[24:27], v[60:63]
    buffer_load_dwordx4 v[192:195], v237, s[36:39], s67 offen offset:2048 sc1
    v_mfma_f32_16x16x32_bf16 v[64:67], a[48:51], v[24:27], v[64:67]
    v_mfma_f32_16x16x32_bf16 v[68:71], a[52:55], v[24:27], v[68:71]
    v_mfma_f32_16x16x32_bf16 v[72:75], a[56:59], v[24:27], v[72:75]
    s_waitcnt vmcnt(10)
    buffer_load_dwordx4 v[196:199], v237, s[36:39], s67 offen offset:2304 sc1
    v_mfma_f32_16x16x32_bf16 v[92:95], a[56:59], v[28:31], v[92:95]
    v_mfma_f32_16x16x32_bf16 v[88:91], a[52:55], v[28:31], v[88:91]
    v_mfma_f32_16x16x32_bf16 v[84:87], a[48:51], v[28:31], v[84:87]
    v_mfma_f32_16x16x32_bf16 v[80:83], a[44:47], v[28:31], v[80:83]
    buffer_load_dwordx4 v[200:203], v237, s[36:39], s68 offen offset:0 sc1
    v_mfma_f32_16x16x32_bf16 v[76:79], a[40:43], v[28:31], v[76:79]
    s_waitcnt vmcnt(11)
    v_mfma_f32_16x16x32_bf16 v[56:59], a[60:63], v[32:35], v[56:59]
    v_mfma_f32_16x16x32_bf16 v[60:63], a[64:67], v[32:35], v[60:63]
    buffer_load_dwordx4 v[204:207], v237, s[36:39], s68 offen offset:256 sc1
    v_mfma_f32_16x16x32_bf16 v[64:67], a[68:71], v[32:35], v[64:67]
    v_mfma_f32_16x16x32_bf16 v[68:71], a[72:75], v[32:35], v[68:71]
    v_mfma_f32_16x16x32_bf16 v[72:75], a[76:79], v[32:35], v[72:75]
    s_waitcnt vmcnt(11)
    v_mfma_f32_16x16x32_bf16 v[92:95], a[76:79], v[36:39], v[92:95]
    buffer_load_dwordx4 v[208:211], v237, s[36:39], s68 offen offset:2048 sc1
    v_mfma_f32_16x16x32_bf16 v[88:91], a[72:75], v[36:39], v[88:91]
    v_mfma_f32_16x16x32_bf16 v[84:87], a[68:71], v[36:39], v[84:87]
    s_waitcnt vmcnt(11)
    s_barrier
    s_add_u32 s35, s35, 4096
    buffer_atomic_add v4, v2, s[36:39], s35 offen offset:128 sc1
    v_mfma_f32_16x16x32_bf16 v[80:83], a[64:67], v[36:39], v[80:83]
    buffer_load_dwordx4 v[104:107], v237, s[36:39], s68 offen offset:2304 sc1
    v_mfma_f32_16x16x32_bf16 v[76:79], a[60:63], v[36:39], v[76:79]
    s_waitcnt vmcnt(12)
    v_mfma_f32_16x16x32_bf16 v[56:59], a[80:83], v[40:43], v[56:59]
    v_mfma_f32_16x16x32_bf16 v[60:63], a[84:87], v[40:43], v[60:63]
    v_mfma_f32_16x16x32_bf16 v[64:67], a[88:91], v[40:43], v[64:67]
    buffer_load_dwordx4 v[108:111], v237, s[36:39], s69 offen offset:0 sc1
    v_mfma_f32_16x16x32_bf16 v[68:71], a[92:95], v[40:43], v[68:71]
    v_mfma_f32_16x16x32_bf16 v[72:75], a[96:99], v[40:43], v[72:75]
    s_waitcnt vmcnt(12)
    v_mfma_f32_16x16x32_bf16 v[92:95], a[96:99], v[44:47], v[92:95]
    buffer_load_dwordx4 a[208:211], v240, s[36:39], s77 offen offset:0 sc1
    v_mfma_f32_16x16x32_bf16 v[88:91], a[92:95], v[44:47], v[88:91]
    v_mfma_f32_16x16x32_bf16 v[84:87], a[88:91], v[44:47], v[84:87]
    v_mfma_f32_16x16x32_bf16 v[80:83], a[84:87], v[44:47], v[80:83]
    v_mfma_f32_16x16x32_bf16 v[76:79], a[80:83], v[44:47], v[76:79]
    s_waitcnt vmcnt(12)
    buffer_load_dwordx4 a[212:215], v240, s[36:39], s77 offen offset:1024 sc1
    v_mfma_f32_16x16x32_bf16 v[56:59], a[100:103], v[48:51], v[56:59]
    v_lshlrev_b32 v212, 16, v124
    v_and_b32 v213, 0xffff0000, v124
    v_mfma_f32_16x16x32_bf16 v[60:63], a[104:107], v[48:51], v[60:63]
    v_lshlrev_b32 v214, 16, v125
    v_and_b32 v215, 0xffff0000, v125
    v_mfma_f32_16x16x32_bf16 v[64:67], a[108:111], v[48:51], v[64:67]
    buffer_load_dwordx4 a[216:219], v240, s[36:39], s77 offen offset:2048 sc1
    v_mfma_f32_16x16x32_bf16 v[68:71], a[112:115], v[48:51], v[68:71]
    v_lshlrev_b32 v216, 16, v126
    v_and_b32 v217, 0xffff0000, v126
    v_mfma_f32_16x16x32_bf16 v[72:75], a[116:119], v[48:51], v[72:75]
    s_waitcnt vmcnt(13)
    v_lshlrev_b32 v218, 16, v127
    v_and_b32 v219, 0xffff0000, v127
    v_mfma_f32_16x16x32_bf16 v[92:95], a[116:119], v[52:55], v[92:95]
    v_lshlrev_b32 v220, 16, v128
    v_and_b32 v221, 0xffff0000, v128
    v_mfma_f32_16x16x32_bf16 v[88:91], a[112:115], v[52:55], v[88:91]
    buffer_load_dwordx4 v[112:115], v237, s[36:39], s69 offen offset:256 sc1
    v_mfma_f32_16x16x32_bf16 v[84:87], a[108:111], v[52:55], v[84:87]
    v_lshlrev_b32 v222, 16, v129
    v_and_b32 v223, 0xffff0000, v129
    v_mfma_f32_16x16x32_bf16 v[80:83], a[104:107], v[52:55], v[80:83]
    v_mfma_f32_16x16x32_bf16 v[76:79], a[100:103], v[52:55], v[76:79]
    s_waitcnt vmcnt(13)
    buffer_load_dwordx4 v[116:119], v237, s[36:39], s69 offen offset:2048 sc1
    v_mfma_f32_16x16x32_bf16 v[56:59], a[120:123], v[184:187], v[56:59]
    v_mfma_f32_16x16x32_bf16 v[60:63], a[124:127], v[184:187], v[60:63]
    v_mfma_f32_16x16x32_bf16 v[64:67], a[128:131], v[184:187], v[64:67]
    v_mfma_f32_16x16x32_bf16 v[68:71], a[132:135], v[184:187], v[68:71]
    buffer_load_dwordx4 a[220:223], v240, s[36:39], s77 offen offset:3072 sc1
    v_mfma_f32_16x16x32_bf16 v[72:75], a[136:139], v[184:187], v[72:75]
    s_waitcnt vmcnt(14)
    v_mfma_f32_16x16x32_bf16 v[92:95], a[136:139], v[188:191], v[92:95]
    v_mfma_f32_16x16x32_bf16 v[88:91], a[132:135], v[188:191], v[88:91]
    buffer_load_dwordx4 a[224:227], v240, s[36:39], s78 offen offset:0 sc1
    v_mfma_f32_16x16x32_bf16 v[84:87], a[128:131], v[188:191], v[84:87]
    v_mfma_f32_16x16x32_bf16 v[80:83], a[124:127], v[188:191], v[80:83]
    v_mfma_f32_16x16x32_bf16 v[76:79], a[120:123], v[188:191], v[76:79]
    s_waitcnt vmcnt(14)
    v_mfma_f32_16x16x32_bf16 v[56:59], a[140:143], v[192:195], v[56:59]
    buffer_load_dwordx4 a[228:231], v240, s[36:39], s78 offen offset:1024 sc1
    v_mfma_f32_16x16x32_bf16 v[60:63], a[144:147], v[192:195], v[60:63]
    v_mfma_f32_16x16x32_bf16 v[64:67], a[148:151], v[192:195], v[64:67]
    v_mfma_f32_16x16x32_bf16 v[68:71], a[152:155], v[192:195], v[68:71]
    buffer_load_dwordx4 a[232:235], v240, s[36:39], s78 offen offset:2048 sc1
    v_mfma_f32_16x16x32_bf16 v[72:75], a[156:159], v[192:195], v[72:75]
    s_waitcnt vmcnt(15)
    v_mfma_f32_16x16x32_bf16 v[92:95], a[156:159], v[196:199], v[92:95]
    buffer_load_dword v5, v255, s[36:39], s35 offen offset:128 sc1
    v_mfma_f32_16x16x32_bf16 v[88:91], a[152:155], v[196:199], v[88:91]
    v_mfma_f32_16x16x32_bf16 v[84:87], a[148:151], v[196:199], v[84:87]
    buffer_load_dwordx4 a[236:239], v240, s[36:39], s78 offen offset:3072 sc1
    v_mfma_f32_16x16x32_bf16 v[80:83], a[144:147], v[196:199], v[80:83]
    v_mfma_f32_16x16x32_bf16 v[76:79], a[140:143], v[196:199], v[76:79]
    s_waitcnt vmcnt(16)
    v_mfma_f32_16x16x32_bf16 v[56:59], a[160:163], v[200:203], v[56:59]
    buffer_load_dwordx4 v[120:123], v237, s[36:39], s69 offen offset:2304 sc1
    v_mfma_f32_16x16x32_bf16 v[60:63], a[164:167], v[200:203], v[60:63]
    v_add_u32 v237, 3145728, v237
    v_mfma_f32_16x16x32_bf16 v[64:67], a[168:171], v[200:203], v[64:67]
    v_mfma_f32_16x16x32_bf16 v[68:71], a[172:175], v[200:203], v[68:71]
    v_mfma_f32_16x16x32_bf16 v[72:75], a[176:179], v[200:203], v[72:75]
    s_waitcnt vmcnt(16)
    v_mfma_f32_16x16x32_bf16 v[92:95], a[176:179], v[204:207], v[92:95]
    v_mfma_f32_16x16x32_bf16 v[88:91], a[172:175], v[204:207], v[88:91]
    v_mfma_f32_16x16x32_bf16 v[84:87], a[168:171], v[204:207], v[84:87]
    v_mfma_f32_16x16x32_bf16 v[80:83], a[164:167], v[204:207], v[80:83]
    v_mfma_f32_16x16x32_bf16 v[76:79], a[160:163], v[204:207], v[76:79]
    s_waitcnt vmcnt(15)
    v_mfma_f32_16x16x32_bf16 v[56:59], a[180:183], v[208:211], v[56:59]
    v_mfma_f32_16x16x32_bf16 v[60:63], a[184:187], v[208:211], v[60:63]
    v_mfma_f32_16x16x32_bf16 v[64:67], a[188:191], v[208:211], v[64:67]
    v_mfma_f32_16x16x32_bf16 v[68:71], a[192:195], v[208:211], v[68:71]
    v_mfma_f32_16x16x32_bf16 v[72:75], a[196:199], v[208:211], v[72:75]
    s_waitcnt vmcnt(13)
    v_mfma_f32_16x16x32_bf16 v[92:95], a[196:199], v[104:107], v[92:95]
    v_mfma_f32_16x16x32_bf16 v[88:91], a[192:195], v[104:107], v[88:91]
    v_mfma_f32_16x16x32_bf16 v[84:87], a[188:191], v[104:107], v[84:87]
    v_mfma_f32_16x16x32_bf16 v[80:83], a[184:187], v[104:107], v[80:83]
    v_mfma_f32_16x16x32_bf16 v[76:79], a[180:183], v[104:107], v[76:79]
    s_waitcnt vmcnt(12)
    v_mfma_f32_16x16x32_bf16 v[56:59], a[200:203], v[108:111], v[56:59]
L_pg7:
    s_cbranch_execz L_pgback
    v_mfma_f32_16x16x32_bf16 v[60:63], a[204:207], v[108:111], v[60:63]
    s_waitcnt vmcnt(11)
    v_mfma_f32_16x16x32_bf16 v[64:67], a[208:211], v[108:111], v[64:67]
    s_waitcnt vmcnt(10)
    v_mfma_f32_16x16x32_bf16 v[68:71], a[212:215], v[108:111], v[68:71]
    s_waitcnt vmcnt(9)
    v_mfma_f32_16x16x32_bf16 v[72:75], a[216:219], v[108:111], v[72:75]
    s_waitcnt vmcnt(8)
    v_mfma_f32_16x16x32_bf16 v[92:95], a[216:219], v[112:115], v[92:95]
    v_mfma_f32_16x16x32_bf16 v[88:91], a[212:215], v[112:115], v[88:91]
    v_mfma_f32_16x16x32_bf16 v[84:87], a[208:211], v[112:115], v[84:87]
    v_mfma_f32_16x16x32_bf16 v[80:83], a[204:207], v[112:115], v[80:83]
    v_mfma_f32_16x16x32_bf16 v[76:79], a[200:203], v[112:115], v[76:79]
    s_waitcnt vmcnt(6)
    v_mfma_f32_16x16x32_bf16 v[56:59], a[220:223], v[116:119], v[56:59]
    s_waitcnt vmcnt(5)
    v_mfma_f32_16x16x32_bf16 v[60:63], a[224:227], v[116:119], v[60:63]
    s_waitcnt vmcnt(4)
    v_mfma_f32_16x16x32_bf16 v[64:67], a[228:231], v[116:119], v[64:67]
    s_waitcnt vmcnt(3)
    v_mfma_f32_16x16x32_bf16 v[68:71], a[232:235], v[116:119], v[68:71]
    s_waitcnt vmcnt(2)
    v_cmp_gt_u32 vcc, 16, v5
    s_nop 0
    s_and_b64 vcc, vcc, s[58:59]
    s_cbranch_scc1 L_spin_31
L_back_32:
    s_barrier
    s_waitcnt vmcnt(1)
    v_mfma_f32_16x16x32_bf16 v[72:75], a[236:239], v[116:119], v[72:75]
    s_waitcnt vmcnt(0)
    buffer_load_dwordx4 v[8:11], v237, s[36:39], s64 offen offset:0 sc1
    v_mfma_f32_16x16x32_bf16 v[92:95], a[236:239], v[120:123], v[92:95]
    v_mfma_f32_16x16x32_bf16 v[88:91], a[232:235], v[120:123], v[88:91]
    buffer_load_dwordx4 v[12:15], v237, s[36:39], s64 offen offset:2048 sc1
    v_mfma_f32_16x16x32_bf16 v[84:87], a[228:231], v[120:123], v[84:87]
    v_mfma_f32_16x16x32_bf16 v[80:83], a[224:227], v[120:123], v[80:83]
    buffer_load_dwordx4 v[16:19], v237, s[36:39], s65 offen offset:0 sc1
    v_mfma_f32_16x16x32_bf16 v[76:79], a[220:223], v[120:123], v[76:79]
    buffer_load_dwordx4 v[20:23], v237, s[36:39], s65 offen offset:2048 sc1
    ds_write_b128 v238, v[56:59] offset:0
    ds_write_b128 v238, v[60:63] offset:4096
    ds_write_b128 v238, v[64:67] offset:8192
    ds_write_b128 v238, v[68:71] offset:12288
    ds_write_b128 v238, v[72:75] offset:16384
    buffer_load_dwordx4 v[24:27], v237, s[36:39], s66 offen offset:0 sc1
    buffer_load_dwordx4 v[28:31], v237, s[36:39], s66 offen offset:2048 sc1
    buffer_load_dwordx4 v[32:35], v237, s[36:39], s67 offen offset:0 sc1
    ds_write_b128 v238, v[92:95] offset:36864
    ds_write_b128 v238, v[88:91] offset:32768
    ds_write_b128 v238, v[84:87] offset:28672
    ds_write_b128 v238, v[80:83] offset:24576
    ds_write_b128 v238, v[76:79] offset:20480
    buffer_load_dwordx4 v[36:39], v237, s[36:39], s67 offen offset:2048 sc1
    buffer_load_dwordx4 v[40:43], v237, s[36:39], s68 offen offset:0 sc1
    buffer_load_dwordx4 v[44:47], v237, s[36:39], s68 offen offset:2048 sc1
    s_waitcnt lgkmcnt(0)
    s_barrier
    s_waitcnt vmcnt(9)
    v_mfma_f32_16x16x32_bf16 v[136:139], a[0:3], v[8:11], 0
    buffer_load_dwordx4 v[48:51], v237, s[36:39], s69 offen offset:0 sc1
    v_mfma_f32_16x16x32_bf16 v[140:143], a[4:7], v[8:11], 0
    ds_read_b128 v[56:59], v239 offset:0
    v_mfma_f32_16x16x32_bf16 v[144:147], a[8:11], v[8:11], 0
    ds_read_b128 v[60:63], v239 offset:1024
    v_mfma_f32_16x16x32_bf16 v[148:151], a[12:15], v[8:11], 0
    ds_read_b128 v[64:67], v239 offset:2048
    v_mfma_f32_16x16x32_bf16 v[152:155], a[16:19], v[8:11], 0
    s_waitcnt vmcnt(9)
    buffer_load_dwordx4 v[52:55], v237, s[36:39], s69 offen offset:2048 sc1
    v_mfma_f32_16x16x32_bf16 v[152:155], a[36:39], v[12:15], v[152:155]
    ds_read_b128 v[68:71], v239 offset:3072
    v_mfma_f32_16x16x32_bf16 v[148:151], a[32:35], v[12:15], v[148:151]
    ds_read_b128 v[72:75], v239 offset:16384
    v_mfma_f32_16x16x32_bf16 v[144:147], a[28:31], v[12:15], v[144:147]
    ds_read_b128 v[76:79], v239 offset:17408
    v_mfma_f32_16x16x32_bf16 v[140:143], a[24:27], v[12:15], v[140:143]
    buffer_load_dwordx4 v[184:187], v237, s[36:39], s64 offen offset:256 sc1
    v_mfma_f32_16x16x32_bf16 v[136:139], a[20:23], v[12:15], v[136:139]
    s_waitcnt vmcnt(10)
    ds_read_b128 v[80:83], v239 offset:18432
    v_mfma_f32_16x16x32_bf16 v[136:139], a[40:43], v[16:19], v[136:139]
    ds_read_b128 v[84:87], v239 offset:19456
    v_mfma_f32_16x16x32_bf16 v[140:143], a[44:47], v[16:19], v[140:143]
    ds_read_b128 v[88:91], v239 offset:32768
    v_mfma_f32_16x16x32_bf16 v[144:147], a[48:51], v[16:19], v[144:147]
    ds_read_b128 v[92:95], v239 offset:33792
    v_mfma_f32_16x16x32_bf16 v[148:151], a[52:55], v[16:19], v[148:151]
    buffer_load_dwordx4 v[188:191], v237, s[36:39], s64 offen offset:2304 sc1
    v_mfma_f32_16x16x32_bf16 v[152:155], a[56:59], v[16:19], v[152:155]
    ds_read_b128 v[96:99], v239 offset:34816
    s_waitcnt lgkmcnt(10)
    v_add_f32 v212, v212, v56
    s_waitcnt vmcnt(10)
    v_mfma_f32_16x16x32_bf16 v[152:155], a[76:79], v[20:23], v[152:155]
    ds_read_b128 v[100:103], v239 offset:35840
    v_add_f32 v213, v213, v57
    v_mfma_f32_16x16x32_bf16 v[148:151], a[72:75], v[20:23], v[148:151]
    v_add_f32 v214, v214, v58
    v_add_f32 v215, v215, v59
    v_mfma_f32_16x16x32_bf16 v[144:147], a[68:71], v[20:23], v[144:147]
    buffer_load_dwordx4 v[192:195], v237, s[36:39], s65 offen offset:256 sc1
    v_mfma_f32_16x16x32_bf16 v[140:143], a[64:67], v[20:23], v[140:143]
    s_waitcnt lgkmcnt(9)
    v_add_f32 v60, v60, v64
    v_add_f32 v61, v61, v65
    v_mfma_f32_16x16x32_bf16 v[136:139], a[60:63], v[20:23], v[136:139]
    s_waitcnt vmcnt(10)
    v_add_f32 v62, v62, v66
    v_add_f32 v63, v63, v67
    v_mfma_f32_16x16x32_bf16 v[136:139], a[80:83], v[24:27], v[136:139]
    s_waitcnt lgkmcnt(8)
    v_add_f32 v212, v212, v68
    v_add_f32 v213, v213, v69
    v_mfma_f32_16x16x32_bf16 v[140:143], a[84:87], v[24:27], v[140:143]
    v_add_f32 v214, v214, v70
    v_add_f32 v215, v215, v71
    v_mfma_f32_16x16x32_bf16 v[144:147], a[88:91], v[24:27], v[144:147]
    buffer_load_dwordx4 v[196:199], v237, s[36:39], s65 offen offset:2304 sc1
    v_mfma_f32_16x16x32_bf16 v[148:151], a[92:95], v[24:27], v[148:151]
    v_add_f32 v212, v212, v60
    v_add_f32 v213, v213, v61
    v_mfma_f32_16x16x32_bf16 v[152:155], a[96:99], v[24:27], v[152:155]
    s_waitcnt vmcnt(10)
    v_add_f32 v214, v214, v62
    v_add_f32 v215, v215, v63
    v_mfma_f32_16x16x32_bf16 v[152:155], a[116:119], v[28:31], v[152:155]
    v_cvt_pk_bf16_f32 v56, v212, v213
    v_cvt_pk_bf16_f32 v57, v214, v215
    v_mfma_f32_16x16x32_bf16 v[148:151], a[112:115], v[28:31], v[148:151]
    buffer_load_dwordx4 v[200:203], v237, s[36:39], s66 offen offset:256 sc1
    v_mfma_f32_16x16x32_bf16 v[144:147], a[108:111], v[28:31], v[144:147]
    s_waitcnt lgkmcnt(7)
    v_add_f32 v216, v216, v72
    v_add_f32 v217, v217, v73
    v_mfma_f32_16x16x32_bf16 v[140:143], a[104:107], v[28:31], v[140:143]
    v_add_f32 v218, v218, v74
    v_add_f32 v219, v219, v75
    v_mfma_f32_16x16x32_bf16 v[136:139], a[100:103], v[28:31], v[136:139]
    s_waitcnt lgkmcnt(5)
    v_add_f32 v76, v76, v80
    v_add_f32 v77, v77, v81
    s_waitcnt vmcnt(10)
    v_mfma_f32_16x16x32_bf16 v[136:139], a[120:123], v[32:35], v[136:139]
    buffer_load_dwordx4 v[204:207], v237, s[36:39], s66 offen offset:2304 sc1
    v_mfma_f32_16x16x32_bf16 v[140:143], a[124:127], v[32:35], v[140:143]
    v_add_f32 v78, v78, v82
    v_add_f32 v79, v79, v83
    v_mfma_f32_16x16x32_bf16 v[144:147], a[128:131], v[32:35], v[144:147]
    s_waitcnt lgkmcnt(4)
    v_add_f32 v216, v216, v84
    v_add_f32 v217, v217, v85
    v_mfma_f32_16x16x32_bf16 v[148:151], a[132:135], v[32:35], v[148:151]
    v_add_f32 v218, v218, v86
    v_add_f32 v219, v219, v87
    v_mfma_f32_16x16x32_bf16 v[152:155], a[136:139], v[32:35], v[152:155]
    s_waitcnt vmcnt(10)
    v_add_f32 v216, v216, v76
    v_add_f32 v217, v217, v77
    v_mfma_f32_16x16x32_bf16 v[152:155], a[156:159], v[36:39], v[152:155]
    buffer_load_dwordx4 v[208:211], v237, s[36:39], s67 offen offset:256 sc1
    v_mfma_f32_16x16x32_bf16 v[148:151], a[152:155], v[36:39], v[148:151]
    v_add_f32 v218, v218, v78
    v_add_f32 v219, v219, v79
    v_mfma_f32_16x16x32_bf16 v[144:147], a[148:151], v[36:39], v[144:147]
    v_cvt_pk_bf16_f32 v72, v216, v217
    v_cvt_pk_bf16_f32 v73, v218, v219
    v_mfma_f32_16x16x32_bf16 v[140:143], a[144:147], v[36:39], v[140:143]
    s_waitcnt lgkmcnt(3)
    v_add_f32 v220, v220, v88
    v_add_f32 v221, v221, v89
    v_mfma_f32_16x16x32_bf16 v[136:139], a[140:143], v[36:39], v[136:139]
    s_waitcnt vmcnt(10)
    buffer_load_dwordx4 v[104:107], v237, s[36:39], s67 offen offset:2304 sc1
    v_mfma_f32_16x16x32_bf16 v[136:139], a[160:163], v[40:43], v[136:139]
    v_add_f32 v222, v222, v90
    v_add_f32 v223, v223, v91
    v_mfma_f32_16x16x32_bf16 v[140:143], a[164:167], v[40:43], v[140:143]
    s_waitcnt lgkmcnt(1)
    v_add_f32 v92, v92, v96
    v_add_f32 v93, v93, v97
    v_mfma_f32_16x16x32_bf16 v[144:147], a[168:171], v[40:43], v[144:147]
    v_add_f32 v94, v94, v98
    v_add_f32 v95, v95, v99
    v_mfma_f32_16x16x32_bf16 v[148:151], a[172:175], v[40:43], v[148:151]
    buffer_load_dwordx4 v[108:111], v237, s[36:39], s68 offen offset:256 sc1
    v_mfma_f32_16x16x32_bf16 v[152:155], a[176:179], v[40:43], v[152:155]
    s_waitcnt lgkmcnt(0)
    v_add_f32 v220, v220, v100
    v_add_f32 v221, v221, v101
    s_waitcnt vmcnt(11)
    v_mfma_f32_16x16x32_bf16 v[152:155], a[196:199], v[44:47], v[152:155]
    v_add_f32 v222, v222, v102
    v_add_f32 v223, v223, v103
    v_mfma_f32_16x16x32_bf16 v[148:151], a[192:195], v[44:47], v[148:151]
    v_add_f32 v220, v220, v92
    v_add_f32 v221, v221, v93
    v_mfma_f32_16x16x32_bf16 v[144:147], a[188:191], v[44:47], v[144:147]
    v_add_f32 v222, v222, v94
    v_add_f32 v223, v223, v95
    v_mfma_f32_16x16x32_bf16 v[140:143], a[184:187], v[44:47], v[140:143]
    buffer_load_dwordx4 v[112:115], v237, s[36:39], s68 offen offset:2304 sc1
    v_mfma_f32_16x16x32_bf16 v[136:139], a[180:183], v[44:47], v[136:139]
    s_waitcnt vmcnt(11)
    v_cvt_pk_bf16_f32 v88, v220, v221
    v_cvt_pk_bf16_f32 v89, v222, v223
    v_mfma_f32_16x16x32_bf16 v[136:139], a[200:203], v[48:51], v[136:139]
    v_mfma_f32_16x16x32_bf16 v[140:143], a[204:207], v[48:51], v[140:143]
    v_mfma_f32_16x16x32_bf16 v[144:147], a[208:211], v[48:51], v[144:147]
    buffer_load_dwordx4 v[116:119], v237, s[36:39], s69 offen offset:256 sc1
    v_mfma_f32_16x16x32_bf16 v[148:151], a[212:215], v[48:51], v[148:151]
    v_add_u32 v238, 49152, v238
    v_add_u32 v239, 49152, v239
    v_mfma_f32_16x16x32_bf16 v[152:155], a[216:219], v[48:51], v[152:155]
    s_waitcnt vmcnt(11)
    v_lshlrev_b32 v212, 16, v130
    v_and_b32 v213, 0xffff0000, v130
    v_mfma_f32_16x16x32_bf16 v[152:155], a[236:239], v[52:55], v[152:155]
    v_lshlrev_b32 v214, 16, v131
    v_and_b32 v215, 0xffff0000, v131
    v_mfma_f32_16x16x32_bf16 v[148:151], a[232:235], v[52:55], v[148:151]
    v_lshlrev_b32 v216, 16, v132
    v_and_b32 v217, 0xffff0000, v132
    v_mfma_f32_16x16x32_bf16 v[144:147], a[228:231], v[52:55], v[144:147]
    buffer_load_dwordx4 v[120:123], v237, s[36:39], s69 offen offset:2304 sc1
    v_mfma_f32_16x16x32_bf16 v[140:143], a[224:227], v[52:55], v[140:143]
    v_lshlrev_b32 v218, 16, v133
    v_and_b32 v219, 0xffff0000, v133
    v_mfma_f32_16x16x32_bf16 v[136:139], a[220:223], v[52:55], v[136:139]
    s_waitcnt vmcnt(11)
    v_lshlrev_b32 v220, 16, v134
    v_and_b32 v221, 0xffff0000, v134
    v_mfma_f32_16x16x32_bf16 v[156:159], a[0:3], v[184:187], 0
    v_lshlrev_b32 v222, 16, v135
    v_and_b32 v223, 0xffff0000, v135
    v_mfma_f32_16x16x32_bf16 v[160:163], a[4:7], v[184:187], 0
    buffer_store_dwordx2 v[56:57], v232, s[40:43], s47 offen
    v_mfma_f32_16x16x32_bf16 v[164:167], a[8:11], v[184:187], 0
    v_mfma_f32_16x16x32_bf16 v[168:171], a[12:15], v[184:187], 0
    s_waitcnt vmcnt(11)
    ds_write_b128 v238, v[136:139] offset:0
    v_mfma_f32_16x16x32_bf16 v[168:171], a[32:35], v[188:191], v[168:171]
    v_mfma_f32_16x16x32_bf16 v[164:167], a[28:31], v[188:191], v[164:167]
    buffer_store_dwordx2 v[72:73], v233, s[40:43], s47 offen
    v_mfma_f32_16x16x32_bf16 v[160:163], a[24:27], v[188:191], v[160:163]
    v_mfma_f32_16x16x32_bf16 v[156:159], a[20:23], v[188:191], v[156:159]
    s_waitcnt vmcnt(11)
    ds_write_b128 v238, v[140:143] offset:4096
    v_mfma_f32_16x16x32_bf16 v[156:159], a[40:43], v[192:195], v[156:159]
    v_mfma_f32_16x16x32_bf16 v[160:163], a[44:47], v[192:195], v[160:163]
    v_mfma_f32_16x16x32_bf16 v[164:167], a[48:51], v[192:195], v[164:167]
    buffer_store_dwordx2 v[88:89], v234, s[40:43], s47 offen
    v_mfma_f32_16x16x32_bf16 v[168:171], a[52:55], v[192:195], v[168:171]
    s_waitcnt vmcnt(11)
    ds_write_b128 v238, v[144:147] offset:8192
    v_mfma_f32_16x16x32_bf16 v[168:171], a[72:75], v[196:199], v[168:171]
    s_add_u32 s47, s47, 1310720
    v_mfma_f32_16x16x32_bf16 v[164:167], a[68:71], v[196:199], v[164:167]
    v_mfma_f32_16x16x32_bf16 v[160:163], a[64:67], v[196:199], v[160:163]
    v_mfma_f32_16x16x32_bf16 v[156:159], a[60:63], v[196:199], v[156:159]
    s_waitcnt vmcnt(10)
    ds_write_b128 v238, v[148:151] offset:12288
    v_mfma_f32_16x16x32_bf16 v[156:159], a[80:83], v[200:203], v[156:159]
    v_mfma_f32_16x16x32_bf16 v[160:163], a[84:87], v[200:203], v[160:163]
    v_mfma_f32_16x16x32_bf16 v[164:167], a[88:91], v[200:203], v[164:167]
    v_mfma_f32_16x16x32_bf16 v[168:171], a[92:95], v[200:203], v[168:171]
    s_waitcnt vmcnt(9)
    ds_write_b128 v238, v[152:155] offset:16384
    v_mfma_f32_16x16x32_bf16 v[168:171], a[112:115], v[204:207], v[168:171]
    v_mfma_f32_16x16x32_bf16 v[164:167], a[108:111], v[204:207], v[164:167]
    v_mfma_f32_16x16x32_bf16 v[160:163], a[104:107], v[204:207], v[160:163]
    v_mfma_f32_16x16x32_bf16 v[156:159], a[100:103], v[204:207], v[156:159]
    s_waitcnt vmcnt(8)
    v_mfma_f32_16x16x32_bf16 v[156:159], a[120:123], v[208:211], v[156:159]
    v_mfma_f32_16x16x32_bf16 v[160:163], a[124:127], v[208:211], v[160:163]
    v_mfma_f32_16x16x32_bf16 v[164:167], a[128:131], v[208:211], v[164:167]
    s_waitcnt lgkmcnt(0)
    s_barrier
    v_mfma_f32_16x16x32_bf16 v[168:171], a[132:135], v[208:211], v[168:171]
    s_waitcnt vmcnt(7)
    ds_read_b128 v[56:59], v239 offset:0
    v_mfma_f32_16x16x32_bf16 v[168:171], a[152:155], v[104:107], v[168:171]
    ds_read_b128 v[60:63], v239 offset:1024
    v_mfma_f32_16x16x32_bf16 v[164:167], a[148:151], v[104:107], v[164:167]
    ds_read_b128 v[64:67], v239 offset:2048
    v_mfma_f32_16x16x32_bf16 v[160:163], a[144:147], v[104:107], v[160:163]
    ds_read_b128 v[68:71], v239 offset:3072
    v_mfma_f32_16x16x32_bf16 v[156:159], a[140:143], v[104:107], v[156:159]
    s_waitcnt vmcnt(6)
    v_mfma_f32_16x16x32_bf16 v[156:159], a[160:163], v[108:111], v[156:159]
    v_mfma_f32_16x16x32_bf16 v[160:163], a[164:167], v[108:111], v[160:163]
    v_mfma_f32_16x16x32_bf16 v[164:167], a[168:171], v[108:111], v[164:167]
    v_mfma_f32_16x16x32_bf16 v[168:171], a[172:175], v[108:111], v[168:171]
    s_waitcnt vmcnt(5)
    v_mfma_f32_16x16x32_bf16 v[168:171], a[192:195], v[112:115], v[168:171]
    v_mfma_f32_16x16x32_bf16 v[164:167], a[188:191], v[112:115], v[164:167]
    v_mfma_f32_16x16x32_bf16 v[160:163], a[184:187], v[112:115], v[160:163]
    s_waitcnt lgkmcnt(3)
    v_add_f32 v212, v212, v56
    v_add_f32 v213, v213, v57
    v_mfma_f32_16x16x32_bf16 v[156:159], a[180:183], v[112:115], v[156:159]
    s_waitcnt vmcnt(4)
    v_add_f32 v214, v214, v58
    v_add_f32 v215, v215, v59
    v_mfma_f32_16x16x32_bf16 v[156:159], a[200:203], v[116:119], v[156:159]
    s_waitcnt lgkmcnt(1)
    v_add_f32 v60, v60, v64
    v_add_f32 v61, v61, v65
    v_mfma_f32_16x16x32_bf16 v[160:163], a[204:207], v[116:119], v[160:163]
    v_add_f32 v62, v62, v66
    v_add_f32 v63, v63, v67
    v_mfma_f32_16x16x32_bf16 v[164:167], a[208:211], v[116:119], v[164:167]
    s_waitcnt lgkmcnt(0)
    v_add_f32 v212, v212, v68
    v_add_f32 v213, v213, v69
    v_mfma_f32_16x16x32_bf16 v[168:171], a[212:215], v[116:119], v[168:171]
    s_waitcnt vmcnt(3)
    v_add_f32 v214, v214, v70
    v_add_f32 v215, v215, v71
    v_mfma_f32_16x16x32_bf16 v[168:171], a[232:235], v[120:123], v[168:171]
    v_add_f32 v212, v212, v60
    v_add_f32 v213, v213, v61
    v_mfma_f32_16x16x32_bf16 v[164:167], a[228:231], v[120:123], v[164:167]
    v_add_f32 v214, v214, v62
    v_add_f32 v215, v215, v63
    v_mfma_f32_16x16x32_bf16 v[160:163], a[224:227], v[120:123], v[160:163]
    v_cvt_pk_bf16_f32 v56, v212, v213
    v_cvt_pk_bf16_f32 v57, v214, v215
    v_mfma_f32_16x16x32_bf16 v[156:159], a[220:223], v[120:123], v[156:159]
    buffer_store_dwordx2 v[56:57], v232, s[40:43], s47 offen
    v_mfma_f32_16x16x32_bf16 v[172:175], a[16:19], v[184:187], 0
    v_mfma_f32_16x16x32_bf16 v[172:175], a[36:39], v[188:191], v[172:175]
    v_mfma_f32_16x16x32_bf16 v[172:175], a[56:59], v[192:195], v[172:175]
    ds_write_b128 v238, v[168:171] offset:32768
    v_mfma_f32_16x16x32_bf16 v[172:175], a[76:79], v[196:199], v[172:175]
    v_mfma_f32_16x16x32_bf16 v[172:175], a[96:99], v[200:203], v[172:175]
    v_mfma_f32_16x16x32_bf16 v[172:175], a[116:119], v[204:207], v[172:175]
    ds_write_b128 v238, v[164:167] offset:28672
    v_mfma_f32_16x16x32_bf16 v[172:175], a[136:139], v[208:211], v[172:175]
    v_mfma_f32_16x16x32_bf16 v[172:175], a[156:159], v[104:107], v[172:175]
    v_mfma_f32_16x16x32_bf16 v[172:175], a[176:179], v[108:111], v[172:175]
    ds_write_b128 v238, v[160:163] offset:24576
    v_mfma_f32_16x16x32_bf16 v[172:175], a[196:199], v[112:115], v[172:175]
    v_mfma_f32_16x16x32_bf16 v[172:175], a[216:219], v[116:119], v[172:175]
    v_mfma_f32_16x16x32_bf16 v[172:175], a[236:239], v[120:123], v[172:175]
    ds_write_b128 v238, v[156:159] offset:20480
    s_nop 6
    ds_write_b128 v238, v[172:175] offset:36864
    s_waitcnt lgkmcnt(0)
    s_barrier
    ds_read_b128 v[72:75], v239 offset:16384
    ds_read_b128 v[76:79], v239 offset:17408
    ds_read_b128 v[80:83], v239 offset:18432
    ds_read_b128 v[84:87], v239 offset:19456
    ds_read_b128 v[88:91], v239 offset:32768
    ds_read_b128 v[92:95], v239 offset:33792
    ds_read_b128 v[96:99], v239 offset:34816
    ds_read_b128 v[100:103], v239 offset:35840
    s_waitcnt lgkmcnt(7)
    v_pk_add_f32 v[216:217], v[216:217], v[72:73]
    v_pk_add_f32 v[218:219], v[218:219], v[74:75]
    s_waitcnt lgkmcnt(5)
    v_pk_add_f32 v[76:77], v[76:77], v[80:81]
    v_pk_add_f32 v[78:79], v[78:79], v[82:83]
    s_waitcnt lgkmcnt(4)
    v_pk_add_f32 v[216:217], v[216:217], v[84:85]
    v_pk_add_f32 v[218:219], v[218:219], v[86:87]
    v_pk_add_f32 v[216:217], v[216:217], v[76:77]
    v_pk_add_f32 v[218:219], v[218:219], v[78:79]
    v_cvt_pk_bf16_f32 v72, v216, v217
    v_cvt_pk_bf16_f32 v73, v218, v219
    buffer_store_dwordx2 v[72:73], v233, s[40:43], s47 offen
    s_waitcnt lgkmcnt(3)
    v_pk_add_f32 v[220:221], v[220:221], v[88:89]
    v_pk_add_f32 v[222:223], v[222:223], v[90:91]
    s_waitcnt lgkmcnt(1)
    v_pk_add_f32 v[92:93], v[92:93], v[96:97]
    v_pk_add_f32 v[94:95], v[94:95], v[98:99]
    s_waitcnt lgkmcnt(0)
    v_pk_add_f32 v[220:221], v[220:221], v[100:101]
    v_pk_add_f32 v[222:223], v[222:223], v[102:103]
    v_pk_add_f32 v[220:221], v[220:221], v[92:93]
    v_pk_add_f32 v[222:223], v[222:223], v[94:95]
    v_cvt_pk_bf16_f32 v88, v220, v221
    v_cvt_pk_bf16_f32 v89, v222, v223
    buffer_store_dwordx2 v[88:89], v234, s[40:43], s47 offen
    s_add_u32 s47, s47, 1310720
L_fin:
L_end:
    s_endpgm
L_helper:
L_pg1:
    s_cbranch_execz L_pg5
    s_add_u32 m0, s13, 112416
    s_add_u32 s14, s14, 786432
    buffer_load_dwordx4 v224, s[8:11], s14 offen offset:0 lds
    buffer_load_dwordx4 v225, s[8:11], s14 offen offset:1024 lds
    buffer_load_dwordx4 v226, s[8:11], s14 offen offset:2048 lds
    s_add_u32 m0, s13, 124720
    s_add_u32 s14, s14, 98304
    buffer_load_dwordx4 v224, s[8:11], s14 offen offset:0 lds
    buffer_load_dwordx4 v225, s[8:11], s14 offen offset:1024 lds
    buffer_load_dwordx4 v226, s[8:11], s14 offen offset:2048 lds
    v_mov_b32 v144, v7
    v_and_b32 v141, 3, v1
    v_mov_b32 v148, s53
    v_mov_b32 v149, s53
    v_mov_b32 v150, s53
    v_mov_b32 v151, s53
    v_and_b32 v146, 12, v1
    v_cmp_eq_u32 vcc, 0, v146
    v_lshlrev_b32 v146, 4, v141
    s_nop 0
    v_cndmask_b32 v146, v144, v146, vcc
    v_subrev_u32 v238, 24608, v232
    v_subrev_u32 v239, 24608, v233
    v_and_b32 v140, 48, v1
    v_lshl_add_u32 v146, v140, 2, v146
    s_cmp_eq_u32 s15, 0
    s_cselect_b32 s50, s53, 0
    v_mov_b32 v164, s50
    v_mov_b32 v165, s50
    v_mov_b32 v166, s50
    v_mov_b32 v167, s50
    s_mul_i32 s4, s15, 6144
    s_add_u32 s4, s4, 24576
    s_lshl_b32 s5, s46, 2
    s_add_u32 s5, s5, s44
    s_mul_i32 s5, s5, 768
    s_add_u32 s5, s5, 163840
    s_mul_i32 s6, s15, 49152
    s_add_u32 s6, s6, s5
    s_waitcnt vmcnt(6)
    v_cmp_gt_u32 vcc, 1, v5
    s_nop 0
    s_and_b64 vcc, vcc, s[58:59]
    s_cbranch_scc1 L_spin_33
L_back_34:
    s_barrier
    s_add_u32 s62, s33, 0
    buffer_atomic_add v4, v2, s[36:39], s62 offen offset:128 sc1
    s_sub_u32 s57, s2, 160
    s_lshr_b32 s49, s57, 1
    s_lshl_b32 s50, s49, 2
    s_add_u32 s50, s50, s44
    s_mul_i32 s51, s50, 21846
    s_lshr_b32 s51, s51, 16
    s_mul_i32 s52, s51, 3
    s_sub_u32 s52, s50, s52
    s_mul_i32 s51, s51, 24
    s_cmp_eq_u32 s52, 2
    s_cselect_b32 s50, 1, 3
    s_cselect_b32 s52, 8, s52
    s_lshl_b32 s52, s52, 1
    s_add_u32 s51, s51, s52
    v_bfe_u32 v140, v1, 5, 1
    v_lshlrev_b32 v140, s50, v140
    v_bfe_u32 v141, v1, 4, 1
    v_lshl_add_u32 v140, v141, 2, v140
    v_bfe_u32 v141, v1, 3, 1
    v_add3_u32 v140, v140, v141, s51
    v_mul_u32_u24 v143, 1280, v140
    s_and_b32 s52, s57, 1
    s_mul_i32 s50, s52, 640
    v_and_b32 v141, 7, v1
    v_lshl_add_u32 v143, v141, 4, v143
    v_add_u32 v143, s50, v143
    v_lshrrev_b32 v145, 3, v0
    v_mul_u32_u24 v145, 672, v145
    v_lshl_add_u32 v145, v141, 4, v145
    v_add_u32 v145, 85760, v145
    v_lshrrev_b32 v140, 2, v1
    v_and_b32 v147, 12, v140
    v_add_u32 v147, v147, v140
    v_mul_u32_u24 v147, 672, v147
    v_and_b32 v141, 3, v1
    v_lshl_add_u32 v147, v141, 3, v147
    s_mul_i32 s50, s44, 160
    s_add_u32 s50, s50, 85760
    v_add_u32 v147, s50, v147
    s_lshl_b32 s52, s52, 2
    s_add_u32 s52, s52, s44
    s_mul_i32 s52, s52, 48
    s_add_u32 s52, s52, s49
    s_mul_i32 s52, s52, 5120
    s_add_u32 s7, s52, 14680064
    global_load_dwordx4 v[120:123], v143, s[28:29] offset:0
    global_load_dwordx4 v[124:127], v143, s[28:29] offset:128
    global_load_dwordx4 v[128:131], v143, s[28:29] offset:256
    global_load_dwordx4 v[132:135], v143, s[28:29] offset:384
    global_load_dwordx4 v[136:139], v143, s[28:29] offset:512
    s_mul_i32 s49, s45, 82048
    s_lshl_b32 s50, s44, 10
    s_add_u32 s49, s49, s50
    s_add_u32 s49, s49, 6422528
    v_add_u32 v254, s49, v6
    s_waitcnt vmcnt(6)
    s_barrier
    ds_read_b64_tr_b16 v[8:9], v238 offset:0
    ds_read_b64_tr_b16 v[10:11], v238 offset:3072
    ds_read_b64_tr_b16 v[12:13], v238 offset:6160
    ds_read_b64_tr_b16 v[14:15], v238 offset:9232
    ds_read_b64_tr_b16 v[16:17], v239 offset:0
    ds_read_b64_tr_b16 v[18:19], v239 offset:3072
    ds_read_b64_tr_b16 v[20:21], v238 offset:12304
    ds_read_b64_tr_b16 v[22:23], v238 offset:15376
    ds_read_b64_tr_b16 v[24:25], v238 offset:18464
    ds_read_b64_tr_b16 v[26:27], v238 offset:21536
    ds_read_b64_tr_b16 v[28:29], v239 offset:12304
    ds_read_b64_tr_b16 v[30:31], v239 offset:15376
    s_waitcnt lgkmcnt(10)
    buffer_store_dwordx4 v[8:11], v252, s[36:39], s4 offen offset:0 sc1
    s_waitcnt lgkmcnt(8)
    buffer_store_dwordx4 v[12:15], v252, s[36:39], s4 offen offset:1024 sc1
    s_waitcnt lgkmcnt(6)
    buffer_store_dwordx4 v[16:19], v252, s[36:39], s4 offen offset:2048 sc1
    s_add_u32 s4, s4, 3072
    s_waitcnt lgkmcnt(4)
    buffer_store_dwordx4 v[20:23], v252, s[36:39], s4 offen offset:0 sc1
    s_waitcnt lgkmcnt(2)
    buffer_store_dwordx4 v[24:27], v252, s[36:39], s4 offen offset:1024 sc1
    s_waitcnt lgkmcnt(0)
    buffer_store_dwordx4 v[28:31], v252, s[36:39], s4 offen offset:2048 sc1
    s_add_u32 s4, s4, 3072
    v_mfma_f32_16x16x32_bf16 v[152:155], v[8:11], v[148:151], 0
    v_mfma_f32_16x16x32_bf16 v[156:159], v[12:15], v[148:151], 0
    v_mfma_f32_16x16x32_bf16 v[160:163], v[16:19], v[148:151], 0
    v_mfma_f32_16x16x32_bf16 v[152:155], v[20:23], v[148:151], v[152:155]
    v_mfma_f32_16x16x32_bf16 v[156:159], v[24:27], v[148:151], v[156:159]
    v_mfma_f32_16x16x32_bf16 v[160:163], v[28:31], v[148:151], v[160:163]
    s_add_u32 m0, s13, 137024
    s_mov_b32 s14, 0
    buffer_load_dwordx4 v224, s[8:11], s14 offen offset:0 lds
    buffer_load_dwordx4 v225, s[8:11], s14 offen offset:1024 lds
    buffer_load_dwordx4 v226, s[8:11], s14 offen offset:2048 lds
    s_add_u32 m0, s13, 149328
    s_mov_b32 s14, 98304
    buffer_load_dwordx4 v224, s[8:11], s14 offen offset:0 lds
    buffer_load_dwordx4 v225, s[8:11], s14 offen offset:1024 lds
    buffer_load_dwordx4 v226, s[8:11], s14 offen offset:2048 lds
    s_waitcnt vmcnt(6)
    s_barrier
    buffer_atomic_add v4, v2, s[36:39], s16 offen offset:128 sc1
    s_add_u32 m0, s13, 66560
    s_mov_b32 s14, 196608
    buffer_load_dwordx4 v224, s[8:11], s14 offen offset:0 lds
    buffer_load_dwordx4 v225, s[8:11], s14 offen offset:1024 lds
    buffer_load_dwordx4 v226, s[8:11], s14 offen offset:2048 lds
    s_add_u32 m0, s13, 54256
    s_mov_b32 s14, 294912
    buffer_load_dwordx4 v224, s[8:11], s14 offen offset:0 lds
    buffer_load_dwordx4 v225, s[8:11], s14 offen offset:1024 lds
    buffer_load_dwordx4 v226, s[8:11], s14 offen offset:2048 lds
    s_add_u32 m0, s13, 41952
    s_mov_b32 s14, 393216
    buffer_load_dwordx4 v224, s[8:11], s14 offen offset:0 lds
    buffer_load_dwordx4 v225, s[8:11], s14 offen offset:1024 lds
    buffer_load_dwordx4 v226, s[8:11], s14 offen offset:2048 lds
    s_add_u32 m0, s13, 29648
    s_mov_b32 s14, 491520
    buffer_load_dwordx4 v224, s[8:11], s14 offen offset:0 lds
    buffer_load_dwordx4 v225, s[8:11], s14 offen offset:1024 lds
    buffer_load_dwordx4 v226, s[8:11], s14 offen offset:2048 lds
    buffer_load_dword v5, v255, s[36:39], s16 offen offset:128 sc1
    s_add_u32 m0, s13, 17344
    s_mov_b32 s14, 589824
    buffer_load_dwordx4 v224, s[8:11], s14 offen offset:0 lds
    buffer_load_dwordx4 v225, s[8:11], s14 offen offset:1024 lds
    buffer_load_dwordx4 v226, s[8:11], s14 offen offset:2048 lds
    s_add_u32 m0, s13, 5040
    s_mov_b32 s14, 688128
    buffer_load_dwordx4 v224, s[8:11], s14 offen offset:0 lds
    buffer_load_dwordx4 v225, s[8:11], s14 offen offset:1024 lds
    buffer_load_dwordx4 v226, s[8:11], s14 offen offset:2048 lds
    ds_write_b128 v145, v[120:123] offset:0
    ds_write_b128 v145, v[124:127] offset:128
    ds_write_b128 v145, v[128:131] offset:256
    ds_write_b128 v145, v[132:135] offset:384
    ds_write_b128 v145, v[136:139] offset:512
    s_waitcnt vmcnt(6)
    v_cmp_gt_u32 vcc, 6, v5
    s_nop 0
    s_and_b64 vcc, vcc, s[58:59]
    s_cbranch_scc1 L_spin_35
L_back_36:
    s_waitcnt lgkmcnt(0)
    s_barrier
    buffer_load_dwordx4 a[96:99], v252, s[36:39], s70 offen offset:0 sc1
    buffer_load_dwordx4 a[100:103], v252, s[36:39], s70 offen offset:1024 sc1
    buffer_load_dwordx4 a[104:107], v252, s[36:39], s70 offen offset:2048 sc1
    buffer_load_dwordx4 a[108:111], v252, s[36:39], s70 offen offset:3072 sc1
    ds_read_b64_tr_b16 v[120:121], v147 offset:0
    ds_read_b64_tr_b16 v[122:123], v147 offset:2688
    ds_read_b64_tr_b16 v[124:125], v147 offset:32
    ds_read_b64_tr_b16 v[126:127], v147 offset:2720
    ds_read_b64_tr_b16 v[128:129], v147 offset:64
    ds_read_b64_tr_b16 v[130:131], v147 offset:2752
    ds_read_b64_tr_b16 v[132:133], v147 offset:96
    ds_read_b64_tr_b16 v[134:135], v147 offset:2784
    ds_read_b64_tr_b16 v[136:137], v147 offset:128
    ds_read_b64_tr_b16 v[138:139], v147 offset:2816
    ds_read_b64_tr_b16 a[0:1], v232 offset:0
    ds_read_b64_tr_b16 a[2:3], v232 offset:3072
    ds_read_b64_tr_b16 a[4:5], v232 offset:6160
    ds_read_b64_tr_b16 a[6:7], v232 offset:9232
    ds_read_b64_tr_b16 a[8:9], v233 offset:0
    ds_read_b64_tr_b16 a[10:11], v233 offset:3072
    ds_read_b64_tr_b16 a[12:13], v232 offset:12304
    ds_read_b64_tr_b16 a[14:15], v232 offset:15376
    ds_read_b64_tr_b16 a[16:17], v232 offset:18464
    ds_read_b64_tr_b16 a[18:19], v232 offset:21536
    ds_read_b64_tr_b16 a[20:21], v233 offset:12304
    ds_read_b64_tr_b16 a[22:23], v233 offset:15376
    ds_read_b64_tr_b16 a[24:25], v234 offset:50176
    ds_read_b64_tr_b16 a[26:27], v234 offset:53248
    ds_read_b64_tr_b16 a[28:29], v234 offset:56336
    ds_read_b64_tr_b16 a[30:31], v234 offset:59408
    ds_read_b64_tr_b16 a[32:33], v235 offset:50176
    ds_read_b64_tr_b16 a[34:35], v235 offset:53248
    s_waitcnt lgkmcnt(15)
    buffer_store_dwordx4 v[120:123], v6, s[36:39], s7 offen sc1
    s_add_u32 s7, s7, 1024
    buffer_store_dwordx4 v[124:127], v6, s[36:39], s7 offen sc1
    s_add_u32 s7, s7, 1024
    buffer_store_dwordx4 v[128:131], v6, s[36:39], s7 offen sc1
    s_add_u32 s7, s7, 1024
L_pg8:
    s_cbranch_execz L_pgback
    buffer_store_dwordx4 v[132:135], v6, s[36:39], s7 offen sc1
    s_add_u32 s7, s7, 1024
    buffer_store_dwordx4 v[136:139], v6, s[36:39], s7 offen sc1
    ds_read_b64_tr_b16 a[36:37], v234 offset:37872
    ds_read_b64_tr_b16 a[38:39], v234 offset:40944
    ds_read_b64_tr_b16 a[40:41], v234 offset:44032
    ds_read_b64_tr_b16 a[42:43], v234 offset:47104
    ds_read_b64_tr_b16 a[44:45], v235 offset:37872
    ds_read_b64_tr_b16 a[46:47], v235 offset:40944
    ds_read_b64_tr_b16 a[48:49], v234 offset:25568
    ds_read_b64_tr_b16 a[50:51], v234 offset:28640
    ds_read_b64_tr_b16 a[52:53], v234 offset:31728
    ds_read_b64_tr_b16 a[54:55], v234 offset:34800
    ds_read_b64_tr_b16 a[56:57], v235 offset:25568
    ds_read_b64_tr_b16 a[58:59], v235 offset:28640
    ds_read_b64_tr_b16 a[60:61], v234 offset:13264
    ds_read_b64_tr_b16 a[62:63], v234 offset:16336
    ds_read_b64_tr_b16 a[64:65], v234 offset:19424
    ds_read_b64_tr_b16 a[66:67], v234 offset:22496
    ds_read_b64_tr_b16 a[68:69], v235 offset:13264
    ds_read_b64_tr_b16 a[70:71], v235 offset:16336
    s_waitcnt vmcnt(9)
    s_barrier
    buffer_load_dwordx4 a[112:115], v252, s[36:39], s71 offen offset:0 sc1
    buffer_load_dwordx4 a[116:119], v252, s[36:39], s71 offen offset:1024 sc1
    buffer_load_dwordx4 a[120:123], v252, s[36:39], s71 offen offset:2048 sc1
    ds_read_b64_tr_b16 a[72:73], v234 offset:960
    ds_read_b64_tr_b16 a[74:75], v234 offset:4032
    ds_read_b64_tr_b16 a[76:77], v234 offset:7120
    ds_read_b64_tr_b16 a[78:79], v234 offset:10192
    ds_read_b64_tr_b16 a[80:81], v235 offset:960
    ds_read_b64_tr_b16 a[82:83], v235 offset:4032
    ds_read_b64_tr_b16 a[84:85], v236 offset:5040
    ds_read_b64_tr_b16 a[86:87], v236 offset:8112
    ds_read_b64_tr_b16 a[88:89], v236 offset:11200
    ds_read_b64_tr_b16 a[90:91], v236 offset:14272
    ds_read_b64_tr_b16 a[92:93], v237 offset:5040
    ds_read_b64_tr_b16 a[94:95], v237 offset:8112
    global_load_dwordx4 v[224:227], v6, s[60:61] offset:-1024
    global_load_dwordx4 v[228:231], v6, s[60:61] offset:0
    global_load_dwordx4 v[232:235], v6, s[60:61] offset:1024
    global_load_dwordx4 v[236:239], v6, s[60:61] offset:2048
    buffer_load_dwordx4 a[124:127], v252, s[36:39], s71 offen offset:3072 sc1
    buffer_load_dwordx4 a[128:131], v252, s[36:39], s72 offen offset:0 sc1
    buffer_load_dwordx4 a[132:135], v252, s[36:39], s72 offen offset:1024 sc1
    v_mfma_f32_16x16x32_bf16 v[152:155], a[0:3], v[164:167], v[152:155]
    s_waitcnt lgkmcnt(15)
    v_mfma_f32_16x16x32_bf16 v[156:159], a[4:7], v[164:167], v[156:159]
    v_mfma_f32_16x16x32_bf16 v[160:163], a[8:11], v[164:167], v[160:163]
    v_mfma_f32_16x16x32_bf16 v[152:155], a[12:15], v[164:167], v[152:155]
    v_mfma_f32_16x16x32_bf16 v[156:159], a[16:19], v[164:167], v[156:159]
    v_mfma_f32_16x16x32_bf16 v[160:163], a[20:23], v[164:167], v[160:163]
    v_mfma_f32_16x16x32_bf16 v[152:155], a[24:27], v[164:167], v[152:155]
    v_mfma_f32_16x16x32_bf16 v[156:159], a[28:31], v[164:167], v[156:159]
    v_mfma_f32_16x16x32_bf16 v[160:163], a[32:35], v[164:167], v[160:163]
    v_mfma_f32_16x16x32_bf16 v[152:155], a[36:39], v[164:167], v[152:155]
    v_mfma_f32_16x16x32_bf16 v[156:159], a[40:43], v[164:167], v[156:159]
    v_mfma_f32_16x16x32_bf16 v[160:163], a[44:47], v[164:167], v[160:163]
    v_mfma_f32_16x16x32_bf16 v[152:155], a[48:51], v[164:167], v[152:155]
    v_mfma_f32_16x16x32_bf16 v[156:159], a[52:55], v[164:167], v[156:159]
    v_mfma_f32_16x16x32_bf16 v[160:163], a[56:59], v[164:167], v[160:163]
    v_mfma_f32_16x16x32_bf16 v[152:155], a[60:63], v[164:167], v[152:155]
    s_waitcnt lgkmcnt(14)
    v_mfma_f32_16x16x32_bf16 v[156:159], a[64:67], v[164:167], v[156:159]
    s_waitcnt lgkmcnt(12)
    v_mfma_f32_16x16x32_bf16 v[160:163], a[68:71], v[164:167], v[160:163]
    s_waitcnt lgkmcnt(10)
    v_mfma_f32_16x16x32_bf16 v[152:155], a[72:75], v[164:167], v[152:155]
    s_waitcnt lgkmcnt(8)
    v_mfma_f32_16x16x32_bf16 v[156:159], a[76:79], v[164:167], v[156:159]
    s_waitcnt lgkmcnt(6)
    v_mfma_f32_16x16x32_bf16 v[160:163], a[80:83], v[164:167], v[160:163]
    s_waitcnt lgkmcnt(4)
    v_mfma_f32_16x16x32_bf16 v[152:155], a[84:87], v[164:167], v[152:155]
    s_waitcnt lgkmcnt(2)
    v_mfma_f32_16x16x32_bf16 v[156:159], a[88:91], v[164:167], v[156:159]
    s_waitcnt lgkmcnt(0)
    v_mfma_f32_16x16x32_bf16 v[160:163], a[92:95], v[164:167], v[160:163]
    s_nop 3
    buffer_store_dwordx4 v[152:155], v146, s[36:39], s6 offen offset:0 sc1
    s_nop 0
    buffer_store_dwordx4 v[156:159], v146, s[36:39], s6 offen offset:256 sc1
    s_nop 0
    buffer_store_dwordx4 v[160:163], v146, s[36:39], s6 offen offset:512 sc1
    buffer_load_dwordx4 a[136:139], v252, s[36:39], s72 offen offset:2048 sc1
    buffer_load_dwordx4 a[140:143], v252, s[36:39], s72 offen offset:3072 sc1
    buffer_load_dwordx4 a[144:147], v252, s[36:39], s73 offen offset:0 sc1
    buffer_load_dwordx4 a[148:151], v252, s[36:39], s73 offen offset:1024 sc1
    buffer_load_dwordx4 a[152:155], v252, s[36:39], s73 offen offset:2048 sc1
    buffer_load_dwordx4 a[156:159], v252, s[36:39], s73 offen offset:3072 sc1
    s_mov_b32 s32, 8192
    buffer_load_dword v5, v3, s[36:39], s32 offen offset:128 sc1
    buffer_load_dwordx4 a[160:163], v252, s[36:39], s74 offen offset:0 sc1
    buffer_load_dwordx4 a[164:167], v252, s[36:39], s74 offen offset:1024 sc1
    buffer_load_dwordx4 a[168:171], v252, s[36:39], s74 offen offset:2048 sc1
    buffer_load_dwordx4 a[172:175], v252, s[36:39], s74 offen offset:3072 sc1
    buffer_load_dwordx4 a[176:179], v252, s[36:39], s75 offen offset:0 sc1
    s_mul_i32 s49, s46, 12
    s_lshl_b32 s12, s49, 8
    s_add_u32 s12, s12, 163840
    s_mul_i32 s50, s45, 384
    s_add_u32 s49, s49, s50
    s_lshl_b32 s49, s49, 9
    s_add_u32 s34, s49, 16777216
    s_and_b32 s51, s46, 7
    s_lshl_b32 s49, s51, 2
    s_add_u32 s49, s49, s44
    s_mul_i32 s49, s49, 61440
    s_add_u32 s49, s49, 14680064
    v_add_u32 v240, s49, v6
    s_lshl_b32 s3, s45, 12
    s_add_u32 s3, s3, 32768
    s_lshl_b32 s35, s45, 8
    s_add_u32 s35, s35, 20480
    s_mov_b32 s40, s30
    s_mov_b32 s41, s31
    s_mov_b32 s42, 2621440
    s_mov_b32 s43, 0x20000
    s_lshr_b32 s52, s46, 3
    s_lshl_b32 s49, s45, 1
    s_add_u32 s49, s49, s52
    s_mul_i32 s50, s49, 98304
    s_add_u32 s50, s50, 16777216
    s_mul_i32 s49, s49, 40960
    s_mul_i32 s47, s51, 160
    s_add_u32 s47, s47, s49
    s_mul_i32 s51, s51, 10240
    s_lshl_b32 s52, s52, 5
    s_waitcnt vmcnt(18)
    v_add_u32 v237, s50, v237
    v_xor_b32 v228, s52, v228
    v_add_u32 v228, s51, v228
    v_xor_b32 v229, s52, v229
    v_add_u32 v229, s51, v229
    v_xor_b32 v230, s52, v230
    v_add_u32 v230, s51, v230
    s_waitcnt vmcnt(5)
    v_cmp_gt_u32 vcc, 1, v5
    s_nop 0
    s_and_b64 vcc, vcc, s[58:59]
    s_cbranch_scc1 L_spin_37
L_back_38:
    s_mov_b32 s32, 16384
    buffer_load_dword v5, v3, s[36:39], s32 offen offset:128 sc1
    s_waitcnt vmcnt(0)
    v_cmp_gt_u32 vcc, 10, v5
    s_nop 0
    s_and_b64 vcc, vcc, s[58:59]
    s_cbranch_scc1 L_spin_39
L_back_40:
    s_barrier
    s_add_u32 s62, s33, 12288
    buffer_atomic_add v4, v2, s[36:39], s62 offen offset:128 sc1
    v_mov_b32 v247, 2147483632
    v_mov_b32 v243, 2147352560
    v_mov_b32 v244, v224
    s_lshl_b32 m0, s44, 10
    s_nop 0
    buffer_load_dwordx4 v254, s[36:39], s64 offen sc1 lds
    s_add_u32 m0, m0, 4096
    s_nop 0
    buffer_load_dwordx4 v254, s[36:39], s65 offen sc1 lds
    s_add_u32 m0, m0, 4096
    s_nop 0
    buffer_load_dwordx4 v254, s[36:39], s66 offen sc1 lds
    s_add_u32 m0, m0, 4096
    s_nop 0
    buffer_load_dwordx4 v254, s[36:39], s67 offen sc1 lds
    s_add_u32 m0, m0, 4096
    s_nop 0
    buffer_load_dwordx4 v254, s[36:39], s68 offen sc1 lds
    buffer_store_dword v4, v247, s[36:39], 0 offen
    buffer_store_dword v4, v247, s[36:39], 0 offen
    s_branch L_g1
L_spin_1:
    s_sleep 1
    buffer_load_dword v5, v253, s[40:43], 0 offen sc1
    s_waitcnt vmcnt(0)
    v_cmp_gt_u32 vcc, 1, v5
    s_nop 0
    s_and_b64 vcc, vcc, s[58:59]
    s_cbranch_scc0 L_back_2
    s_sub_u32 s48, s48, 1
    s_cbranch_scc0 L_spin_1
    s_mov_b32 s48, 0
    s_branch L_back_2
L_spin_3:
    s_sleep 1
    s_mov_b32 s32, 0
    buffer_load_dword v5, v3, s[36:39], s32 offen offset:128 sc1
    s_waitcnt vmcnt(0)
    v_cmp_gt_u32 vcc, 16, v5
    s_nop 0
    s_and_b64 vcc, vcc, s[58:59]
    s_cbranch_scc0 L_back_4
    s_sub_u32 s48, s48, 1
    s_cbranch_scc0 L_spin_3
    s_mov_b32 s48, 0
    s_branch L_back_4
L_spin_5:
    s_sleep 1
    s_mov_b32 s32, 16384
    buffer_load_dword v5, v3, s[36:39], s32 offen offset:128 sc1
    s_waitcnt vmcnt(0)
    v_cmp_gt_u32 vcc, 10, v5
    s_nop 0
    s_and_b64 vcc, vcc, s[58:59]
    s_cbranch_scc0 L_back_6
    s_sub_u32 s48, s48, 1
    s_cbranch_scc0 L_spin_5
    s_mov_b32 s48, 0
    s_branch L_back_6
L_spin_7:
    s_sleep 1
    s_mov_b32 s32, 8192
    buffer_load_dword v5, v3, s[36:39], s32 offen offset:128 sc1
    s_waitcnt vmcnt(0)
    v_cmp_gt_u32 vcc, 1, v5
    s_nop 0
    s_and_b64 vcc, vcc, s[58:59]
    s_cbranch_scc0 L_back_8
    s_sub_u32 s48, s48, 1
    s_cbranch_scc0 L_spin_7
    s_mov_b32 s48, 0
    s_branch L_back_8
L_spin_9:
    s_sleep 1
    buffer_load_dword v5, v255, s[36:39], s16 offen offset:128 sc1
    s_waitcnt vmcnt(0)
    v_cmp_gt_u32 vcc, 6, v5
    s_nop 0
    s_and_b64 vcc, vcc, s[58:59]
    s_cbranch_scc0 L_back_10
    s_sub_u32 s48, s48, 1
    s_cbranch_scc0 L_spin_9
    s_mov_b32 s48, 0
    s_branch L_back_10
L_spin_23:
    s_sleep 1
    s_mov_b32 s32, 12288
    buffer_load_dword v5, v3, s[36:39], s32 offen offset:128 sc1
    s_waitcnt vmcnt(0)
    v_cmp_gt_u32 vcc, 16, v5
    s_nop 0
    s_and_b64 vcc, vcc, s[58:59]
    s_cbranch_scc0 L_back_24
    s_sub_u32 s48, s48, 1
    s_cbranch_scc0 L_spin_23
    s_mov_b32 s48, 0
    s_branch L_back_24
L_spin_25:
    s_sleep 1
    buffer_load_dwordx2 v[164:165], v235, s[36:39], s3 offen offset:0 sc1
    buffer_load_dwordx2 v[166:167], v235, s[36:39], s3 offen offset:256 sc1
    buffer_load_dwordx2 v[168:169], v235, s[36:39], s3 offen offset:512 sc1
    buffer_load_dwordx2 v[170:171], v235, s[36:39], s3 offen offset:768 sc1
    s_waitcnt vmcnt(0)
    v_and_b32 v162, v165, v167
    v_and_b32 v163, v169, v171
    v_and_b32 v162, v162, v163
    v_cmp_le_i32 vcc, 0, v162
    s_nop 0
    s_cmp_lg_u64 vcc, 0
    s_cbranch_scc0 L_back_26
    s_sub_u32 s48, s48, 1
    s_cbranch_scc0 L_spin_25
    s_mov_b32 s48, 0
    s_branch L_back_26
L_spin_27:
    s_sleep 1
    buffer_load_dwordx2 v[164:165], v235, s[36:39], s3 offen offset:0 sc1
    buffer_load_dwordx2 v[166:167], v235, s[36:39], s3 offen offset:256 sc1
    buffer_load_dwordx2 v[168:169], v235, s[36:39], s3 offen offset:512 sc1
    buffer_load_dwordx2 v[170:171], v235, s[36:39], s3 offen offset:768 sc1
    s_waitcnt vmcnt(0)
    v_and_b32 v162, v165, v167
    v_and_b32 v163, v169, v171
    v_and_b32 v162, v162, v163
    v_cmp_le_i32 vcc, 0, v162
    s_nop 0
    s_cmp_lg_u64 vcc, 0
    s_cbranch_scc0 L_back_28
    s_sub_u32 s48, s48, 1
    s_cbranch_scc0 L_spin_27
    s_mov_b32 s48, 0
    s_branch L_back_28
L_spin_29:
    s_sleep 1
    buffer_load_dword v5, v255, s[36:39], s35 offen offset:128 sc1
    s_waitcnt vmcnt(0)
    v_cmp_gt_u32 vcc, 16, v5
    s_nop 0
    s_and_b64 vcc, vcc, s[58:59]
    s_cbranch_scc0 L_back_30
    s_sub_u32 s48, s48, 1
    s_cbranch_scc0 L_spin_29
    s_mov_b32 s48, 0
    s_branch L_back_30
L_spin_31:
    s_sleep 1
    buffer_load_dword v5, v255, s[36:39], s35 offen offset:128 sc1
    s_waitcnt vmcnt(0)
    v_cmp_gt_u32 vcc, 16, v5
    s_nop 0
    s_and_b64 vcc, vcc, s[58:59]
    s_cbranch_scc0 L_back_32
    s_sub_u32 s48, s48, 1
    s_cbranch_scc0 L_spin_31
    s_mov_b32 s48, 0
    s_branch L_back_32
L_spin_33:
    s_sleep 1
    buffer_load_dword v5, v253, s[40:43], 0 offen sc1
    s_waitcnt vmcnt(0)
    v_cmp_gt_u32 vcc, 1, v5
    s_nop 0
    s_and_b64 vcc, vcc, s[58:59]
    s_cbranch_scc0 L_back_34
    s_sub_u32 s48, s48, 1
    s_cbranch_scc0 L_spin_33
    s_mov_b32 s48, 0
    s_branch L_back_34
L_spin_35:
    s_sleep 2
    buffer_load_dword v5, v255, s[36:39], s16 offen offset:128 sc1
    s_waitcnt vmcnt(0)
    v_cmp_gt_u32 vcc, 6, v5
    s_nop 0
    s_and_b64 vcc, vcc, s[58:59]
    s_cbranch_scc0 L_back_36
    s_sub_u32 s48, s48, 1
    s_cbranch_scc0 L_spin_35
    s_mov_b32 s48, 0
    s_branch L_back_36
L_spin_37:
    s_sleep 2
    s_mov_b32 s32, 8192
    buffer_load_dword v5, v3, s[36:39], s32 offen offset:128 sc1
    s_waitcnt vmcnt(0)
    v_cmp_gt_u32 vcc, 1, v5
    s_nop 0
    s_and_b64 vcc, vcc, s[58:59]
    s_cbranch_scc0 L_back_38
    s_sub_u32 s48, s48, 1
    s_cbranch_scc0 L_spin_37
    s_mov_b32 s48, 0
    s_branch L_back_38
L_spin_39:
    s_sleep 4
    s_mov_b32 s32, 16384
    buffer_load_dword v5, v3, s[36:39], s32 offen offset:128 sc1
    s_waitcnt vmcnt(0)
    v_cmp_gt_u32 vcc, 10, v5
    s_nop 0
    s_and_b64 vcc, vcc, s[58:59]
    s_cbranch_scc0 L_back_40
    s_sub_u32 s48, s48, 1
    s_cbranch_scc0 L_spin_39
    s_mov_b32 s48, 0
    s_branch L_back_40
    s_endpgm
.p2align 7
.type K_ramp1,@object
K_ramp1:
.long 0x0,0x1000,0x2000,0x3000,0x4000,0x5000,0x6000,0x7000,0x8000,0x9000,0xa000,0xb000,0xc000,0xd000,0xe000,0xf000
.long 0x10000,0x11000,0x12000,0x13000,0x14000,0x15000,0x16000,0x17000,0x18000,0x19000,0x1a000,0x1b000,0x1c000,0x1d000,0x1e000,0x1f000
.size K_ramp1, .-K_ramp1
.type K_ctab,@object
K_ctab:
.long 0x1cf00,0x1cf00,0x1cf00,0x1e000,0x1cf20,0x1cf20,0x1cf04,0x1e000,0x1cf40,0x1cf40,0x1cf08,0x1e004,0x1cf60,0x1cf60,0x1cf0c,0x1e004
.long 0x1cf80,0x1cf80,0x1cf10,0x1e008,0x1cfa0,0x1cfa0,0x1cf14,0x1e008,0x1cfc0,0x1cfc0,0x1cf18,0x1e00c,0x1cfe0,0x1cfe0,0x1cf1c,0x1e00c
.long 0x1d000,0x1d000,0x1cf20,0x1e010,0x1d020,0x1d020,0x1cf24,0x1e010,0x1d040,0x1d040,0x1cf28,0x1e014,0x1d060,0x1d060,0x1cf2c,0x1e014
.long 0x1d080,0x1d080,0x1cf30,0x1e018,0x1d0a0,0x1d0a0,0x1cf34,0x1e018,0x1d0c0,0x1d0c0,0x1cf38,0x1e01c,0x1d0e0,0x1d0e0,0x1cf3c,0x1e01c
.long 0x1d100,0x1d100,0x1cf40,0x1e020,0x1d120,0x1d120,0x1cf44,0x1e020,0x1d140,0x1d140,0x1cf48,0x1e024,0x1d160,0x1d160,0x1cf4c,0x1e024
.long 0x1d180,0x1d180,0x1cf50,0x1e028,0x1d1a0,0x1d1a0,0x1cf54,0x1e028,0x1d1c0,0x1d1c0,0x1cf58,0x1e02c,0x1d1e0,0x1d1e0,0x1cf5c,0x1e02c
.long 0x1d200,0x1d200,0x1cf60,0x1e030,0x1d220,0x1d220,0x1cf64,0x1e030,0x1d240,0x1d240,0x1cf68,0x1e034,0x1d260,0x1d260,0x1cf6c,0x1e034
.long 0x1d280,0x1d280,0x1cf70,0x1e038,0x1d2a0,0x1d2a0,0x1cf74,0x1e038,0x1d2c0,0x1d2c0,0x1cf78,0x1e03c,0x1d2e0,0x1d2e0,0x1cf7c,0x1e03c
.long 0x1cf10,0x1d300,0x1cf80,0x1e040,0x1cf30,0x1d320,0x1cf84,0x1e040,0x1cf50,0x1d340,0x1cf88,0x1e044,0x1cf70,0x1d360,0x1cf8c,0x1e044
.long 0x1cf90,0x1d380,0x1cf90,0x1e048,0x1cfb0,0x1d3a0,0x1cf94,0x1e048,0x1cfd0,0x1d3c0,0x1cf98,0x1e04c,0x1cff0,0x1d3e0,0x1cf9c,0x1e04c
.long 0x1d010,0x1d400,0x1cfa0,0x1e050,0x1d030,0x1d420,0x1cfa4,0x1e050,0x1d050,0x1d440,0x1cfa8,0x1e054,0x1d070,0x1d460,0x1cfac,0x1e054
.long 0x1d090,0x1d480,0x1cfb0,0x1e058,0x1d0b0,0x1d4a0,0x1cfb4,0x1e058,0x1d0d0,0x1d4c0,0x1cfb8,0x1e05c,0x1d0f0,0x1d4e0,0x1cfbc,0x1e05c
.long 0x1d110,0x1d500,0x1cfc0,0x1e060,0x1d130,0x1d520,0x1cfc4,0x1e060,0x1d150,0x1d540,0x1cfc8,0x1e064,0x1d170,0x1d560,0x1cfcc,0x1e064
.long 0x1d190,0x1d580,0x1cfd0,0x1e068,0x1d1b0,0x1d5a0,0x1cfd4,0x1e068,0x1d1d0,0x1d5c0,0x1cfd8,0x1e06c,0x1d1f0,0x1d5e0,0x1cfdc,0x1e06c
.long 0x1d210,0x1d600,0x1cfe0,0x1e070,0x1d230,0x1d620,0x1cfe4,0x1e070,0x1d250,0x1d640,0x1cfe8,0x1e074,0x1d270,0x1d660,0x1cfec,0x1e074
.long 0x1d290,0x1d680,0x1cff0,0x1e078,0x1d2b0,0x1d6a0,0x1cff4,0x1e078,0x1d2d0,0x1d6c0,0x1cff8,0x1e07c,0x1d2f0,0x1d6e0,0x1cffc,0x1e07c
.long 0x1,0x0,0x0,0x0,0x10000,0x0,0x0,0x0,0x0,0x1,0x0,0x0,0x0,0x10000,0x0,0x0
.long 0x0,0x0,0x1,0x0,0x0,0x0,0x10000,0x0,0x0,0x0,0x0,0x1,0x0,0x0,0x0,0x10000
.long 0x0,0x0,0x0,0x0,0x0,0x0,0x0,0x0,0x0,0x0,0x0,0x0,0x0,0x0,0x0,0x0
.long 0x0,0x0,0x0,0x0,0x0,0x0,0x0,0x0,0x0,0x0,0x0,0x0,0x0,0x0,0x0,0x0
.long 0x0,0x0,0x0,0x0,0x0,0x0,0x0,0x0,0x0,0x0,0x0,0x0,0x0,0x0,0x0,0x0
.long 0x0,0x0,0x0,0x0,0x0,0x0,0x0,0x0,0x0,0x0,0x0,0x0,0x0,0x0,0x0,0x0
.long 0x1,0x0,0x0,0x0,0x10000,0x0,0x0,0x0,0x0,0x1,0x0,0x0,0x0,0x10000,0x0,0x0
.long 0x0,0x0,0x1,0x0,0x0,0x0,0x10000,0x0,0x0,0x0,0x0,0x1,0x0,0x0,0x0,0x10000
.long 0x1,0x0,0x0,0x0,0x10000,0x0,0x0,0x0,0x0,0x1,0x0,0x0,0x0,0x10000,0x0,0x0
.long 0x0,0x0,0x1,0x0,0x0,0x0,0x10000,0x0,0x0,0x0,0x0,0x1,0x0,0x0,0x0,0x10000
.long 0x0,0x0,0x0,0x0,0x0,0x0,0x0,0x0,0x0,0x0,0x0,0x0,0x0,0x0,0x0,0x0
.long 0x0,0x0,0x0,0x0,0x0,0x0,0x0,0x0,0x0,0x0,0x0,0x0,0x0,0x0,0x0,0x0
.long 0x0,0x0,0x0,0x0,0x0,0x0,0x0,0x0,0x0,0x0,0x0,0x0,0x0,0x0,0x0,0x0
.long 0x0,0x0,0x0,0x0,0x0,0x0,0x0,0x0,0x0,0x0,0x0,0x0,0x0,0x0,0x0,0x0
.long 0x1,0x0,0x0,0x0,0x10000,0x0,0x0,0x0,0x0,0x1,0x0,0x0,0x0,0x10000,0x0,0x0
.long 0x0,0x0,0x1,0x0,0x0,0x0,0x10000,0x0,0x0,0x0,0x0,0x1,0x0,0x0,0x0,0x10000
.long 0x1cf68,0x1dff4,0x13e70,0x14010,0x1cf6c,0x1dff8,0x13f00,0x14120,0x1cf70,0x1dffc,0x14010,0x14230,0x1cf74,0x1e000,0x14120,0x14340
.long 0x1cf78,0x1e004,0x14230,0x14450,0x1cf7c,0x1e008,0x14340,0x14560,0x1cf80,0x1e00c,0x14450,0x14670,0x1cf84,0x1e010,0x14560,0x14700
.long 0x1cf88,0x1e014,0x14670,0x14810,0x1cf8c,0x1e018,0x14700,0x14920,0x1cf90,0x1e01c,0x14810,0x14a30,0x1cf94,0x1e020,0x14920,0x14b40
.long 0x1cf98,0x1e024,0x14a30,0x14c50,0x1cf9c,0x1e028,0x14b40,0x14d60,0x1cfa0,0x1e02c,0x14c50,0x14e70,0x1cfa4,0x1e030,0x14d60,0x14f00
.long 0x1cf48,0x1dfe4,0x13ef0,0x14090,0x1cf4c,0x1dfe8,0x13f80,0x141a0,0x1cf50,0x1dfec,0x14090,0x142b0,0x1cf54,0x1dff0,0x141a0,0x143c0
.long 0x1cf58,0x1dff4,0x142b0,0x144d0,0x1cf5c,0x1dff8,0x143c0,0x145e0,0x1cf60,0x1dffc,0x144d0,0x146f0,0x1cf64,0x1e000,0x145e0,0x14780
.long 0x1cf68,0x1e004,0x146f0,0x14890,0x1cf6c,0x1e008,0x14780,0x149a0,0x1cf70,0x1e00c,0x14890,0x14ab0,0x1cf74,0x1e010,0x149a0,0x14bc0
.long 0x1cf78,0x1e014,0x14ab0,0x14cd0,0x1cf7c,0x1e018,0x14bc0,0x14de0,0x1cf80,0x1e01c,0x14cd0,0x14ef0,0x1cf84,0x1e020,0x14de0,0x14f80
.long 0x1cf28,0x1dfd4,0x13f00,0x14120,0x1cf2c,0x1dfd8,0x14010,0x14230,0x1cf30,0x1dfdc,0x14120,0x14340,0x1cf34,0x1dfe0,0x14230,0x14450
.long 0x1cf38,0x1dfe4,0x14340,0x14560,0x1cf3c,0x1dfe8,0x14450,0x14670,0x1cf40,0x1dfec,0x14560,0x14700,0x1cf44,0x1dff0,0x14670,0x14810
.long 0x1cf48,0x1dff4,0x14700,0x14920,0x1cf4c,0x1dff8,0x14810,0x14a30,0x1cf50,0x1dffc,0x14920,0x14b40,0x1cf54,0x1e000,0x14a30,0x14c50
.long 0x1cf58,0x1e004,0x14b40,0x14d60,0x1cf5c,0x1e008,0x14c50,0x14e70,0x1cf60,0x1e00c,0x14d60,0x14f00,0x1cf64,0x1e010,0x14e70,0x15010
.long 0x1cf08,0x1dfc4,0x13f80,0x141a0,0x1cf0c,0x1dfc8,0x14090,0x142b0,0x1cf10,0x1dfcc,0x141a0,0x143c0,0x1cf14,0x1dfd0,0x142b0,0x144d0
.long 0x1cf18,0x1dfd4,0x143c0,0x145e0,0x1cf1c,0x1dfd8,0x144d0,0x146f0,0x1cf20,0x1dfdc,0x145e0,0x14780,0x1cf24,0x1dfe0,0x146f0,0x14890
.long 0x1cf28,0x1dfe4,0x14780,0x149a0,0x1cf2c,0x1dfe8,0x14890,0x14ab0,0x1cf30,0x1dfec,0x149a0,0x14bc0,0x1cf34,0x1dff0,0x14ab0,0x14cd0
.long 0x1cf38,0x1dff4,0x14bc0,0x14de0,0x1cf3c,0x1dff8,0x14cd0,0x14ef0,0x1cf40,0x1dffc,0x14de0,0x14f80,0x1cf44,0x1e000,0x14ef0,0x15090
.long 0x14230,0x14450,0x14de0,0x14f40,0x14340,0x14560,0x14ef0,0x15050,0x14450,0x14670,0x14f80,0x15160,0x14560,0x14700,0x15090,0x15270
.long 0x14670,0x14810,0x151a0,0x15300,0x14700,0x14920,0x152b0,0x15410,0x14810,0x14a30,0x153c0,0x15520,0x14920,0x14b40,0x154d0,0x15630
.long 0x14a30,0x14c50,0x155e0,0x15740,0x14b40,0x14d60,0x156f0,0x15850,0x14c50,0x14e70,0x15780,0x15960,0x14d60,0x14f00,0x15890,0x15a70
.long 0x14e70,0x15010,0x159a0,0x15b00,0x14f00,0x15120,0x15ab0,0x15c10,0x15010,0x15230,0x15bc0,0x15d20,0x15120,0x15340,0x15cd0,0x15e30
.long 0x142b0,0x144d0,0x14e70,0x14fc0,0x143c0,0x145e0,0x14f00,0x150d0,0x144d0,0x146f0,0x15010,0x151e0,0x145e0,0x14780,0x15120,0x152f0
.long 0x146f0,0x14890,0x15230,0x15380,0x14780,0x149a0,0x15340,0x15490,0x14890,0x14ab0,0x15450,0x155a0,0x149a0,0x14bc0,0x15560,0x156b0
.long 0x14ab0,0x14cd0,0x15670,0x157c0,0x14bc0,0x14de0,0x15700,0x158d0,0x14cd0,0x14ef0,0x15810,0x159e0,0x14de0,0x14f80,0x15920,0x15af0
.long 0x14ef0,0x15090,0x15a30,0x15b80,0x14f80,0x151a0,0x15b40,0x15c90,0x15090,0x152b0,0x15c50,0x15da0,0x151a0,0x153c0,0x15d60,0x15eb0
.long 0x14340,0x14560,0x14ef0,0x14f00,0x14450,0x14670,0x14f80,0x15010,0x14560,0x14700,0x15090,0x15120,0x14670,0x14810,0x151a0,0x15230
.long 0x14700,0x14920,0x152b0,0x15340,0x14810,0x14a30,0x153c0,0x15450,0x14920,0x14b40,0x154d0,0x15560,0x14a30,0x14c50,0x155e0,0x15670
.long 0x14b40,0x14d60,0x156f0,0x15700,0x14c50,0x14e70,0x15780,0x15810,0x14d60,0x14f00,0x15890,0x15920,0x14e70,0x15010,0x159a0,0x15a30
.long 0x14f00,0x15120,0x15ab0,0x15b40,0x15010,0x15230,0x15bc0,0x15c50,0x15120,0x15340,0x15cd0,0x15d60,0x15230,0x15450,0x15de0,0x15e70
.long 0x143c0,0x145e0,0x14f00,0x14f80,0x144d0,0x146f0,0x15010,0x15090,0x145e0,0x14780,0x15120,0x151a0,0x146f0,0x14890,0x15230,0x152b0
.long 0x14780,0x149a0,0x15340,0x153c0,0x14890,0x14ab0,0x15450,0x154d0,0x149a0,0x14bc0,0x15560,0x155e0,0x14ab0,0x14cd0,0x15670,0x156f0
.long 0x14bc0,0x14de0,0x15700,0x15780,0x14cd0,0x14ef0,0x15810,0x15890,0x14de0,0x14f80,0x15920,0x159a0,0x14ef0,0x15090,0x15a30,0x15ab0
.long 0x14f80,0x151a0,0x15b40,0x15bc0,0x15090,0x152b0,0x15c50,0x15cd0,0x151a0,0x153c0,0x15d60,0x15de0,0x152b0,0x154d0,0x15e70,0x15ef0
.long 0x0,0x0,0x0,0x0,0x10,0x10,0x10,0x10,0x20,0x20,0x20,0x20,0x30,0x30,0x30,0x30
.long 0x14080,0x14080,0x14080,0x14080,0x14090,0x14090,0x14090,0x14090,0x140a0,0x140a0,0x140a0,0x140a0,0x140b0,0x140b0,0x140b0,0x140b0
.long 0x28100,0x28100,0x28100,0x28100,0x28110,0x28110,0x28110,0x28110,0x28120,0x28120,0x28120,0x28120,0x28130,0x28130,0x28130,0x28130
.long 0x3c180,0x3c180,0x3c180,0x3c180,0x3c190,0x3c190,0x3c190,0x3c190,0x3c1a0,0x3c1a0,0x3c1a0,0x3c1a0,0x3c1b0,0x3c1b0,0x3c1b0,0x3c1b0
.long 0x50200,0x50200,0x50200,0x50200,0x50210,0x50210,0x50210,0x50210,0x50220,0x50220,0x50220,0x50220,0x50230,0x50230,0x50230,0x50230
.long 0x64280,0x64280,0x64280,0x64280,0x64290,0x64290,0x64290,0x64290,0x642a0,0x642a0,0x642a0,0x642a0,0x642b0,0x642b0,0x642b0,0x642b0
.long 0x78300,0x78300,0x78300,0x78300,0x78310,0x78310,0x78310,0x78310,0x78320,0x78320,0x78320,0x78320,0x78330,0x78330,0x78330,0x78330
.long 0x8c380,0x8c380,0x8c380,0x8c380,0x8c390,0x8c390,0x8c390,0x8c390,0x8c3a0,0x8c3a0,0x8c3a0,0x8c3a0,0x8c3b0,0x8c3b0,0x8c3b0,0x8c3b0
.long 0x40,0x40,0x40,0x40,0x50,0x50,0x50,0x50,0x60,0x60,0x60,0x60,0x70,0x70,0x70,0x70
.long 0x140c0,0x140c0,0x140c0,0x140c0,0x140d0,0x140d0,0x140d0,0x140d0,0x140e0,0x140e0,0x140e0,0x140e0,0x140f0,0x140f0,0x140f0,0x140f0
.long 0x28140,0x28140,0x28140,0x28140,0x28150,0x28150,0x28150,0x28150,0x28160,0x28160,0x28160,0x28160,0x28170,0x28170,0x28170,0x28170
.long 0x3c1c0,0x3c1c0,0x3c1c0,0x3c1c0,0x3c1d0,0x3c1d0,0x3c1d0,0x3c1d0,0x3c1e0,0x3c1e0,0x3c1e0,0x3c1e0,0x3c1f0,0x3c1f0,0x3c1f0,0x3c1f0
.long 0x50240,0x50240,0x50240,0x50240,0x50250,0x50250,0x50250,0x50250,0x50260,0x50260,0x50260,0x50260,0x50270,0x50270,0x50270,0x50270
.long 0x642c0,0x642c0,0x642c0,0x642c0,0x642d0,0x642d0,0x642d0,0x642d0,0x642e0,0x642e0,0x642e0,0x642e0,0x642f0,0x642f0,0x642f0,0x642f0
.long 0x78340,0x78340,0x78340,0x78340,0x78350,0x78350,0x78350,0x78350,0x78360,0x78360,0x78360,0x78360,0x78370,0x78370,0x78370,0x78370
.long 0x8c3c0,0x8c3c0,0x8c3c0,0x8c3c0,0x8c3d0,0x8c3d0,0x8c3d0,0x8c3d0,0x8c3e0,0x8c3e0,0x8c3e0,0x8c3e0,0x8c3f0,0x8c3f0,0x8c3f0,0x8c3f0
.long 0x0,0x0,0x3f800000,0x3f803f80,0x0,0x0,0x0,0x3f803f80,0x0,0x0,0x0,0x3f800000,0x0,0x0,0x0,0x0
.long 0x0,0x0,0x0,0x0,0x0,0x0,0x0,0x0,0x0,0x0,0x0,0x0,0x0,0x0,0x0,0x0
.long 0x0,0x0,0x0,0x0,0x0,0x0,0x0,0x0,0x0,0x0,0x0,0x0,0x0,0x0,0x0,0x0
.long 0x0,0x0,0x0,0x0,0x0,0x0,0x0,0x0,0x0,0x0,0x0,0x0,0x0,0x0,0x0,0x0
.long 0x3f803f80,0x3f803f80,0x0,0x0,0x3f803f80,0x3f803f80,0x3f80,0x0,0x3f803f80,0x3f803f80,0x3f803f80,0x0,0x3f803f80,0x3f803f80,0x3f803f80,0x3f80
.long 0x3f800000,0x3f803f80,0x3f803f80,0x3f803f80,0x0,0x3f803f80,0x3f803f80,0x3f803f80,0x0,0x3f800000,0x3f803f80,0x3f803f80,0x0,0x0,0x3f803f80,0x3f803f80
.long 0x0,0x0,0x3f800000,0x3f803f80,0x0,0x0,0x0,0x3f803f80,0x0,0x0,0x0,0x3f800000,0x0,0x0,0x0,0x0
.long 0x0,0x0,0x0,0x0,0x0,0x0,0x0,0x0,0x0,0x0,0x0,0x0,0x0,0x0,0x0,0x0
.long 0x0,0x0,0x0,0x0,0x0,0x0,0x0,0x0,0x0,0x0,0x0,0x0,0x0,0x0,0x0,0x0
.long 0x0,0x0,0x0,0x0,0x3f80,0x0,0x0,0x0,0x3f803f80,0x0,0x0,0x0,0x3f803f80,0x3f80,0x0,0x0
.long 0x3f803f80,0x3f803f80,0x0,0x0,0x3f803f80,0x3f803f80,0x3f80,0x0,0x3f803f80,0x3f803f80,0x3f803f80,0x0,0x3f803f80,0x3f803f80,0x3f803f80,0x3f80
.long 0x3f800000,0x3f803f80,0x3f803f80,0x3f803f80,0x0,0x3f803f80,0x3f803f80,0x3f803f80,0x0,0x3f800000,0x3f803f80,0x3f803f80,0x0,0x0,0x3f803f80,0x3f803f80
.long 0x0,0x0,0x0,0x0,0x0,0x0,0x0,0x0,0x0,0x0,0x0,0x0,0x0,0x0,0x0,0x0
.long 0x0,0x0,0x0,0x0,0x0,0x0,0x0,0x0,0x0,0x0,0x0,0x0,0x0,0x0,0x0,0x0
.long 0x0,0x0,0x0,0x0,0x0,0x0,0x0,0x0,0x0,0x0,0x0,0x0,0x0,0x0,0x0,0x0
.long 0x0,0x0,0x0,0x0,0x3f80,0x0,0x0,0x0,0x3f803f80,0x0,0x0,0x0,0x3f803f80,0x3f80,0x0,0x0
.long 0x0,0x0,0x3f803f80,0x3f803f80,0x0,0x0,0x3f800000,0x3f803f80,0x0,0x0,0x0,0x3f803f80,0x0,0x0,0x0,0x3f800000
.long 0x0,0x0,0x0,0x0,0x0,0x0,0x0,0x0,0x0,0x0,0x0,0x0,0x0,0x0,0x0,0x0
.long 0x0,0x0,0x0,0x0,0x0,0x0,0x0,0x0,0x0,0x0,0x0,0x0,0x0,0x0,0x0,0x0
.long 0x0,0x0,0x0,0x0,0x0,0x0,0x0,0x0,0x0,0x0,0x0,0x0,0x0,0x0,0x0,0x0
.long 0x3f803f80,0x3f803f80,0x3f80,0x0,0x3f803f80,0x3f803f80,0x3f803f80,0x0,0x3f803f80,0x3f803f80,0x3f803f80,0x3f80,0x3f803f80,0x3f803f80,0x3f803f80,0x3f803f80
.long 0x3f803f80,0x3f803f80,0x3f803f80,0x3f803f80,0x3f800000,0x3f803f80,0x3f803f80,0x3f803f80,0x0,0x3f803f80,0x3f803f80,0x3f803f80,0x0,0x3f800000,0x3f803f80,0x3f803f80
.long 0x0,0x0,0x3f803f80,0x3f803f80,0x0,0x0,0x3f800000,0x3f803f80,0x0,0x0,0x0,0x3f803f80,0x0,0x0,0x0,0x3f800000
.long 0x0,0x0,0x0,0x0,0x0,0x0,0x0,0x0,0x0,0x0,0x0,0x0,0x0,0x0,0x0,0x0
.long 0x0,0x0,0x0,0x0,0x0,0x0,0x0,0x0,0x0,0x0,0x0,0x0,0x0,0x0,0x0,0x0
.long 0x3f80,0x0,0x0,0x0,0x3f803f80,0x0,0x0,0x0,0x3f803f80,0x3f80,0x0,0x0,0x3f803f80,0x3f803f80,0x0,0x0
.long 0x3f803f80,0x3f803f80,0x3f80,0x0,0x3f803f80,0x3f803f80,0x3f803f80,0x0,0x3f803f80,0x3f803f80,0x3f803f80,0x3f80,0x3f803f80,0x3f803f80,0x3f803f80,0x3f803f80
.long 0x3f803f80,0x3f803f80,0x3f803f80,0x3f803f80,0x3f800000,0x3f803f80,0x3f803f80,0x3f803f80,0x0,0x3f803f80,0x3f803f80,0x3f803f80,0x0,0x3f800000,0x3f803f80,0x3f803f80
.long 0x0,0x0,0x0,0x0,0x0,0x0,0x0,0x0,0x0,0x0,0x0,0x0,0x0,0x0,0x0,0x0
.long 0x0,0x0,0x0,0x0,0x0,0x0,0x0,0x0,0x0,0x0,0x0,0x0,0x0,0x0,0x0,0x0
.long 0x0,0x0,0x0,0x0,0x0,0x0,0x0,0x0,0x0,0x0,0x0,0x0,0x0,0x0,0x0,0x0
.long 0x3f80,0x0,0x0,0x0,0x3f803f80,0x0,0x0,0x0,0x3f803f80,0x3f80,0x0,0x0,0x3f803f80,0x3f803f80,0x0,0x0
.long 0x0,0x10,0x20,0x30,0x8,0x18,0x28,0x38,0x40,0x50,0x60,0x70,0x48,0x58,0x68,0x78
.long 0x80,0x90,0xa0,0xb0,0x88,0x98,0xa8,0xb8,0xc0,0xd0,0xe0,0xf0,0xc8,0xd8,0xe8,0xf8
.long 0x110,0x100,0x130,0x120,0x118,0x108,0x138,0x128,0x150,0x140,0x170,0x160,0x158,0x148,0x178,0x168
.long 0x190,0x180,0x1b0,0x1a0,0x198,0x188,0x1b8,0x1a8,0x1d0,0x1c0,0x1f0,0x1e0,0x1d8,0x1c8,0x1f8,0x1e8
.long 0x220,0x230,0x200,0x210,0x228,0x238,0x208,0x218,0x260,0x270,0x240,0x250,0x268,0x278,0x248,0x258
.long 0x2a0,0x2b0,0x280,0x290,0x2a8,0x2b8,0x288,0x298,0x2e0,0x2f0,0x2c0,0x2d0,0x2e8,0x2f8,0x2c8,0x2d8
.long 0x330,0x320,0x310,0x300,0x338,0x328,0x318,0x308,0x370,0x360,0x350,0x340,0x378,0x368,0x358,0x348
.long 0x3b0,0x3a0,0x390,0x380,0x3b8,0x3a8,0x398,0x388,0x3f0,0x3e0,0x3d0,0x3c0,0x3f8,0x3e8,0x3d8,0x3c8
.long 0x400,0x410,0x420,0x430,0x408,0x418,0x428,0x438,0x440,0x450,0x460,0x470,0x448,0x458,0x468,0x478
.long 0x480,0x490,0x4a0,0x4b0,0x488,0x498,0x4a8,0x4b8,0x4c0,0x4d0,0x4e0,0x4f0,0x4c8,0x4d8,0x4e8,0x4f8
.long 0x510,0x500,0x530,0x520,0x518,0x508,0x538,0x528,0x550,0x540,0x570,0x560,0x558,0x548,0x578,0x568
.long 0x590,0x580,0x5b0,0x5a0,0x598,0x588,0x5b8,0x5a8,0x5d0,0x5c0,0x5f0,0x5e0,0x5d8,0x5c8,0x5f8,0x5e8
.long 0x620,0x630,0x600,0x610,0x628,0x638,0x608,0x618,0x660,0x670,0x640,0x650,0x668,0x678,0x648,0x658
.long 0x6a0,0x6b0,0x680,0x690,0x6a8,0x6b8,0x688,0x698,0x6e0,0x6f0,0x6c0,0x6d0,0x6e8,0x6f8,0x6c8,0x6d8
.long 0x730,0x720,0x710,0x700,0x738,0x728,0x718,0x708,0x770,0x760,0x750,0x740,0x778,0x768,0x758,0x748
.long 0x7b0,0x7a0,0x790,0x780,0x7b8,0x7a8,0x798,0x788,0x7f0,0x7e0,0x7d0,0x7c0,0x7f8,0x7e8,0x7d8,0x7c8
.long 0x0,0x2000,0x1810,0x0,0x8,0x2008,0x1818,0xc000,0x40,0x2040,0x1850,0x18000,0x48,0x2048,0x1858,0x24000
.long 0x80,0x2080,0x1890,0x30000,0x88,0x2088,0x1898,0x3c000,0xc0,0x20c0,0x18d0,0x7ffffff0,0xc8,0x20c8,0x18d8,0x7ffffff0
.long 0x110,0x2110,0x1900,0x0,0x118,0x2118,0x1908,0xc000,0x150,0x2150,0x1940,0x18000,0x158,0x2158,0x1948,0x24000
.long 0x190,0x2190,0x1980,0x30000,0x198,0x2198,0x1988,0x3c000,0x1d0,0x21d0,0x19c0,0x7ffffff0,0x1d8,0x21d8,0x19c8,0x7ffffff0
.long 0x220,0x2220,0x1a30,0x40,0x228,0x2228,0x1a38,0xc040,0x260,0x2260,0x1a70,0x18040,0x268,0x2268,0x1a78,0x24040
.long 0x2a0,0x22a0,0x1ab0,0x30040,0x2a8,0x22a8,0x1ab8,0x3c040,0x2e0,0x22e0,0x1af0,0x7ffffff0,0x2e8,0x22e8,0x1af8,0x7ffffff0
.long 0x330,0x2330,0x1b20,0x40,0x338,0x2338,0x1b28,0xc040,0x370,0x2370,0x1b60,0x18040,0x378,0x2378,0x1b68,0x24040
.long 0x3b0,0x23b0,0x1ba0,0x30040,0x3b8,0x23b8,0x1ba8,0x3c040,0x3f0,0x23f0,0x1be0,0x7ffffff0,0x3f8,0x23f8,0x1be8,0x7ffffff0
.long 0x400,0x2400,0x1c10,0x80,0x408,0x2408,0x1c18,0xc080,0x440,0x2440,0x1c50,0x18080,0x448,0x2448,0x1c58,0x24080
.long 0x480,0x2480,0x1c90,0x30080,0x488,0x2488,0x1c98,0x3c080,0x4c0,0x24c0,0x1cd0,0x7ffffff0,0x4c8,0x24c8,0x1cd8,0x7ffffff0
.long 0x510,0x2510,0x1d00,0x80,0x518,0x2518,0x1d08,0xc080,0x550,0x2550,0x1d40,0x18080,0x558,0x2558,0x1d48,0x24080
.long 0x590,0x2590,0x1d80,0x30080,0x598,0x2598,0x1d88,0x3c080,0x5d0,0x25d0,0x1dc0,0x7ffffff0,0x5d8,0x25d8,0x1dc8,0x7ffffff0
.long 0x620,0x2620,0x1e30,0xc0,0x628,0x2628,0x1e38,0xc0c0,0x660,0x2660,0x1e70,0x180c0,0x668,0x2668,0x1e78,0x240c0
.long 0x6a0,0x26a0,0x1eb0,0x300c0,0x6a8,0x26a8,0x1eb8,0x3c0c0,0x6e0,0x26e0,0x1ef0,0x7ffffff0,0x6e8,0x26e8,0x1ef8,0x7ffffff0
.long 0x730,0x2730,0x1f20,0xc0,0x738,0x2738,0x1f28,0xc0c0,0x770,0x2770,0x1f60,0x180c0,0x778,0x2778,0x1f68,0x240c0
.long 0x7b0,0x27b0,0x1fa0,0x300c0,0x7b8,0x27b8,0x1fa8,0x3c0c0,0x7f0,0x27f0,0x1fe0,0x7ffffff0,0x7f8,0x27f8,0x1fe8,0x7ffffff0
.long 0x0,0x80,0x5060,0x0,0x500,0x580,0x5560,0x10,0xa00,0xa80,0x5a60,0x20,0xf00,0xf80,0x5f60,0x30
.long 0x1400,0x1480,0x6460,0x40,0x1900,0x1980,0x6960,0x50,0x1e00,0x1e80,0x6e60,0x60,0x2300,0x2380,0x7360,0x70
.long 0x2800,0x2880,0x7860,0x80,0x2d00,0x2d80,0x7d60,0x90,0x3200,0x3280,0x8260,0xa0,0x3700,0x3780,0x8760,0xb0
.long 0x3c00,0x3c80,0x8c60,0xc0,0x4100,0x4180,0x9160,0xd0,0x4600,0x4680,0x9660,0xe0,0x4b00,0x4b80,0x9b60,0xf0
.long 0x8,0x88,0x5068,0x400,0x508,0x588,0x5568,0x410,0xa08,0xa88,0x5a68,0x420,0xf08,0xf88,0x5f68,0x430
.long 0x1408,0x1488,0x6468,0x440,0x1908,0x1988,0x6968,0x450,0x1e08,0x1e88,0x6e68,0x460,0x2308,0x2388,0x7368,0x470
.long 0x2808,0x2888,0x7868,0x480,0x2d08,0x2d88,0x7d68,0x490,0x3208,0x3288,0x8268,0x4a0,0x3708,0x3788,0x8768,0x4b0
.long 0x3c08,0x3c88,0x8c68,0x4c0,0x4108,0x4188,0x9168,0x4d0,0x4608,0x4688,0x9668,0x4e0,0x4b08,0x4b88,0x9b68,0x4f0
.long 0x10,0x90,0x5070,0x800,0x510,0x590,0x5570,0x810,0xa10,0xa90,0x5a70,0x820,0xf10,0xf90,0x5f70,0x830
.long 0x1410,0x1490,0x6470,0x840,0x1910,0x1990,0x6970,0x850,0x1e10,0x1e90,0x6e70,0x860,0x2310,0x2390,0x7370,0x870
.long 0x2810,0x2890,0x7870,0x880,0x2d10,0x2d90,0x7d70,0x890,0x3210,0x3290,0x8270,0x8a0,0x3710,0x3790,0x8770,0x8b0
.long 0x3c10,0x3c90,0x8c70,0x8c0,0x4110,0x4190,0x9170,0x8d0,0x4610,0x4690,0x9670,0x8e0,0x4b10,0x4b90,0x9b70,0x8f0
.long 0x18,0x98,0x5078,0xc00,0x518,0x598,0x5578,0xc10,0xa18,0xa98,0x5a78,0xc20,0xf18,0xf98,0x5f78,0xc30
.long 0x1418,0x1498,0x6478,0xc40,0x1918,0x1998,0x6978,0xc50,0x1e18,0x1e98,0x6e78,0xc60,0x2318,0x2398,0x7378,0xc70
.long 0x2818,0x2898,0x7878,0xc80,0x2d18,0x2d98,0x7d78,0xc90,0x3218,0x3298,0x8278,0xca0,0x3718,0x3798,0x8778,0xcb0
.long 0x3c18,0x3c98,0x8c78,0xcc0,0x4118,0x4198,0x9178,0xcd0,0x4618,0x4698,0x9678,0xce0,0x4b18,0x4b98,0x9b78,0xcf0
.long 0x0,0x0,0x0,0x0,0x10,0x10,0x10,0x10,0x20,0x20,0x20,0x20,0x30,0x30,0x30,0x30
.long 0x40,0x40,0x40,0x40,0x50,0x50,0x50,0x50,0x60,0x60,0x60,0x60,0x70,0x70,0x70,0x70
.long 0x80,0x80,0x80,0x80,0x90,0x90,0x90,0x90,0xa0,0xa0,0xa0,0xa0,0xb0,0xb0,0xb0,0xb0
.long 0xc0,0xc0,0xc0,0xc0,0xd0,0xd0,0xd0,0xd0,0xe0,0xe0,0xe0,0xe0,0xf0,0xf0,0xf0,0xf0
.long 0x100,0x200,0x100,0x100,0x110,0x210,0x110,0x110,0x120,0x220,0x120,0x120,0x130,0x230,0x130,0x130
.long 0x140,0x240,0x140,0x140,0x150,0x250,0x150,0x150,0x160,0x260,0x160,0x160,0x170,0x270,0x170,0x170
.long 0x180,0x280,0x180,0x180,0x190,0x290,0x190,0x190,0x1a0,0x2a0,0x1a0,0x1a0,0x1b0,0x2b0,0x1b0,0x1b0
.long 0x1c0,0x2c0,0x1c0,0x1c0,0x1d0,0x2d0,0x1d0,0x1d0,0x1e0,0x2e0,0x1e0,0x1e0,0x1f0,0x2f0,0x1f0,0x1f0
.long 0x18000,0x400,0x200,0x200,0x18010,0x410,0x210,0x210,0x18020,0x420,0x220,0x220,0x18030,0x430,0x230,0x230
.long 0x18040,0x440,0x240,0x240,0x18050,0x450,0x250,0x250,0x18060,0x460,0x260,0x260,0x18070,0x470,0x270,0x270
.long 0x18080,0x480,0x280,0x280,0x18090,0x490,0x290,0x290,0x180a0,0x4a0,0x2a0,0x2a0,0x180b0,0x4b0,0x2b0,0x2b0
.long 0x180c0,0x4c0,0x2c0,0x2c0,0x180d0,0x4d0,0x2d0,0x2d0,0x180e0,0x4e0,0x2e0,0x2e0,0x180f0,0x4f0,0x2f0,0x2f0
.long 0x18100,0x600,0x300,0x300,0x18110,0x610,0x310,0x310,0x18120,0x620,0x320,0x320,0x18130,0x630,0x330,0x330
.long 0x18140,0x640,0x340,0x340,0x18150,0x650,0x350,0x350,0x18160,0x660,0x360,0x360,0x18170,0x670,0x370,0x370
.long 0x18180,0x680,0x380,0x380,0x18190,0x690,0x390,0x390,0x181a0,0x6a0,0x3a0,0x3a0,0x181b0,0x6b0,0x3b0,0x3b0
.long 0x181c0,0x6c0,0x3c0,0x3c0,0x181d0,0x6d0,0x3d0,0x3d0,0x181e0,0x6e0,0x3e0,0x3e0,0x181f0,0x6f0,0x3f0,0x3f0
.long 0x1e100,0x1e100,0x1e100,0x1f200,0x1e120,0x1e120,0x1e104,0x1f200,0x1e140,0x1e140,0x1e108,0x1f204,0x1e160,0x1e160,0x1e10c,0x1f204
.long 0x1e180,0x1e180,0x1e110,0x1f208,0x1e1a0,0x1e1a0,0x1e114,0x1f208,0x1e1c0,0x1e1c0,0x1e118,0x1f20c,0x1e1e0,0x1e1e0,0x1e11c,0x1f20c
.long 0x1e200,0x1e200,0x1e120,0x1f210,0x1e220,0x1e220,0x1e124,0x1f210,0x1e240,0x1e240,0x1e128,0x1f214,0x1e260,0x1e260,0x1e12c,0x1f214
.long 0x1e280,0x1e280,0x1e130,0x1f218,0x1e2a0,0x1e2a0,0x1e134,0x1f218,0x1e2c0,0x1e2c0,0x1e138,0x1f21c,0x1e2e0,0x1e2e0,0x1e13c,0x1f21c
.long 0x1e300,0x1e300,0x1e140,0x1f220,0x1e320,0x1e320,0x1e144,0x1f220,0x1e340,0x1e340,0x1e148,0x1f224,0x1e360,0x1e360,0x1e14c,0x1f224
.long 0x1e380,0x1e380,0x1e150,0x1f228,0x1e3a0,0x1e3a0,0x1e154,0x1f228,0x1e3c0,0x1e3c0,0x1e158,0x1f22c,0x1e3e0,0x1e3e0,0x1e15c,0x1f22c
.long 0x1e400,0x1e400,0x1e160,0x1f230,0x1e420,0x1e420,0x1e164,0x1f230,0x1e440,0x1e440,0x1e168,0x1f234,0x1e460,0x1e460,0x1e16c,0x1f234
.long 0x1e480,0x1e480,0x1e170,0x1f238,0x1e4a0,0x1e4a0,0x1e174,0x1f238,0x1e4c0,0x1e4c0,0x1e178,0x1f23c,0x1e4e0,0x1e4e0,0x1e17c,0x1f23c
.long 0x1e110,0x1e500,0x1e180,0x1f240,0x1e130,0x1e520,0x1e184,0x1f240,0x1e150,0x1e540,0x1e188,0x1f244,0x1e170,0x1e560,0x1e18c,0x1f244
.long 0x1e190,0x1e580,0x1e190,0x1f248,0x1e1b0,0x1e5a0,0x1e194,0x1f248,0x1e1d0,0x1e5c0,0x1e198,0x1f24c,0x1e1f0,0x1e5e0,0x1e19c,0x1f24c
.long 0x1e210,0x1e600,0x1e1a0,0x1f250,0x1e230,0x1e620,0x1e1a4,0x1f250,0x1e250,0x1e640,0x1e1a8,0x1f254,0x1e270,0x1e660,0x1e1ac,0x1f254
.long 0x1e290,0x1e680,0x1e1b0,0x1f258,0x1e2b0,0x1e6a0,0x1e1b4,0x1f258,0x1e2d0,0x1e6c0,0x1e1b8,0x1f25c,0x1e2f0,0x1e6e0,0x1e1bc,0x1f25c
.long 0x1e310,0x1e700,0x1e1c0,0x1f260,0x1e330,0x1e720,0x1e1c4,0x1f260,0x1e350,0x1e740,0x1e1c8,0x1f264,0x1e370,0x1e760,0x1e1cc,0x1f264
.long 0x1e390,0x1e780,0x1e1d0,0x1f268,0x1e3b0,0x1e7a0,0x1e1d4,0x1f268,0x1e3d0,0x1e7c0,0x1e1d8,0x1f26c,0x1e3f0,0x1e7e0,0x1e1dc,0x1f26c
.long 0x1e410,0x1e800,0x1e1e0,0x1f270,0x1e430,0x1e820,0x1e1e4,0x1f270,0x1e450,0x1e840,0x1e1e8,0x1f274,0x1e470,0x1e860,0x1e1ec,0x1f274
.long 0x1e490,0x1e880,0x1e1f0,0x1f278,0x1e4b0,0x1e8a0,0x1e1f4,0x1f278,0x1e4d0,0x1e8c0,0x1e1f8,0x1f27c,0x1e4f0,0x1e8e0,0x1e1fc,0x1f27c
.long 0x1,0x0,0x0,0x0,0x10000,0x0,0x0,0x0,0x0,0x1,0x0,0x0,0x0,0x10000,0x0,0x0
.long 0x0,0x0,0x1,0x0,0x0,0x0,0x10000,0x0,0x0,0x0,0x0,0x1,0x0,0x0,0x0,0x10000
.long 0x0,0x0,0x0,0x0,0x0,0x0,0x0,0x0,0x0,0x0,0x0,0x0,0x0,0x0,0x0,0x0
.long 0x0,0x0,0x0,0x0,0x0,0x0,0x0,0x0,0x0,0x0,0x0,0x0,0x0,0x0,0x0,0x0
.long 0x0,0x0,0x0,0x0,0x0,0x0,0x0,0x0,0x0,0x0,0x0,0x0,0x0,0x0,0x0,0x0
.long 0x0,0x0,0x0,0x0,0x0,0x0,0x0,0x0,0x0,0x0,0x0,0x0,0x0,0x0,0x0,0x0
.long 0x1,0x0,0x0,0x0,0x10000,0x0,0x0,0x0,0x0,0x1,0x0,0x0,0x0,0x10000,0x0,0x0
.long 0x0,0x0,0x1,0x0,0x0,0x0,0x10000,0x0,0x0,0x0,0x0,0x1,0x0,0x0,0x0,0x10000
.long 0x1,0x0,0x0,0x0,0x10000,0x0,0x0,0x0,0x0,0x1,0x0,0x0,0x0,0x10000,0x0,0x0
.long 0x0,0x0,0x1,0x0,0x0,0x0,0x10000,0x0,0x0,0x0,0x0,0x1,0x0,0x0,0x0,0x10000
.long 0x0,0x0,0x0,0x0,0x0,0x0,0x0,0x0,0x0,0x0,0x0,0x0,0x0,0x0,0x0,0x0
.long 0x0,0x0,0x0,0x0,0x0,0x0,0x0,0x0,0x0,0x0,0x0,0x0,0x0,0x0,0x0,0x0
.long 0x0,0x0,0x0,0x0,0x0,0x0,0x0,0x0,0x0,0x0,0x0,0x0,0x0,0x0,0x0,0x0
.long 0x0,0x0,0x0,0x0,0x0,0x0,0x0,0x0,0x0,0x0,0x0,0x0,0x0,0x0,0x0,0x0
.long 0x1,0x0,0x0,0x0,0x10000,0x0,0x0,0x0,0x0,0x1,0x0,0x0,0x0,0x10000,0x0,0x0
.long 0x0,0x0,0x1,0x0,0x0,0x0,0x10000,0x0,0x0,0x0,0x0,0x1,0x0,0x0,0x0,0x10000
.long 0x1e168,0x1f1f4,0x13e60,0x14000,0x1e16c,0x1f1f8,0x13f10,0x14130,0x1e170,0x1f1fc,0x14000,0x14220,0x1e174,0x1f200,0x14130,0x14350
.long 0x1e178,0x1f204,0x14220,0x14440,0x1e17c,0x1f208,0x14350,0x14570,0x1e180,0x1f20c,0x14440,0x14660,0x1e184,0x1f210,0x14570,0x14710
.long 0x1e188,0x1f214,0x14660,0x14800,0x1e18c,0x1f218,0x14710,0x14930,0x1e190,0x1f21c,0x14800,0x14a20,0x1e194,0x1f220,0x14930,0x14b50
.long 0x1e198,0x1f224,0x14a20,0x14c40,0x1e19c,0x1f228,0x14b50,0x14d70,0x1e1a0,0x1f22c,0x14c40,0x14e60,0x1e1a4,0x1f230,0x14d70,0x14f10
.long 0x1e148,0x1f1e4,0x13ee0,0x14080,0x1e14c,0x1f1e8,0x13f90,0x141b0,0x1e150,0x1f1ec,0x14080,0x142a0,0x1e154,0x1f1f0,0x141b0,0x143d0
.long 0x1e158,0x1f1f4,0x142a0,0x144c0,0x1e15c,0x1f1f8,0x143d0,0x145f0,0x1e160,0x1f1fc,0x144c0,0x146e0,0x1e164,0x1f200,0x145f0,0x14790
.long 0x1e168,0x1f204,0x146e0,0x14880,0x1e16c,0x1f208,0x14790,0x149b0,0x1e170,0x1f20c,0x14880,0x14aa0,0x1e174,0x1f210,0x149b0,0x14bd0
.long 0x1e178,0x1f214,0x14aa0,0x14cc0,0x1e17c,0x1f218,0x14bd0,0x14df0,0x1e180,0x1f21c,0x14cc0,0x14ee0,0x1e184,0x1f220,0x14df0,0x14f90
.long 0x1e128,0x1f1d4,0x13f10,0x14130,0x1e12c,0x1f1d8,0x14000,0x14220,0x1e130,0x1f1dc,0x14130,0x14350,0x1e134,0x1f1e0,0x14220,0x14440
.long 0x1e138,0x1f1e4,0x14350,0x14570,0x1e13c,0x1f1e8,0x14440,0x14660,0x1e140,0x1f1ec,0x14570,0x14710,0x1e144,0x1f1f0,0x14660,0x14800
.long 0x1e148,0x1f1f4,0x14710,0x14930,0x1e14c,0x1f1f8,0x14800,0x14a20,0x1e150,0x1f1fc,0x14930,0x14b50,0x1e154,0x1f200,0x14a20,0x14c40
.long 0x1e158,0x1f204,0x14b50,0x14d70,0x1e15c,0x1f208,0x14c40,0x14e60,0x1e160,0x1f20c,0x14d70,0x14f10,0x1e164,0x1f210,0x14e60,0x15000
.long 0x1e108,0x1f1c4,0x13f90,0x141b0,0x1e10c,0x1f1c8,0x14080,0x142a0,0x1e110,0x1f1cc,0x141b0,0x143d0,0x1e114,0x1f1d0,0x142a0,0x144c0
.long 0x1e118,0x1f1d4,0x143d0,0x145f0,0x1e11c,0x1f1d8,0x144c0,0x146e0,0x1e120,0x1f1dc,0x145f0,0x14790,0x1e124,0x1f1e0,0x146e0,0x14880
.long 0x1e128,0x1f1e4,0x14790,0x149b0,0x1e12c,0x1f1e8,0x14880,0x14aa0,0x1e130,0x1f1ec,0x149b0,0x14bd0,0x1e134,0x1f1f0,0x14aa0,0x14cc0
.long 0x1e138,0x1f1f4,0x14bd0,0x14df0,0x1e13c,0x1f1f8,0x14cc0,0x14ee0,0x1e140,0x1f1fc,0x14df0,0x14f90,0x1e144,0x1f200,0x14ee0,0x15080
.long 0x14220,0x14440,0x14df0,0x14f50,0x14350,0x14570,0x14ee0,0x15040,0x14440,0x14660,0x14f90,0x15170,0x14570,0x14710,0x15080,0x15260
.long 0x14660,0x14800,0x151b0,0x15310,0x14710,0x14930,0x152a0,0x15400,0x14800,0x14a20,0x153d0,0x15530,0x14930,0x14b50,0x154c0,0x15620
.long 0x14a20,0x14c40,0x155f0,0x15750,0x14b50,0x14d70,0x156e0,0x15840,0x14c40,0x14e60,0x15790,0x15970,0x14d70,0x14f10,0x15880,0x15a60
.long 0x14e60,0x15000,0x159b0,0x15b10,0x14f10,0x15130,0x15aa0,0x15c00,0x15000,0x15220,0x15bd0,0x15d30,0x15130,0x15350,0x15cc0,0x15e20
.long 0x142a0,0x144c0,0x14e60,0x14fd0,0x143d0,0x145f0,0x14f10,0x150c0,0x144c0,0x146e0,0x15000,0x151f0,0x145f0,0x14790,0x15130,0x152e0
.long 0x146e0,0x14880,0x15220,0x15390,0x14790,0x149b0,0x15350,0x15480,0x14880,0x14aa0,0x15440,0x155b0,0x149b0,0x14bd0,0x15570,0x156a0
.long 0x14aa0,0x14cc0,0x15660,0x157d0,0x14bd0,0x14df0,0x15710,0x158c0,0x14cc0,0x14ee0,0x15800,0x159f0,0x14df0,0x14f90,0x15930,0x15ae0
.long 0x14ee0,0x15080,0x15a20,0x15b90,0x14f90,0x151b0,0x15b50,0x15c80,0x15080,0x152a0,0x15c40,0x15db0,0x151b0,0x153d0,0x15d70,0x15ea0
.long 0x14350,0x14570,0x14ee0,0x14f10,0x14440,0x14660,0x14f90,0x15000,0x14570,0x14710,0x15080,0x15130,0x14660,0x14800,0x151b0,0x15220
.long 0x14710,0x14930,0x152a0,0x15350,0x14800,0x14a20,0x153d0,0x15440,0x14930,0x14b50,0x154c0,0x15570,0x14a20,0x14c40,0x155f0,0x15660
.long 0x14b50,0x14d70,0x156e0,0x15710,0x14c40,0x14e60,0x15790,0x15800,0x14d70,0x14f10,0x15880,0x15930,0x14e60,0x15000,0x159b0,0x15a20
.long 0x14f10,0x15130,0x15aa0,0x15b50,0x15000,0x15220,0x15bd0,0x15c40,0x15130,0x15350,0x15cc0,0x15d70,0x15220,0x15440,0x15df0,0x15e60
.long 0x143d0,0x145f0,0x14f10,0x14f90,0x144c0,0x146e0,0x15000,0x15080,0x145f0,0x14790,0x15130,0x151b0,0x146e0,0x14880,0x15220,0x152a0
.long 0x14790,0x149b0,0x15350,0x153d0,0x14880,0x14aa0,0x15440,0x154c0,0x149b0,0x14bd0,0x15570,0x155f0,0x14aa0,0x14cc0,0x15660,0x156e0
.long 0x14bd0,0x14df0,0x15710,0x15790,0x14cc0,0x14ee0,0x15800,0x15880,0x14df0,0x14f90,0x15930,0x159b0,0x14ee0,0x15080,0x15a20,0x15aa0
.long 0x14f90,0x151b0,0x15b50,0x15bd0,0x15080,0x152a0,0x15c40,0x15cc0,0x151b0,0x153d0,0x15d70,0x15df0,0x152a0,0x154c0,0x15e60,0x15ee0
.long 0x80,0x80,0x80,0x80,0x90,0x90,0x90,0x90,0xa0,0xa0,0xa0,0xa0,0xb0,0xb0,0xb0,0xb0
.long 0x14100,0x14100,0x14100,0x14100,0x14110,0x14110,0x14110,0x14110,0x14120,0x14120,0x14120,0x14120,0x14130,0x14130,0x14130,0x14130
.long 0x28180,0x28180,0x28180,0x28180,0x28190,0x28190,0x28190,0x28190,0x281a0,0x281a0,0x281a0,0x281a0,0x281b0,0x281b0,0x281b0,0x281b0
.long 0x3c200,0x3c200,0x3c200,0x3c200,0x3c210,0x3c210,0x3c210,0x3c210,0x3c220,0x3c220,0x3c220,0x3c220,0x3c230,0x3c230,0x3c230,0x3c230
.long 0x50280,0x50280,0x50280,0x50280,0x50290,0x50290,0x50290,0x50290,0x502a0,0x502a0,0x502a0,0x502a0,0x502b0,0x502b0,0x502b0,0x502b0
.long 0x64300,0x64300,0x64300,0x64300,0x64310,0x64310,0x64310,0x64310,0x64320,0x64320,0x64320,0x64320,0x64330,0x64330,0x64330,0x64330
.long 0x78380,0x78380,0x78380,0x78380,0x78390,0x78390,0x78390,0x78390,0x783a0,0x783a0,0x783a0,0x783a0,0x783b0,0x783b0,0x783b0,0x783b0
.long 0x8c400,0x8c400,0x8c400,0x8c400,0x8c410,0x8c410,0x8c410,0x8c410,0x8c420,0x8c420,0x8c420,0x8c420,0x8c430,0x8c430,0x8c430,0x8c430
.long 0xc0,0xc0,0xc0,0xc0,0xd0,0xd0,0xd0,0xd0,0xe0,0xe0,0xe0,0xe0,0xf0,0xf0,0xf0,0xf0
.long 0x14140,0x14140,0x14140,0x14140,0x14150,0x14150,0x14150,0x14150,0x14160,0x14160,0x14160,0x14160,0x14170,0x14170,0x14170,0x14170
.long 0x281c0,0x281c0,0x281c0,0x281c0,0x281d0,0x281d0,0x281d0,0x281d0,0x281e0,0x281e0,0x281e0,0x281e0,0x281f0,0x281f0,0x281f0,0x281f0
.long 0x3c240,0x3c240,0x3c240,0x3c240,0x3c250,0x3c250,0x3c250,0x3c250,0x3c260,0x3c260,0x3c260,0x3c260,0x3c270,0x3c270,0x3c270,0x3c270
.long 0x502c0,0x502c0,0x502c0,0x502c0,0x502d0,0x502d0,0x502d0,0x502d0,0x502e0,0x502e0,0x502e0,0x502e0,0x502f0,0x502f0,0x502f0,0x502f0
.long 0x64340,0x64340,0x64340,0x64340,0x64350,0x64350,0x64350,0x64350,0x64360,0x64360,0x64360,0x64360,0x64370,0x64370,0x64370,0x64370
.long 0x783c0,0x783c0,0x783c0,0x783c0,0x783d0,0x783d0,0x783d0,0x783d0,0x783e0,0x783e0,0x783e0,0x783e0,0x783f0,0x783f0,0x783f0,0x783f0
.long 0x8c440,0x8c440,0x8c440,0x8c440,0x8c450,0x8c450,0x8c450,0x8c450,0x8c460,0x8c460,0x8c460,0x8c460,0x8c470,0x8c470,0x8c470,0x8c470
.long 0x0,0x0,0x3f800000,0x3f803f80,0x0,0x0,0x0,0x3f803f80,0x0,0x0,0x0,0x3f800000,0x0,0x0,0x0,0x0
.long 0x0,0x0,0x0,0x0,0x0,0x0,0x0,0x0,0x0,0x0,0x0,0x0,0x0,0x0,0x0,0x0
.long 0x0,0x0,0x0,0x0,0x0,0x0,0x0,0x0,0x0,0x0,0x0,0x0,0x0,0x0,0x0,0x0
.long 0x0,0x0,0x0,0x0,0x0,0x0,0x0,0x0,0x0,0x0,0x0,0x0,0x0,0x0,0x0,0x0
.long 0x3f803f80,0x3f803f80,0x0,0x0,0x3f803f80,0x3f803f80,0x3f80,0x0,0x3f803f80,0x3f803f80,0x3f803f80,0x0,0x3f803f80,0x3f803f80,0x3f803f80,0x3f80
.long 0x3f800000,0x3f803f80,0x3f803f80,0x3f803f80,0x0,0x3f803f80,0x3f803f80,0x3f803f80,0x0,0x3f800000,0x3f803f80,0x3f803f80,0x0,0x0,0x3f803f80,0x3f803f80
.long 0x0,0x0,0x3f800000,0x3f803f80,0x0,0x0,0x0,0x3f803f80,0x0,0x0,0x0,0x3f800000,0x0,0x0,0x0,0x0
.long 0x0,0x0,0x0,0x0,0x0,0x0,0x0,0x0,0x0,0x0,0x0,0x0,0x0,0x0,0x0,0x0
.long 0x0,0x0,0x0,0x0,0x0,0x0,0x0,0x0,0x0,0x0,0x0,0x0,0x0,0x0,0x0,0x0
.long 0x0,0x0,0x0,0x0,0x3f80,0x0,0x0,0x0,0x3f803f80,0x0,0x0,0x0,0x3f803f80,0x3f80,0x0,0x0
.long 0x3f803f80,0x3f803f80,0x0,0x0,0x3f803f80,0x3f803f80,0x3f80,0x0,0x3f803f80,0x3f803f80,0x3f803f80,0x0,0x3f803f80,0x3f803f80,0x3f803f80,0x3f80
.long 0x3f800000,0x3f803f80,0x3f803f80,0x3f803f80,0x0,0x3f803f80,0x3f803f80,0x3f803f80,0x0,0x3f800000,0x3f803f80,0x3f803f80,0x0,0x0,0x3f803f80,0x3f803f80
.long 0x0,0x0,0x0,0x0,0x0,0x0,0x0,0x0,0x0,0x0,0x0,0x0,0x0,0x0,0x0,0x0
.long 0x0,0x0,0x0,0x0,0x0,0x0,0x0,0x0,0x0,0x0,0x0,0x0,0x0,0x0,0x0,0x0
.long 0x0,0x0,0x0,0x0,0x0,0x0,0x0,0x0,0x0,0x0,0x0,0x0,0x0,0x0,0x0,0x0
.long 0x0,0x0,0x0,0x0,0x3f80,0x0,0x0,0x0,0x3f803f80,0x0,0x0,0x0,0x3f803f80,0x3f80,0x0,0x0
.long 0x0,0x0,0x3f803f80,0x3f803f80,0x0,0x0,0x3f800000,0x3f803f80,0x0,0x0,0x0,0x3f803f80,0x0,0x0,0x0,0x3f800000
.long 0x0,0x0,0x0,0x0,0x0,0x0,0x0,0x0,0x0,0x0,0x0,0x0,0x0,0x0,0x0,0x0
.long 0x0,0x0,0x0,0x0,0x0,0x0,0x0,0x0,0x0,0x0,0x0,0x0,0x0,0x0,0x0,0x0
.long 0x0,0x0,0x0,0x0,0x0,0x0,0x0,0x0,0x0,0x0,0x0,0x0,0x0,0x0,0x0,0x0
.long 0x3f803f80,0x3f803f80,0x3f80,0x0,0x3f803f80,0x3f803f80,0x3f803f80,0x0,0x3f803f80,0x3f803f80,0x3f803f80,0x3f80,0x3f803f80,0x3f803f80,0x3f803f80,0x3f803f80
.long 0x3f803f80,0x3f803f80,0x3f803f80,0x3f803f80,0x3f800000,0x3f803f80,0x3f803f80,0x3f803f80,0x0,0x3f803f80,0x3f803f80,0x3f803f80,0x0,0x3f800000,0x3f803f80,0x3f803f80
.long 0x0,0x0,0x3f803f80,0x3f803f80,0x0,0x0,0x3f800000,0x3f803f80,0x0,0x0,0x0,0x3f803f80,0x0,0x0,0x0,0x3f800000
.long 0x0,0x0,0x0,0x0,0x0,0x0,0x0,0x0,0x0,0x0,0x0,0x0,0x0,0x0,0x0,0x0
.long 0x0,0x0,0x0,0x0,0x0,0x0,0x0,0x0,0x0,0x0,0x0,0x0,0x0,0x0,0x0,0x0
.long 0x3f80,0x0,0x0,0x0,0x3f803f80,0x0,0x0,0x0,0x3f803f80,0x3f80,0x0,0x0,0x3f803f80,0x3f803f80,0x0,0x0
.long 0x3f803f80,0x3f803f80,0x3f80,0x0,0x3f803f80,0x3f803f80,0x3f803f80,0x0,0x3f803f80,0x3f803f80,0x3f803f80,0x3f80,0x3f803f80,0x3f803f80,0x3f803f80,0x3f803f80
.long 0x3f803f80,0x3f803f80,0x3f803f80,0x3f803f80,0x3f800000,0x3f803f80,0x3f803f80,0x3f803f80,0x0,0x3f803f80,0x3f803f80,0x3f803f80,0x0,0x3f800000,0x3f803f80,0x3f803f80
.long 0x0,0x0,0x0,0x0,0x0,0x0,0x0,0x0,0x0,0x0,0x0,0x0,0x0,0x0,0x0,0x0
.long 0x0,0x0,0x0,0x0,0x0,0x0,0x0,0x0,0x0,0x0,0x0,0x0,0x0,0x0,0x0,0x0
.long 0x0,0x0,0x0,0x0,0x0,0x0,0x0,0x0,0x0,0x0,0x0,0x0,0x0,0x0,0x0,0x0
.long 0x3f80,0x0,0x0,0x0,0x3f803f80,0x0,0x0,0x0,0x3f803f80,0x3f80,0x0,0x0,0x3f803f80,0x3f803f80,0x0,0x0
.long 0x0,0x10,0x20,0x30,0x8,0x18,0x28,0x38,0x40,0x50,0x60,0x70,0x48,0x58,0x68,0x78
.long 0x80,0x90,0xa0,0xb0,0x88,0x98,0xa8,0xb8,0xc0,0xd0,0xe0,0xf0,0xc8,0xd8,0xe8,0xf8
.long 0x110,0x100,0x130,0x120,0x118,0x108,0x138,0x128,0x150,0x140,0x170,0x160,0x158,0x148,0x178,0x168
.long 0x190,0x180,0x1b0,0x1a0,0x198,0x188,0x1b8,0x1a8,0x1d0,0x1c0,0x1f0,0x1e0,0x1d8,0x1c8,0x1f8,0x1e8
.long 0x220,0x230,0x200,0x210,0x228,0x238,0x208,0x218,0x260,0x270,0x240,0x250,0x268,0x278,0x248,0x258
.long 0x2a0,0x2b0,0x280,0x290,0x2a8,0x2b8,0x288,0x298,0x2e0,0x2f0,0x2c0,0x2d0,0x2e8,0x2f8,0x2c8,0x2d8
.long 0x330,0x320,0x310,0x300,0x338,0x328,0x318,0x308,0x370,0x360,0x350,0x340,0x378,0x368,0x358,0x348
.long 0x3b0,0x3a0,0x390,0x380,0x3b8,0x3a8,0x398,0x388,0x3f0,0x3e0,0x3d0,0x3c0,0x3f8,0x3e8,0x3d8,0x3c8
.long 0x400,0x410,0x420,0x430,0x408,0x418,0x428,0x438,0x440,0x450,0x460,0x470,0x448,0x458,0x468,0x478
.long 0x480,0x490,0x4a0,0x4b0,0x488,0x498,0x4a8,0x4b8,0x4c0,0x4d0,0x4e0,0x4f0,0x4c8,0x4d8,0x4e8,0x4f8
.long 0x510,0x500,0x530,0x520,0x518,0x508,0x538,0x528,0x550,0x540,0x570,0x560,0x558,0x548,0x578,0x568
.long 0x590,0x580,0x5b0,0x5a0,0x598,0x588,0x5b8,0x5a8,0x5d0,0x5c0,0x5f0,0x5e0,0x5d8,0x5c8,0x5f8,0x5e8
.long 0x620,0x630,0x600,0x610,0x628,0x638,0x608,0x618,0x660,0x670,0x640,0x650,0x668,0x678,0x648,0x658
.long 0x6a0,0x6b0,0x680,0x690,0x6a8,0x6b8,0x688,0x698,0x6e0,0x6f0,0x6c0,0x6d0,0x6e8,0x6f8,0x6c8,0x6d8
.long 0x730,0x720,0x710,0x700,0x738,0x728,0x718,0x708,0x770,0x760,0x750,0x740,0x778,0x768,0x758,0x748
.long 0x7b0,0x7a0,0x790,0x780,0x7b8,0x7a8,0x798,0x788,0x7f0,0x7e0,0x7d0,0x7c0,0x7f8,0x7e8,0x7d8,0x7c8
.long 0x800,0x10,0x2010,0x300,0x808,0x18,0x2018,0xc300,0x840,0x50,0x2050,0x18300,0x848,0x58,0x2058,0x24300
.long 0x880,0x90,0x2090,0x30300,0x888,0x98,0x2098,0x3c300,0x8c0,0xd0,0x20d0,0x7ffffff0,0x8c8,0xd8,0x20d8,0x7ffffff0
.long 0x910,0x100,0x2100,0x300,0x918,0x108,0x2108,0xc300,0x950,0x140,0x2140,0x18300,0x958,0x148,0x2148,0x24300
.long 0x990,0x180,0x2180,0x30300,0x998,0x188,0x2188,0x3c300,0x9d0,0x1c0,0x21c0,0x7ffffff0,0x9d8,0x1c8,0x21c8,0x7ffffff0
.long 0xa20,0x230,0x2230,0x340,0xa28,0x238,0x2238,0xc340,0xa60,0x270,0x2270,0x18340,0xa68,0x278,0x2278,0x24340
.long 0xaa0,0x2b0,0x22b0,0x30340,0xaa8,0x2b8,0x22b8,0x3c340,0xae0,0x2f0,0x22f0,0x7ffffff0,0xae8,0x2f8,0x22f8,0x7ffffff0
.long 0xb30,0x320,0x2320,0x340,0xb38,0x328,0x2328,0xc340,0xb70,0x360,0x2360,0x18340,0xb78,0x368,0x2368,0x24340
.long 0xbb0,0x3a0,0x23a0,0x30340,0xbb8,0x3a8,0x23a8,0x3c340,0xbf0,0x3e0,0x23e0,0x7ffffff0,0xbf8,0x3e8,0x23e8,0x7ffffff0
.long 0xc00,0x410,0x2410,0x380,0xc08,0x418,0x2418,0xc380,0xc40,0x450,0x2450,0x18380,0xc48,0x458,0x2458,0x24380
.long 0xc80,0x490,0x2490,0x30380,0xc88,0x498,0x2498,0x3c380,0xcc0,0x4d0,0x24d0,0x7ffffff0,0xcc8,0x4d8,0x24d8,0x7ffffff0
.long 0xd10,0x500,0x2500,0x380,0xd18,0x508,0x2508,0xc380,0xd50,0x540,0x2540,0x18380,0xd58,0x548,0x2548,0x24380
.long 0xd90,0x580,0x2580,0x30380,0xd98,0x588,0x2588,0x3c380,0xdd0,0x5c0,0x25c0,0x7ffffff0,0xdd8,0x5c8,0x25c8,0x7ffffff0
.long 0xe20,0x630,0x2630,0x3c0,0xe28,0x638,0x2638,0xc3c0,0xe60,0x670,0x2670,0x183c0,0xe68,0x678,0x2678,0x243c0
.long 0xea0,0x6b0,0x26b0,0x303c0,0xea8,0x6b8,0x26b8,0x3c3c0,0xee0,0x6f0,0x26f0,0x7ffffff0,0xee8,0x6f8,0x26f8,0x7ffffff0
.long 0xf30,0x720,0x2720,0x3c0,0xf38,0x728,0x2728,0xc3c0,0xf70,0x760,0x2760,0x183c0,0xf78,0x768,0x2768,0x243c0
.long 0xfb0,0x7a0,0x27a0,0x303c0,0xfb8,0x7a8,0x27a8,0x3c3c0,0xff0,0x7e0,0x27e0,0x7ffffff0,0xff8,0x7e8,0x27e8,0x7ffffff0
.long 0x20,0x5000,0x5080,0x0,0x520,0x5500,0x5580,0x10,0xa20,0x5a00,0x5a80,0x20,0xf20,0x5f00,0x5f80,0x30
.long 0x1420,0x6400,0x6480,0x40,0x1920,0x6900,0x6980,0x50,0x1e20,0x6e00,0x6e80,0x60,0x2320,0x7300,0x7380,0x70
.long 0x2820,0x7800,0x7880,0x80,0x2d20,0x7d00,0x7d80,0x90,0x3220,0x8200,0x8280,0xa0,0x3720,0x8700,0x8780,0xb0
.long 0x3c20,0x8c00,0x8c80,0xc0,0x4120,0x9100,0x9180,0xd0,0x4620,0x9600,0x9680,0xe0,0x4b20,0x9b00,0x9b80,0xf0
.long 0x28,0x5008,0x5088,0x400,0x528,0x5508,0x5588,0x410,0xa28,0x5a08,0x5a88,0x420,0xf28,0x5f08,0x5f88,0x430
.long 0x1428,0x6408,0x6488,0x440,0x1928,0x6908,0x6988,0x450,0x1e28,0x6e08,0x6e88,0x460,0x2328,0x7308,0x7388,0x470
.long 0x2828,0x7808,0x7888,0x480,0x2d28,0x7d08,0x7d88,0x490,0x3228,0x8208,0x8288,0x4a0,0x3728,0x8708,0x8788,0x4b0
.long 0x3c28,0x8c08,0x8c88,0x4c0,0x4128,0x9108,0x9188,0x4d0,0x4628,0x9608,0x9688,0x4e0,0x4b28,0x9b08,0x9b88,0x4f0
.long 0x30,0x5010,0x5090,0x800,0x530,0x5510,0x5590,0x810,0xa30,0x5a10,0x5a90,0x820,0xf30,0x5f10,0x5f90,0x830
.long 0x1430,0x6410,0x6490,0x840,0x1930,0x6910,0x6990,0x850,0x1e30,0x6e10,0x6e90,0x860,0x2330,0x7310,0x7390,0x870
.long 0x2830,0x7810,0x7890,0x880,0x2d30,0x7d10,0x7d90,0x890,0x3230,0x8210,0x8290,0x8a0,0x3730,0x8710,0x8790,0x8b0
.long 0x3c30,0x8c10,0x8c90,0x8c0,0x4130,0x9110,0x9190,0x8d0,0x4630,0x9610,0x9690,0x8e0,0x4b30,0x9b10,0x9b90,0x8f0
.long 0x38,0x5018,0x5098,0xc00,0x538,0x5518,0x5598,0xc10,0xa38,0x5a18,0x5a98,0xc20,0xf38,0x5f18,0x5f98,0xc30
.long 0x1438,0x6418,0x6498,0xc40,0x1938,0x6918,0x6998,0xc50,0x1e38,0x6e18,0x6e98,0xc60,0x2338,0x7318,0x7398,0xc70
.long 0x2838,0x7818,0x7898,0xc80,0x2d38,0x7d18,0x7d98,0xc90,0x3238,0x8218,0x8298,0xca0,0x3738,0x8718,0x8798,0xcb0
.long 0x3c38,0x8c18,0x8c98,0xcc0,0x4138,0x9118,0x9198,0xcd0,0x4638,0x9618,0x9698,0xce0,0x4b38,0x9b18,0x9b98,0xcf0
.long 0x600,0x6000,0x400,0x1000,0x610,0x6010,0x410,0x1010,0x620,0x6020,0x420,0x1020,0x630,0x6030,0x430,0x1030
.long 0x640,0x6040,0x440,0x1040,0x650,0x6050,0x450,0x1050,0x660,0x6060,0x460,0x1060,0x670,0x6070,0x470,0x1070
.long 0x680,0x6080,0x480,0x1080,0x690,0x6090,0x490,0x1090,0x6a0,0x60a0,0x4a0,0x10a0,0x6b0,0x60b0,0x4b0,0x10b0
.long 0x6c0,0x60c0,0x4c0,0x10c0,0x6d0,0x60d0,0x4d0,0x10d0,0x6e0,0x60e0,0x4e0,0x10e0,0x6f0,0x60f0,0x4f0,0x10f0
.long 0x700,0x6200,0x500,0x1100,0x710,0x6210,0x510,0x1110,0x720,0x6220,0x520,0x1120,0x730,0x6230,0x530,0x1130
.long 0x740,0x6240,0x540,0x1140,0x750,0x6250,0x550,0x1150,0x760,0x6260,0x560,0x1160,0x770,0x6270,0x570,0x1170
.long 0x780,0x6280,0x580,0x1180,0x790,0x6290,0x590,0x1190,0x7a0,0x62a0,0x5a0,0x11a0,0x7b0,0x62b0,0x5b0,0x11b0
.long 0x7c0,0x62c0,0x5c0,0x11c0,0x7d0,0x62d0,0x5d0,0x11d0,0x7e0,0x62e0,0x5e0,0x11e0,0x7f0,0x62f0,0x5f0,0x11f0
.long 0x18600,0x6400,0x600,0x1200,0x18610,0x6410,0x610,0x1210,0x18620,0x6420,0x620,0x1220,0x18630,0x6430,0x630,0x1230
.long 0x18640,0x6440,0x640,0x1240,0x18650,0x6450,0x650,0x1250,0x18660,0x6460,0x660,0x1260,0x18670,0x6470,0x670,0x1270
.long 0x18680,0x6480,0x680,0x1280,0x18690,0x6490,0x690,0x1290,0x186a0,0x64a0,0x6a0,0x12a0,0x186b0,0x64b0,0x6b0,0x12b0
.long 0x186c0,0x64c0,0x6c0,0x12c0,0x186d0,0x64d0,0x6d0,0x12d0,0x186e0,0x64e0,0x6e0,0x12e0,0x186f0,0x64f0,0x6f0,0x12f0
.long 0x18700,0x6600,0x700,0x1300,0x18710,0x6610,0x710,0x1310,0x18720,0x6620,0x720,0x1320,0x18730,0x6630,0x730,0x1330
.long 0x18740,0x6640,0x740,0x1340,0x18750,0x6650,0x750,0x1350,0x18760,0x6660,0x760,0x1360,0x18770,0x6670,0x770,0x1370
.long 0x18780,0x6680,0x780,0x1380,0x18790,0x6690,0x790,0x1390,0x187a0,0x66a0,0x7a0,0x13a0,0x187b0,0x66b0,0x7b0,0x13b0
.long 0x187c0,0x66c0,0x7c0,0x13c0,0x187d0,0x66d0,0x7d0,0x13d0,0x187e0,0x66e0,0x7e0,0x13e0,0x187f0,0x66f0,0x7f0,0x13f0
.long 0x1f300,0x1f300,0x1f300,0x20400,0x1f320,0x1f320,0x1f304,0x20400,0x1f340,0x1f340,0x1f308,0x20404,0x1f360,0x1f360,0x1f30c,0x20404
.long 0x1f380,0x1f380,0x1f310,0x20408,0x1f3a0,0x1f3a0,0x1f314,0x20408,0x1f3c0,0x1f3c0,0x1f318,0x2040c,0x1f3e0,0x1f3e0,0x1f31c,0x2040c
.long 0x1f400,0x1f400,0x1f320,0x20410,0x1f420,0x1f420,0x1f324,0x20410,0x1f440,0x1f440,0x1f328,0x20414,0x1f460,0x1f460,0x1f32c,0x20414
.long 0x1f480,0x1f480,0x1f330,0x20418,0x1f4a0,0x1f4a0,0x1f334,0x20418,0x1f4c0,0x1f4c0,0x1f338,0x2041c,0x1f4e0,0x1f4e0,0x1f33c,0x2041c
.long 0x1f500,0x1f500,0x1f340,0x20420,0x1f520,0x1f520,0x1f344,0x20420,0x1f540,0x1f540,0x1f348,0x20424,0x1f560,0x1f560,0x1f34c,0x20424
.long 0x1f580,0x1f580,0x1f350,0x20428,0x1f5a0,0x1f5a0,0x1f354,0x20428,0x1f5c0,0x1f5c0,0x1f358,0x2042c,0x1f5e0,0x1f5e0,0x1f35c,0x2042c
.long 0x1f600,0x1f600,0x1f360,0x20430,0x1f620,0x1f620,0x1f364,0x20430,0x1f640,0x1f640,0x1f368,0x20434,0x1f660,0x1f660,0x1f36c,0x20434
.long 0x1f680,0x1f680,0x1f370,0x20438,0x1f6a0,0x1f6a0,0x1f374,0x20438,0x1f6c0,0x1f6c0,0x1f378,0x2043c,0x1f6e0,0x1f6e0,0x1f37c,0x2043c
.long 0x1f310,0x1f700,0x1f380,0x20440,0x1f330,0x1f720,0x1f384,0x20440,0x1f350,0x1f740,0x1f388,0x20444,0x1f370,0x1f760,0x1f38c,0x20444
.long 0x1f390,0x1f780,0x1f390,0x20448,0x1f3b0,0x1f7a0,0x1f394,0x20448,0x1f3d0,0x1f7c0,0x1f398,0x2044c,0x1f3f0,0x1f7e0,0x1f39c,0x2044c
.long 0x1f410,0x1f800,0x1f3a0,0x20450,0x1f430,0x1f820,0x1f3a4,0x20450,0x1f450,0x1f840,0x1f3a8,0x20454,0x1f470,0x1f860,0x1f3ac,0x20454
.long 0x1f490,0x1f880,0x1f3b0,0x20458,0x1f4b0,0x1f8a0,0x1f3b4,0x20458,0x1f4d0,0x1f8c0,0x1f3b8,0x2045c,0x1f4f0,0x1f8e0,0x1f3bc,0x2045c
.long 0x1f510,0x1f900,0x1f3c0,0x20460,0x1f530,0x1f920,0x1f3c4,0x20460,0x1f550,0x1f940,0x1f3c8,0x20464,0x1f570,0x1f960,0x1f3cc,0x20464
.long 0x1f590,0x1f980,0x1f3d0,0x20468,0x1f5b0,0x1f9a0,0x1f3d4,0x20468,0x1f5d0,0x1f9c0,0x1f3d8,0x2046c,0x1f5f0,0x1f9e0,0x1f3dc,0x2046c
.long 0x1f610,0x1fa00,0x1f3e0,0x20470,0x1f630,0x1fa20,0x1f3e4,0x20470,0x1f650,0x1fa40,0x1f3e8,0x20474,0x1f670,0x1fa60,0x1f3ec,0x20474
.long 0x1f690,0x1fa80,0x1f3f0,0x20478,0x1f6b0,0x1faa0,0x1f3f4,0x20478,0x1f6d0,0x1fac0,0x1f3f8,0x2047c,0x1f6f0,0x1fae0,0x1f3fc,0x2047c
.long 0x1,0x0,0x0,0x0,0x10000,0x0,0x0,0x0,0x0,0x1,0x0,0x0,0x0,0x10000,0x0,0x0
.long 0x0,0x0,0x1,0x0,0x0,0x0,0x10000,0x0,0x0,0x0,0x0,0x1,0x0,0x0,0x0,0x10000
.long 0x0,0x0,0x0,0x0,0x0,0x0,0x0,0x0,0x0,0x0,0x0,0x0,0x0,0x0,0x0,0x0
.long 0x0,0x0,0x0,0x0,0x0,0x0,0x0,0x0,0x0,0x0,0x0,0x0,0x0,0x0,0x0,0x0
.long 0x0,0x0,0x0,0x0,0x0,0x0,0x0,0x0,0x0,0x0,0x0,0x0,0x0,0x0,0x0,0x0
.long 0x0,0x0,0x0,0x0,0x0,0x0,0x0,0x0,0x0,0x0,0x0,0x0,0x0,0x0,0x0,0x0
.long 0x1,0x0,0x0,0x0,0x10000,0x0,0x0,0x0,0x0,0x1,0x0,0x0,0x0,0x10000,0x0,0x0
.long 0x0,0x0,0x1,0x0,0x0,0x0,0x10000,0x0,0x0,0x0,0x0,0x1,0x0,0x0,0x0,0x10000
.long 0x1,0x0,0x0,0x0,0x10000,0x0,0x0,0x0,0x0,0x1,0x0,0x0,0x0,0x10000,0x0,0x0
.long 0x0,0x0,0x1,0x0,0x0,0x0,0x10000,0x0,0x0,0x0,0x0,0x1,0x0,0x0,0x0,0x10000
.long 0x0,0x0,0x0,0x0,0x0,0x0,0x0,0x0,0x0,0x0,0x0,0x0,0x0,0x0,0x0,0x0
.long 0x0,0x0,0x0,0x0,0x0,0x0,0x0,0x0,0x0,0x0,0x0,0x0,0x0,0x0,0x0,0x0
.long 0x0,0x0,0x0,0x0,0x0,0x0,0x0,0x0,0x0,0x0,0x0,0x0,0x0,0x0,0x0,0x0
.long 0x0,0x0,0x0,0x0,0x0,0x0,0x0,0x0,0x0,0x0,0x0,0x0,0x0,0x0,0x0,0x0
.long 0x1,0x0,0x0,0x0,0x10000,0x0,0x0,0x0,0x0,0x1,0x0,0x0,0x0,0x10000,0x0,0x0
.long 0x0,0x0,0x1,0x0,0x0,0x0,0x10000,0x0,0x0,0x0,0x0,0x1,0x0,0x0,0x0,0x10000
.long 0x1f368,0x203f4,0x13e50,0x14030,0x1f36c,0x203f8,0x13f20,0x14100,0x1f370,0x203fc,0x14030,0x14210,0x1f374,0x20400,0x14100,0x14360
.long 0x1f378,0x20404,0x14210,0x14470,0x1f37c,0x20408,0x14360,0x14540,0x1f380,0x2040c,0x14470,0x14650,0x1f384,0x20410,0x14540,0x14720
.long 0x1f388,0x20414,0x14650,0x14830,0x1f38c,0x20418,0x14720,0x14900,0x1f390,0x2041c,0x14830,0x14a10,0x1f394,0x20420,0x14900,0x14b60
.long 0x1f398,0x20424,0x14a10,0x14c70,0x1f39c,0x20428,0x14b60,0x14d40,0x1f3a0,0x2042c,0x14c70,0x14e50,0x1f3a4,0x20430,0x14d40,0x14f20
.long 0x1f348,0x203e4,0x13ed0,0x140b0,0x1f34c,0x203e8,0x13fa0,0x14180,0x1f350,0x203ec,0x140b0,0x14290,0x1f354,0x203f0,0x14180,0x143e0
.long 0x1f358,0x203f4,0x14290,0x144f0,0x1f35c,0x203f8,0x143e0,0x145c0,0x1f360,0x203fc,0x144f0,0x146d0,0x1f364,0x20400,0x145c0,0x147a0
.long 0x1f368,0x20404,0x146d0,0x148b0,0x1f36c,0x20408,0x147a0,0x14980,0x1f370,0x2040c,0x148b0,0x14a90,0x1f374,0x20410,0x14980,0x14be0
.long 0x1f378,0x20414,0x14a90,0x14cf0,0x1f37c,0x20418,0x14be0,0x14dc0,0x1f380,0x2041c,0x14cf0,0x14ed0,0x1f384,0x20420,0x14dc0,0x14fa0
.long 0x1f328,0x203d4,0x13f20,0x14100,0x1f32c,0x203d8,0x14030,0x14210,0x1f330,0x203dc,0x14100,0x14360,0x1f334,0x203e0,0x14210,0x14470
.long 0x1f338,0x203e4,0x14360,0x14540,0x1f33c,0x203e8,0x14470,0x14650,0x1f340,0x203ec,0x14540,0x14720,0x1f344,0x203f0,0x14650,0x14830
.long 0x1f348,0x203f4,0x14720,0x14900,0x1f34c,0x203f8,0x14830,0x14a10,0x1f350,0x203fc,0x14900,0x14b60,0x1f354,0x20400,0x14a10,0x14c70
.long 0x1f358,0x20404,0x14b60,0x14d40,0x1f35c,0x20408,0x14c70,0x14e50,0x1f360,0x2040c,0x14d40,0x14f20,0x1f364,0x20410,0x14e50,0x15030
.long 0x1f308,0x203c4,0x13fa0,0x14180,0x1f30c,0x203c8,0x140b0,0x14290,0x1f310,0x203cc,0x14180,0x143e0,0x1f314,0x203d0,0x14290,0x144f0
.long 0x1f318,0x203d4,0x143e0,0x145c0,0x1f31c,0x203d8,0x144f0,0x146d0,0x1f320,0x203dc,0x145c0,0x147a0,0x1f324,0x203e0,0x146d0,0x148b0
.long 0x1f328,0x203e4,0x147a0,0x14980,0x1f32c,0x203e8,0x148b0,0x14a90,0x1f330,0x203ec,0x14980,0x14be0,0x1f334,0x203f0,0x14a90,0x14cf0
.long 0x1f338,0x203f4,0x14be0,0x14dc0,0x1f33c,0x203f8,0x14cf0,0x14ed0,0x1f340,0x203fc,0x14dc0,0x14fa0,0x1f344,0x20400,0x14ed0,0x150b0
.long 0x14210,0x14470,0x14dc0,0x14f60,0x14360,0x14540,0x14ed0,0x15070,0x14470,0x14650,0x14fa0,0x15140,0x14540,0x14720,0x150b0,0x15250
.long 0x14650,0x14830,0x15180,0x15320,0x14720,0x14900,0x15290,0x15430,0x14830,0x14a10,0x153e0,0x15500,0x14900,0x14b60,0x154f0,0x15610
.long 0x14a10,0x14c70,0x155c0,0x15760,0x14b60,0x14d40,0x156d0,0x15870,0x14c70,0x14e50,0x157a0,0x15940,0x14d40,0x14f20,0x158b0,0x15a50
.long 0x14e50,0x15030,0x15980,0x15b20,0x14f20,0x15100,0x15a90,0x15c30,0x15030,0x15210,0x15be0,0x15d00,0x15100,0x15360,0x15cf0,0x15e10
.long 0x14290,0x144f0,0x14e50,0x14fe0,0x143e0,0x145c0,0x14f20,0x150f0,0x144f0,0x146d0,0x15030,0x151c0,0x145c0,0x147a0,0x15100,0x152d0
.long 0x146d0,0x148b0,0x15210,0x153a0,0x147a0,0x14980,0x15360,0x154b0,0x148b0,0x14a90,0x15470,0x15580,0x14980,0x14be0,0x15540,0x15690
.long 0x14a90,0x14cf0,0x15650,0x157e0,0x14be0,0x14dc0,0x15720,0x158f0,0x14cf0,0x14ed0,0x15830,0x159c0,0x14dc0,0x14fa0,0x15900,0x15ad0
.long 0x14ed0,0x150b0,0x15a10,0x15ba0,0x14fa0,0x15180,0x15b60,0x15cb0,0x150b0,0x15290,0x15c70,0x15d80,0x15180,0x153e0,0x15d40,0x15e90
.long 0x14360,0x14540,0x14ed0,0x14f20,0x14470,0x14650,0x14fa0,0x15030,0x14540,0x14720,0x150b0,0x15100,0x14650,0x14830,0x15180,0x15210
.long 0x14720,0x14900,0x15290,0x15360,0x14830,0x14a10,0x153e0,0x15470,0x14900,0x14b60,0x154f0,0x15540,0x14a10,0x14c70,0x155c0,0x15650
.long 0x14b60,0x14d40,0x156d0,0x15720,0x14c70,0x14e50,0x157a0,0x15830,0x14d40,0x14f20,0x158b0,0x15900,0x14e50,0x15030,0x15980,0x15a10
.long 0x14f20,0x15100,0x15a90,0x15b60,0x15030,0x15210,0x15be0,0x15c70,0x15100,0x15360,0x15cf0,0x15d40,0x15210,0x15470,0x15dc0,0x15e50
.long 0x143e0,0x145c0,0x14f20,0x14fa0,0x144f0,0x146d0,0x15030,0x150b0,0x145c0,0x147a0,0x15100,0x15180,0x146d0,0x148b0,0x15210,0x15290
.long 0x147a0,0x14980,0x15360,0x153e0,0x148b0,0x14a90,0x15470,0x154f0,0x14980,0x14be0,0x15540,0x155c0,0x14a90,0x14cf0,0x15650,0x156d0
.long 0x14be0,0x14dc0,0x15720,0x157a0,0x14cf0,0x14ed0,0x15830,0x158b0,0x14dc0,0x14fa0,0x15900,0x15980,0x14ed0,0x150b0,0x15a10,0x15a90
.long 0x14fa0,0x15180,0x15b60,0x15be0,0x150b0,0x15290,0x15c70,0x15cf0,0x15180,0x153e0,0x15d40,0x15dc0,0x15290,0x154f0,0x15e50,0x15ed0
.long 0x110,0x110,0x110,0x110,0x100,0x100,0x100,0x100,0x130,0x130,0x130,0x130,0x120,0x120,0x120,0x120
.long 0x14190,0x14190,0x14190,0x14190,0x14180,0x14180,0x14180,0x14180,0x141b0,0x141b0,0x141b0,0x141b0,0x141a0,0x141a0,0x141a0,0x141a0
.long 0x28210,0x28210,0x28210,0x28210,0x28200,0x28200,0x28200,0x28200,0x28230,0x28230,0x28230,0x28230,0x28220,0x28220,0x28220,0x28220
.long 0x3c290,0x3c290,0x3c290,0x3c290,0x3c280,0x3c280,0x3c280,0x3c280,0x3c2b0,0x3c2b0,0x3c2b0,0x3c2b0,0x3c2a0,0x3c2a0,0x3c2a0,0x3c2a0
.long 0x50310,0x50310,0x50310,0x50310,0x50300,0x50300,0x50300,0x50300,0x50330,0x50330,0x50330,0x50330,0x50320,0x50320,0x50320,0x50320
.long 0x64390,0x64390,0x64390,0x64390,0x64380,0x64380,0x64380,0x64380,0x643b0,0x643b0,0x643b0,0x643b0,0x643a0,0x643a0,0x643a0,0x643a0
.long 0x78410,0x78410,0x78410,0x78410,0x78400,0x78400,0x78400,0x78400,0x78430,0x78430,0x78430,0x78430,0x78420,0x78420,0x78420,0x78420
.long 0x8c490,0x8c490,0x8c490,0x8c490,0x8c480,0x8c480,0x8c480,0x8c480,0x8c4b0,0x8c4b0,0x8c4b0,0x8c4b0,0x8c4a0,0x8c4a0,0x8c4a0,0x8c4a0
.long 0x150,0x150,0x150,0x150,0x140,0x140,0x140,0x140,0x170,0x170,0x170,0x170,0x160,0x160,0x160,0x160
.long 0x141d0,0x141d0,0x141d0,0x141d0,0x141c0,0x141c0,0x141c0,0x141c0,0x141f0,0x141f0,0x141f0,0x141f0,0x141e0,0x141e0,0x141e0,0x141e0
.long 0x28250,0x28250,0x28250,0x28250,0x28240,0x28240,0x28240,0x28240,0x28270,0x28270,0x28270,0x28270,0x28260,0x28260,0x28260,0x28260
.long 0x3c2d0,0x3c2d0,0x3c2d0,0x3c2d0,0x3c2c0,0x3c2c0,0x3c2c0,0x3c2c0,0x3c2f0,0x3c2f0,0x3c2f0,0x3c2f0,0x3c2e0,0x3c2e0,0x3c2e0,0x3c2e0
.long 0x50350,0x50350,0x50350,0x50350,0x50340,0x50340,0x50340,0x50340,0x50370,0x50370,0x50370,0x50370,0x50360,0x50360,0x50360,0x50360
.long 0x643d0,0x643d0,0x643d0,0x643d0,0x643c0,0x643c0,0x643c0,0x643c0,0x643f0,0x643f0,0x643f0,0x643f0,0x643e0,0x643e0,0x643e0,0x643e0
.long 0x78450,0x78450,0x78450,0x78450,0x78440,0x78440,0x78440,0x78440,0x78470,0x78470,0x78470,0x78470,0x78460,0x78460,0x78460,0x78460
.long 0x8c4d0,0x8c4d0,0x8c4d0,0x8c4d0,0x8c4c0,0x8c4c0,0x8c4c0,0x8c4c0,0x8c4f0,0x8c4f0,0x8c4f0,0x8c4f0,0x8c4e0,0x8c4e0,0x8c4e0,0x8c4e0
.long 0x0,0x0,0x3f800000,0x3f803f80,0x0,0x0,0x0,0x3f803f80,0x0,0x0,0x0,0x3f800000,0x0,0x0,0x0,0x0
.long 0x0,0x0,0x0,0x0,0x0,0x0,0x0,0x0,0x0,0x0,0x0,0x0,0x0,0x0,0x0,0x0
.long 0x0,0x0,0x0,0x0,0x0,0x0,0x0,0x0,0x0,0x0,0x0,0x0,0x0,0x0,0x0,0x0
.long 0x0,0x0,0x0,0x0,0x0,0x0,0x0,0x0,0x0,0x0,0x0,0x0,0x0,0x0,0x0,0x0
.long 0x3f803f80,0x3f803f80,0x0,0x0,0x3f803f80,0x3f803f80,0x3f80,0x0,0x3f803f80,0x3f803f80,0x3f803f80,0x0,0x3f803f80,0x3f803f80,0x3f803f80,0x3f80
.long 0x3f800000,0x3f803f80,0x3f803f80,0x3f803f80,0x0,0x3f803f80,0x3f803f80,0x3f803f80,0x0,0x3f800000,0x3f803f80,0x3f803f80,0x0,0x0,0x3f803f80,0x3f803f80
.long 0x0,0x0,0x3f800000,0x3f803f80,0x0,0x0,0x0,0x3f803f80,0x0,0x0,0x0,0x3f800000,0x0,0x0,0x0,0x0
.long 0x0,0x0,0x0,0x0,0x0,0x0,0x0,0x0,0x0,0x0,0x0,0x0,0x0,0x0,0x0,0x0
.long 0x0,0x0,0x0,0x0,0x0,0x0,0x0,0x0,0x0,0x0,0x0,0x0,0x0,0x0,0x0,0x0
.long 0x0,0x0,0x0,0x0,0x3f80,0x0,0x0,0x0,0x3f803f80,0x0,0x0,0x0,0x3f803f80,0x3f80,0x0,0x0
.long 0x3f803f80,0x3f803f80,0x0,0x0,0x3f803f80,0x3f803f80,0x3f80,0x0,0x3f803f80,0x3f803f80,0x3f803f80,0x0,0x3f803f80,0x3f803f80,0x3f803f80,0x3f80
.long 0x3f800000,0x3f803f80,0x3f803f80,0x3f803f80,0x0,0x3f803f80,0x3f803f80,0x3f803f80,0x0,0x3f800000,0x3f803f80,0x3f803f80,0x0,0x0,0x3f803f80,0x3f803f80
.long 0x0,0x0,0x0,0x0,0x0,0x0,0x0,0x0,0x0,0x0,0x0,0x0,0x0,0x0,0x0,0x0
.long 0x0,0x0,0x0,0x0,0x0,0x0,0x0,0x0,0x0,0x0,0x0,0x0,0x0,0x0,0x0,0x0
.long 0x0,0x0,0x0,0x0,0x0,0x0,0x0,0x0,0x0,0x0,0x0,0x0,0x0,0x0,0x0,0x0
.long 0x0,0x0,0x0,0x0,0x3f80,0x0,0x0,0x0,0x3f803f80,0x0,0x0,0x0,0x3f803f80,0x3f80,0x0,0x0
.long 0x0,0x0,0x3f803f80,0x3f803f80,0x0,0x0,0x3f800000,0x3f803f80,0x0,0x0,0x0,0x3f803f80,0x0,0x0,0x0,0x3f800000
.long 0x0,0x0,0x0,0x0,0x0,0x0,0x0,0x0,0x0,0x0,0x0,0x0,0x0,0x0,0x0,0x0
.long 0x0,0x0,0x0,0x0,0x0,0x0,0x0,0x0,0x0,0x0,0x0,0x0,0x0,0x0,0x0,0x0
.long 0x0,0x0,0x0,0x0,0x0,0x0,0x0,0x0,0x0,0x0,0x0,0x0,0x0,0x0,0x0,0x0
.long 0x3f803f80,0x3f803f80,0x3f80,0x0,0x3f803f80,0x3f803f80,0x3f803f80,0x0,0x3f803f80,0x3f803f80,0x3f803f80,0x3f80,0x3f803f80,0x3f803f80,0x3f803f80,0x3f803f80
.long 0x3f803f80,0x3f803f80,0x3f803f80,0x3f803f80,0x3f800000,0x3f803f80,0x3f803f80,0x3f803f80,0x0,0x3f803f80,0x3f803f80,0x3f803f80,0x0,0x3f800000,0x3f803f80,0x3f803f80
.long 0x0,0x0,0x3f803f80,0x3f803f80,0x0,0x0,0x3f800000,0x3f803f80,0x0,0x0,0x0,0x3f803f80,0x0,0x0,0x0,0x3f800000
.long 0x0,0x0,0x0,0x0,0x0,0x0,0x0,0x0,0x0,0x0,0x0,0x0,0x0,0x0,0x0,0x0
.long 0x0,0x0,0x0,0x0,0x0,0x0,0x0,0x0,0x0,0x0,0x0,0x0,0x0,0x0,0x0,0x0
.long 0x3f80,0x0,0x0,0x0,0x3f803f80,0x0,0x0,0x0,0x3f803f80,0x3f80,0x0,0x0,0x3f803f80,0x3f803f80,0x0,0x0
.long 0x3f803f80,0x3f803f80,0x3f80,0x0,0x3f803f80,0x3f803f80,0x3f803f80,0x0,0x3f803f80,0x3f803f80,0x3f803f80,0x3f80,0x3f803f80,0x3f803f80,0x3f803f80,0x3f803f80
.long 0x3f803f80,0x3f803f80,0x3f803f80,0x3f803f80,0x3f800000,0x3f803f80,0x3f803f80,0x3f803f80,0x0,0x3f803f80,0x3f803f80,0x3f803f80,0x0,0x3f800000,0x3f803f80,0x3f803f80
.long 0x0,0x0,0x0,0x0,0x0,0x0,0x0,0x0,0x0,0x0,0x0,0x0,0x0,0x0,0x0,0x0
.long 0x0,0x0,0x0,0x0,0x0,0x0,0x0,0x0,0x0,0x0,0x0,0x0,0x0,0x0,0x0,0x0
.long 0x0,0x0,0x0,0x0,0x0,0x0,0x0,0x0,0x0,0x0,0x0,0x0,0x0,0x0,0x0,0x0
.long 0x3f80,0x0,0x0,0x0,0x3f803f80,0x0,0x0,0x0,0x3f803f80,0x3f80,0x0,0x0,0x3f803f80,0x3f803f80,0x0,0x0
.long 0x0,0x10,0x20,0x30,0x8,0x18,0x28,0x38,0x40,0x50,0x60,0x70,0x48,0x58,0x68,0x78
.long 0x80,0x90,0xa0,0xb0,0x88,0x98,0xa8,0xb8,0xc0,0xd0,0xe0,0xf0,0xc8,0xd8,0xe8,0xf8
.long 0x110,0x100,0x130,0x120,0x118,0x108,0x138,0x128,0x150,0x140,0x170,0x160,0x158,0x148,0x178,0x168
.long 0x190,0x180,0x1b0,0x1a0,0x198,0x188,0x1b8,0x1a8,0x1d0,0x1c0,0x1f0,0x1e0,0x1d8,0x1c8,0x1f8,0x1e8
.long 0x220,0x230,0x200,0x210,0x228,0x238,0x208,0x218,0x260,0x270,0x240,0x250,0x268,0x278,0x248,0x258
.long 0x2a0,0x2b0,0x280,0x290,0x2a8,0x2b8,0x288,0x298,0x2e0,0x2f0,0x2c0,0x2d0,0x2e8,0x2f8,0x2c8,0x2d8
.long 0x330,0x320,0x310,0x300,0x338,0x328,0x318,0x308,0x370,0x360,0x350,0x340,0x378,0x368,0x358,0x348
.long 0x3b0,0x3a0,0x390,0x380,0x3b8,0x3a8,0x398,0x388,0x3f0,0x3e0,0x3d0,0x3c0,0x3f8,0x3e8,0x3d8,0x3c8
.long 0x400,0x410,0x420,0x430,0x408,0x418,0x428,0x438,0x440,0x450,0x460,0x470,0x448,0x458,0x468,0x478
.long 0x480,0x490,0x4a0,0x4b0,0x488,0x498,0x4a8,0x4b8,0x4c0,0x4d0,0x4e0,0x4f0,0x4c8,0x4d8,0x4e8,0x4f8
.long 0x510,0x500,0x530,0x520,0x518,0x508,0x538,0x528,0x550,0x540,0x570,0x560,0x558,0x548,0x578,0x568
.long 0x590,0x580,0x5b0,0x5a0,0x598,0x588,0x5b8,0x5a8,0x5d0,0x5c0,0x5f0,0x5e0,0x5d8,0x5c8,0x5f8,0x5e8
.long 0x620,0x630,0x600,0x610,0x628,0x638,0x608,0x618,0x660,0x670,0x640,0x650,0x668,0x678,0x648,0x658
.long 0x6a0,0x6b0,0x680,0x690,0x6a8,0x6b8,0x688,0x698,0x6e0,0x6f0,0x6c0,0x6d0,0x6e8,0x6f8,0x6c8,0x6d8
.long 0x730,0x720,0x710,0x700,0x738,0x728,0x718,0x708,0x770,0x760,0x750,0x740,0x778,0x768,0x758,0x748
.long 0x7b0,0x7a0,0x790,0x780,0x7b8,0x7a8,0x798,0x788,0x7f0,0x7e0,0x7d0,0x7c0,0x7f8,0x7e8,0x7d8,0x7c8
.long 0x1000,0x810,0x0,0x600,0x1008,0x818,0x8,0xc600,0x1040,0x850,0x40,0x18600,0x1048,0x858,0x48,0x24600
.long 0x1080,0x890,0x80,0x30600,0x1088,0x898,0x88,0x3c600,0x10c0,0x8d0,0xc0,0x7ffffff0,0x10c8,0x8d8,0xc8,0x7ffffff0
.long 0x1110,0x900,0x110,0x600,0x1118,0x908,0x118,0xc600,0x1150,0x940,0x150,0x18600,0x1158,0x948,0x158,0x24600
.long 0x1190,0x980,0x190,0x30600,0x1198,0x988,0x198,0x3c600,0x11d0,0x9c0,0x1d0,0x7ffffff0,0x11d8,0x9c8,0x1d8,0x7ffffff0
.long 0x1220,0xa30,0x220,0x640,0x1228,0xa38,0x228,0xc640,0x1260,0xa70,0x260,0x18640,0x1268,0xa78,0x268,0x24640
.long 0x12a0,0xab0,0x2a0,0x30640,0x12a8,0xab8,0x2a8,0x3c640,0x12e0,0xaf0,0x2e0,0x7ffffff0,0x12e8,0xaf8,0x2e8,0x7ffffff0
.long 0x1330,0xb20,0x330,0x640,0x1338,0xb28,0x338,0xc640,0x1370,0xb60,0x370,0x18640,0x1378,0xb68,0x378,0x24640
.long 0x13b0,0xba0,0x3b0,0x30640,0x13b8,0xba8,0x3b8,0x3c640,0x13f0,0xbe0,0x3f0,0x7ffffff0,0x13f8,0xbe8,0x3f8,0x7ffffff0
.long 0x1400,0xc10,0x400,0x680,0x1408,0xc18,0x408,0xc680,0x1440,0xc50,0x440,0x18680,0x1448,0xc58,0x448,0x24680
.long 0x1480,0xc90,0x480,0x30680,0x1488,0xc98,0x488,0x3c680,0x14c0,0xcd0,0x4c0,0x7ffffff0,0x14c8,0xcd8,0x4c8,0x7ffffff0
.long 0x1510,0xd00,0x510,0x680,0x1518,0xd08,0x518,0xc680,0x1550,0xd40,0x550,0x18680,0x1558,0xd48,0x558,0x24680
.long 0x1590,0xd80,0x590,0x30680,0x1598,0xd88,0x598,0x3c680,0x15d0,0xdc0,0x5d0,0x7ffffff0,0x15d8,0xdc8,0x5d8,0x7ffffff0
.long 0x1620,0xe30,0x620,0x6c0,0x1628,0xe38,0x628,0xc6c0,0x1660,0xe70,0x660,0x186c0,0x1668,0xe78,0x668,0x246c0
.long 0x16a0,0xeb0,0x6a0,0x306c0,0x16a8,0xeb8,0x6a8,0x3c6c0,0x16e0,0xef0,0x6e0,0x7ffffff0,0x16e8,0xef8,0x6e8,0x7ffffff0
.long 0x1730,0xf20,0x730,0x6c0,0x1738,0xf28,0x738,0xc6c0,0x1770,0xf60,0x770,0x186c0,0x1778,0xf68,0x778,0x246c0
.long 0x17b0,0xfa0,0x7b0,0x306c0,0x17b8,0xfa8,0x7b8,0x3c6c0,0x17f0,0xfe0,0x7f0,0x7ffffff0,0x17f8,0xfe8,0x7f8,0x7ffffff0
.long 0x40,0x5020,0x7ffffff0,0x0,0x540,0x5520,0x7ffffff0,0x10,0xa40,0x5a20,0x7ffffff0,0x20,0xf40,0x5f20,0x7ffffff0,0x30
.long 0x1440,0x6420,0x7ffffff0,0x40,0x1940,0x6920,0x7ffffff0,0x50,0x1e40,0x6e20,0x7ffffff0,0x60,0x2340,0x7320,0x7ffffff0,0x70
.long 0x2840,0x7820,0x7ffffff0,0x80,0x2d40,0x7d20,0x7ffffff0,0x90,0x3240,0x8220,0x7ffffff0,0xa0,0x3740,0x8720,0x7ffffff0,0xb0
.long 0x3c40,0x8c20,0x7ffffff0,0xc0,0x4140,0x9120,0x7ffffff0,0xd0,0x4640,0x9620,0x7ffffff0,0xe0,0x4b40,0x9b20,0x7ffffff0,0xf0
.long 0x48,0x5028,0x7ffffff0,0x400,0x548,0x5528,0x7ffffff0,0x410,0xa48,0x5a28,0x7ffffff0,0x420,0xf48,0x5f28,0x7ffffff0,0x430
.long 0x1448,0x6428,0x7ffffff0,0x440,0x1948,0x6928,0x7ffffff0,0x450,0x1e48,0x6e28,0x7ffffff0,0x460,0x2348,0x7328,0x7ffffff0,0x470
.long 0x2848,0x7828,0x7ffffff0,0x480,0x2d48,0x7d28,0x7ffffff0,0x490,0x3248,0x8228,0x7ffffff0,0x4a0,0x3748,0x8728,0x7ffffff0,0x4b0
.long 0x3c48,0x8c28,0x7ffffff0,0x4c0,0x4148,0x9128,0x7ffffff0,0x4d0,0x4648,0x9628,0x7ffffff0,0x4e0,0x4b48,0x9b28,0x7ffffff0,0x4f0
.long 0x50,0x5030,0x7ffffff0,0x800,0x550,0x5530,0x7ffffff0,0x810,0xa50,0x5a30,0x7ffffff0,0x820,0xf50,0x5f30,0x7ffffff0,0x830
.long 0x1450,0x6430,0x7ffffff0,0x840,0x1950,0x6930,0x7ffffff0,0x850,0x1e50,0x6e30,0x7ffffff0,0x860,0x2350,0x7330,0x7ffffff0,0x870
.long 0x2850,0x7830,0x7ffffff0,0x880,0x2d50,0x7d30,0x7ffffff0,0x890,0x3250,0x8230,0x7ffffff0,0x8a0,0x3750,0x8730,0x7ffffff0,0x8b0
.long 0x3c50,0x8c30,0x7ffffff0,0x8c0,0x4150,0x9130,0x7ffffff0,0x8d0,0x4650,0x9630,0x7ffffff0,0x8e0,0x4b50,0x9b30,0x7ffffff0,0x8f0
.long 0x58,0x5038,0x7ffffff0,0xc00,0x558,0x5538,0x7ffffff0,0xc10,0xa58,0x5a38,0x7ffffff0,0xc20,0xf58,0x5f38,0x7ffffff0,0xc30
.long 0x1458,0x6438,0x7ffffff0,0xc40,0x1958,0x6938,0x7ffffff0,0xc50,0x1e58,0x6e38,0x7ffffff0,0xc60,0x2358,0x7338,0x7ffffff0,0xc70
.long 0x2858,0x7838,0x7ffffff0,0xc80,0x2d58,0x7d38,0x7ffffff0,0xc90,0x3258,0x8238,0x7ffffff0,0xca0,0x3758,0x8738,0x7ffffff0,0xcb0
.long 0x3c58,0x8c38,0x7ffffff0,0xcc0,0x4158,0x9138,0x7ffffff0,0xcd0,0x4658,0x9638,0x7ffffff0,0xce0,0x4b58,0x9b38,0x7ffffff0,0xcf0
.long 0xc00,0xc000,0x800,0x2000,0xc10,0xc010,0x810,0x2010,0xc20,0xc020,0x820,0x2020,0xc30,0xc030,0x830,0x2030
.long 0xc40,0xc040,0x840,0x2040,0xc50,0xc050,0x850,0x2050,0xc60,0xc060,0x860,0x2060,0xc70,0xc070,0x870,0x2070
.long 0xc80,0xc080,0x880,0x2080,0xc90,0xc090,0x890,0x2090,0xca0,0xc0a0,0x8a0,0x20a0,0xcb0,0xc0b0,0x8b0,0x20b0
.long 0xcc0,0xc0c0,0x8c0,0x20c0,0xcd0,0xc0d0,0x8d0,0x20d0,0xce0,0xc0e0,0x8e0,0x20e0,0xcf0,0xc0f0,0x8f0,0x20f0
.long 0xd00,0xc200,0x900,0x2100,0xd10,0xc210,0x910,0x2110,0xd20,0xc220,0x920,0x2120,0xd30,0xc230,0x930,0x2130
.long 0xd40,0xc240,0x940,0x2140,0xd50,0xc250,0x950,0x2150,0xd60,0xc260,0x960,0x2160,0xd70,0xc270,0x970,0x2170
.long 0xd80,0xc280,0x980,0x2180,0xd90,0xc290,0x990,0x2190,0xda0,0xc2a0,0x9a0,0x21a0,0xdb0,0xc2b0,0x9b0,0x21b0
.long 0xdc0,0xc2c0,0x9c0,0x21c0,0xdd0,0xc2d0,0x9d0,0x21d0,0xde0,0xc2e0,0x9e0,0x21e0,0xdf0,0xc2f0,0x9f0,0x21f0
.long 0x18c00,0xc400,0xa00,0x2200,0x18c10,0xc410,0xa10,0x2210,0x18c20,0xc420,0xa20,0x2220,0x18c30,0xc430,0xa30,0x2230
.long 0x18c40,0xc440,0xa40,0x2240,0x18c50,0xc450,0xa50,0x2250,0x18c60,0xc460,0xa60,0x2260,0x18c70,0xc470,0xa70,0x2270
.long 0x18c80,0xc480,0xa80,0x2280,0x18c90,0xc490,0xa90,0x2290,0x18ca0,0xc4a0,0xaa0,0x22a0,0x18cb0,0xc4b0,0xab0,0x22b0
.long 0x18cc0,0xc4c0,0xac0,0x22c0,0x18cd0,0xc4d0,0xad0,0x22d0,0x18ce0,0xc4e0,0xae0,0x22e0,0x18cf0,0xc4f0,0xaf0,0x22f0
.long 0x18d00,0xc600,0xb00,0x2300,0x18d10,0xc610,0xb10,0x2310,0x18d20,0xc620,0xb20,0x2320,0x18d30,0xc630,0xb30,0x2330
.long 0x18d40,0xc640,0xb40,0x2340,0x18d50,0xc650,0xb50,0x2350,0x18d60,0xc660,0xb60,0x2360,0x18d70,0xc670,0xb70,0x2370
.long 0x18d80,0xc680,0xb80,0x2380,0x18d90,0xc690,0xb90,0x2390,0x18da0,0xc6a0,0xba0,0x23a0,0x18db0,0xc6b0,0xbb0,0x23b0
.long 0x18dc0,0xc6c0,0xbc0,0x23c0,0x18dd0,0xc6d0,0xbd0,0x23d0,0x18de0,0xc6e0,0xbe0,0x23e0,0x18df0,0xc6f0,0xbf0,0x23f0
.long 0x20500,0x20500,0x20500,0x21600,0x20520,0x20520,0x20504,0x21600,0x20540,0x20540,0x20508,0x21604,0x20560,0x20560,0x2050c,0x21604
.long 0x20580,0x20580,0x20510,0x21608,0x205a0,0x205a0,0x20514,0x21608,0x205c0,0x205c0,0x20518,0x2160c,0x205e0,0x205e0,0x2051c,0x2160c
.long 0x20600,0x20600,0x20520,0x21610,0x20620,0x20620,0x20524,0x21610,0x20640,0x20640,0x20528,0x21614,0x20660,0x20660,0x2052c,0x21614
.long 0x20680,0x20680,0x20530,0x21618,0x206a0,0x206a0,0x20534,0x21618,0x206c0,0x206c0,0x20538,0x2161c,0x206e0,0x206e0,0x2053c,0x2161c
.long 0x20700,0x20700,0x20540,0x21620,0x20720,0x20720,0x20544,0x21620,0x20740,0x20740,0x20548,0x21624,0x20760,0x20760,0x2054c,0x21624
.long 0x20780,0x20780,0x20550,0x21628,0x207a0,0x207a0,0x20554,0x21628,0x207c0,0x207c0,0x20558,0x2162c,0x207e0,0x207e0,0x2055c,0x2162c
.long 0x20800,0x20800,0x20560,0x21630,0x20820,0x20820,0x20564,0x21630,0x20840,0x20840,0x20568,0x21634,0x20860,0x20860,0x2056c,0x21634
.long 0x20880,0x20880,0x20570,0x21638,0x208a0,0x208a0,0x20574,0x21638,0x208c0,0x208c0,0x20578,0x2163c,0x208e0,0x208e0,0x2057c,0x2163c
.long 0x20510,0x20900,0x20580,0x21640,0x20530,0x20920,0x20584,0x21640,0x20550,0x20940,0x20588,0x21644,0x20570,0x20960,0x2058c,0x21644
.long 0x20590,0x20980,0x20590,0x21648,0x205b0,0x209a0,0x20594,0x21648,0x205d0,0x209c0,0x20598,0x2164c,0x205f0,0x209e0,0x2059c,0x2164c
.long 0x20610,0x20a00,0x205a0,0x21650,0x20630,0x20a20,0x205a4,0x21650,0x20650,0x20a40,0x205a8,0x21654,0x20670,0x20a60,0x205ac,0x21654
.long 0x20690,0x20a80,0x205b0,0x21658,0x206b0,0x20aa0,0x205b4,0x21658,0x206d0,0x20ac0,0x205b8,0x2165c,0x206f0,0x20ae0,0x205bc,0x2165c
.long 0x20710,0x20b00,0x205c0,0x21660,0x20730,0x20b20,0x205c4,0x21660,0x20750,0x20b40,0x205c8,0x21664,0x20770,0x20b60,0x205cc,0x21664
.long 0x20790,0x20b80,0x205d0,0x21668,0x207b0,0x20ba0,0x205d4,0x21668,0x207d0,0x20bc0,0x205d8,0x2166c,0x207f0,0x20be0,0x205dc,0x2166c
.long 0x20810,0x20c00,0x205e0,0x21670,0x20830,0x20c20,0x205e4,0x21670,0x20850,0x20c40,0x205e8,0x21674,0x20870,0x20c60,0x205ec,0x21674
.long 0x20890,0x20c80,0x205f0,0x21678,0x208b0,0x20ca0,0x205f4,0x21678,0x208d0,0x20cc0,0x205f8,0x2167c,0x208f0,0x20ce0,0x205fc,0x2167c
.long 0x1,0x0,0x0,0x0,0x10000,0x0,0x0,0x0,0x0,0x1,0x0,0x0,0x0,0x10000,0x0,0x0
.long 0x0,0x0,0x1,0x0,0x0,0x0,0x10000,0x0,0x0,0x0,0x0,0x1,0x0,0x0,0x0,0x10000
.long 0x0,0x0,0x0,0x0,0x0,0x0,0x0,0x0,0x0,0x0,0x0,0x0,0x0,0x0,0x0,0x0
.long 0x0,0x0,0x0,0x0,0x0,0x0,0x0,0x0,0x0,0x0,0x0,0x0,0x0,0x0,0x0,0x0
.long 0x0,0x0,0x0,0x0,0x0,0x0,0x0,0x0,0x0,0x0,0x0,0x0,0x0,0x0,0x0,0x0
.long 0x0,0x0,0x0,0x0,0x0,0x0,0x0,0x0,0x0,0x0,0x0,0x0,0x0,0x0,0x0,0x0
.long 0x1,0x0,0x0,0x0,0x10000,0x0,0x0,0x0,0x0,0x1,0x0,0x0,0x0,0x10000,0x0,0x0
.long 0x0,0x0,0x1,0x0,0x0,0x0,0x10000,0x0,0x0,0x0,0x0,0x1,0x0,0x0,0x0,0x10000
.long 0x1,0x0,0x0,0x0,0x10000,0x0,0x0,0x0,0x0,0x1,0x0,0x0,0x0,0x10000,0x0,0x0
.long 0x0,0x0,0x1,0x0,0x0,0x0,0x10000,0x0,0x0,0x0,0x0,0x1,0x0,0x0,0x0,0x10000
.long 0x0,0x0,0x0,0x0,0x0,0x0,0x0,0x0,0x0,0x0,0x0,0x0,0x0,0x0,0x0,0x0
.long 0x0,0x0,0x0,0x0,0x0,0x0,0x0,0x0,0x0,0x0,0x0,0x0,0x0,0x0,0x0,0x0
.long 0x0,0x0,0x0,0x0,0x0,0x0,0x0,0x0,0x0,0x0,0x0,0x0,0x0,0x0,0x0,0x0
.long 0x0,0x0,0x0,0x0,0x0,0x0,0x0,0x0,0x0,0x0,0x0,0x0,0x0,0x0,0x0,0x0
.long 0x1,0x0,0x0,0x0,0x10000,0x0,0x0,0x0,0x0,0x1,0x0,0x0,0x0,0x10000,0x0,0x0
.long 0x0,0x0,0x1,0x0,0x0,0x0,0x10000,0x0,0x0,0x0,0x0,0x1,0x0,0x0,0x0,0x10000
.long 0x20568,0x215f4,0x13e40,0x14020,0x2056c,0x215f8,0x13f30,0x14110,0x20570,0x215fc,0x14020,0x14200,0x20574,0x21600,0x14110,0x14370
.long 0x20578,0x21604,0x14200,0x14460,0x2057c,0x21608,0x14370,0x14550,0x20580,0x2160c,0x14460,0x14640,0x20584,0x21610,0x14550,0x14730
.long 0x20588,0x21614,0x14640,0x14820,0x2058c,0x21618,0x14730,0x14910,0x20590,0x2161c,0x14820,0x14a00,0x20594,0x21620,0x14910,0x14b70
.long 0x20598,0x21624,0x14a00,0x14c60,0x2059c,0x21628,0x14b70,0x14d50,0x205a0,0x2162c,0x14c60,0x14e40,0x205a4,0x21630,0x14d50,0x14f30
.long 0x20548,0x215e4,0x13ec0,0x140a0,0x2054c,0x215e8,0x13fb0,0x14190,0x20550,0x215ec,0x140a0,0x14280,0x20554,0x215f0,0x14190,0x143f0
.long 0x20558,0x215f4,0x14280,0x144e0,0x2055c,0x215f8,0x143f0,0x145d0,0x20560,0x215fc,0x144e0,0x146c0,0x20564,0x21600,0x145d0,0x147b0
.long 0x20568,0x21604,0x146c0,0x148a0,0x2056c,0x21608,0x147b0,0x14990,0x20570,0x2160c,0x148a0,0x14a80,0x20574,0x21610,0x14990,0x14bf0
.long 0x20578,0x21614,0x14a80,0x14ce0,0x2057c,0x21618,0x14bf0,0x14dd0,0x20580,0x2161c,0x14ce0,0x14ec0,0x20584,0x21620,0x14dd0,0x14fb0
.long 0x20528,0x215d4,0x13f30,0x14110,0x2052c,0x215d8,0x14020,0x14200,0x20530,0x215dc,0x14110,0x14370,0x20534,0x215e0,0x14200,0x14460
.long 0x20538,0x215e4,0x14370,0x14550,0x2053c,0x215e8,0x14460,0x14640,0x20540,0x215ec,0x14550,0x14730,0x20544,0x215f0,0x14640,0x14820
.long 0x20548,0x215f4,0x14730,0x14910,0x2054c,0x215f8,0x14820,0x14a00,0x20550,0x215fc,0x14910,0x14b70,0x20554,0x21600,0x14a00,0x14c60
.long 0x20558,0x21604,0x14b70,0x14d50,0x2055c,0x21608,0x14c60,0x14e40,0x20560,0x2160c,0x14d50,0x14f30,0x20564,0x21610,0x14e40,0x15020
.long 0x20508,0x215c4,0x13fb0,0x14190,0x2050c,0x215c8,0x140a0,0x14280,0x20510,0x215cc,0x14190,0x143f0,0x20514,0x215d0,0x14280,0x144e0
.long 0x20518,0x215d4,0x143f0,0x145d0,0x2051c,0x215d8,0x144e0,0x146c0,0x20520,0x215dc,0x145d0,0x147b0,0x20524,0x215e0,0x146c0,0x148a0
.long 0x20528,0x215e4,0x147b0,0x14990,0x2052c,0x215e8,0x148a0,0x14a80,0x20530,0x215ec,0x14990,0x14bf0,0x20534,0x215f0,0x14a80,0x14ce0
.long 0x20538,0x215f4,0x14bf0,0x14dd0,0x2053c,0x215f8,0x14ce0,0x14ec0,0x20540,0x215fc,0x14dd0,0x14fb0,0x20544,0x21600,0x14ec0,0x150a0
.long 0x14200,0x14460,0x14dd0,0x14f70,0x14370,0x14550,0x14ec0,0x15060,0x14460,0x14640,0x14fb0,0x15150,0x14550,0x14730,0x150a0,0x15240
.long 0x14640,0x14820,0x15190,0x15330,0x14730,0x14910,0x15280,0x15420,0x14820,0x14a00,0x153f0,0x15510,0x14910,0x14b70,0x154e0,0x15600
.long 0x14a00,0x14c60,0x155d0,0x15770,0x14b70,0x14d50,0x156c0,0x15860,0x14c60,0x14e40,0x157b0,0x15950,0x14d50,0x14f30,0x158a0,0x15a40
.long 0x14e40,0x15020,0x15990,0x15b30,0x14f30,0x15110,0x15a80,0x15c20,0x15020,0x15200,0x15bf0,0x15d10,0x15110,0x15370,0x15ce0,0x15e00
.long 0x14280,0x144e0,0x14e40,0x14ff0,0x143f0,0x145d0,0x14f30,0x150e0,0x144e0,0x146c0,0x15020,0x151d0,0x145d0,0x147b0,0x15110,0x152c0
.long 0x146c0,0x148a0,0x15200,0x153b0,0x147b0,0x14990,0x15370,0x154a0,0x148a0,0x14a80,0x15460,0x15590,0x14990,0x14bf0,0x15550,0x15680
.long 0x14a80,0x14ce0,0x15640,0x157f0,0x14bf0,0x14dd0,0x15730,0x158e0,0x14ce0,0x14ec0,0x15820,0x159d0,0x14dd0,0x14fb0,0x15910,0x15ac0
.long 0x14ec0,0x150a0,0x15a00,0x15bb0,0x14fb0,0x15190,0x15b70,0x15ca0,0x150a0,0x15280,0x15c60,0x15d90,0x15190,0x153f0,0x15d50,0x15e80
.long 0x14370,0x14550,0x14ec0,0x14f30,0x14460,0x14640,0x14fb0,0x15020,0x14550,0x14730,0x150a0,0x15110,0x14640,0x14820,0x15190,0x15200
.long 0x14730,0x14910,0x15280,0x15370,0x14820,0x14a00,0x153f0,0x15460,0x14910,0x14b70,0x154e0,0x15550,0x14a00,0x14c60,0x155d0,0x15640
.long 0x14b70,0x14d50,0x156c0,0x15730,0x14c60,0x14e40,0x157b0,0x15820,0x14d50,0x14f30,0x158a0,0x15910,0x14e40,0x15020,0x15990,0x15a00
.long 0x14f30,0x15110,0x15a80,0x15b70,0x15020,0x15200,0x15bf0,0x15c60,0x15110,0x15370,0x15ce0,0x15d50,0x15200,0x15460,0x15dd0,0x15e40
.long 0x143f0,0x145d0,0x14f30,0x14fb0,0x144e0,0x146c0,0x15020,0x150a0,0x145d0,0x147b0,0x15110,0x15190,0x146c0,0x148a0,0x15200,0x15280
.long 0x147b0,0x14990,0x15370,0x153f0,0x148a0,0x14a80,0x15460,0x154e0,0x14990,0x14bf0,0x15550,0x155d0,0x14a80,0x14ce0,0x15640,0x156c0
.long 0x14bf0,0x14dd0,0x15730,0x157b0,0x14ce0,0x14ec0,0x15820,0x158a0,0x14dd0,0x14fb0,0x15910,0x15990,0x14ec0,0x150a0,0x15a00,0x15a80
.long 0x14fb0,0x15190,0x15b70,0x15bf0,0x150a0,0x15280,0x15c60,0x15ce0,0x15190,0x153f0,0x15d50,0x15dd0,0x15280,0x154e0,0x15e40,0x15ec0
.long 0x190,0x190,0x190,0x190,0x180,0x180,0x180,0x180,0x1b0,0x1b0,0x1b0,0x1b0,0x1a0,0x1a0,0x1a0,0x1a0
.long 0x14210,0x14210,0x14210,0x14210,0x14200,0x14200,0x14200,0x14200,0x14230,0x14230,0x14230,0x14230,0x14220,0x14220,0x14220,0x14220
.long 0x28290,0x28290,0x28290,0x28290,0x28280,0x28280,0x28280,0x28280,0x282b0,0x282b0,0x282b0,0x282b0,0x282a0,0x282a0,0x282a0,0x282a0
.long 0x3c310,0x3c310,0x3c310,0x3c310,0x3c300,0x3c300,0x3c300,0x3c300,0x3c330,0x3c330,0x3c330,0x3c330,0x3c320,0x3c320,0x3c320,0x3c320
.long 0x50390,0x50390,0x50390,0x50390,0x50380,0x50380,0x50380,0x50380,0x503b0,0x503b0,0x503b0,0x503b0,0x503a0,0x503a0,0x503a0,0x503a0
.long 0x64410,0x64410,0x64410,0x64410,0x64400,0x64400,0x64400,0x64400,0x64430,0x64430,0x64430,0x64430,0x64420,0x64420,0x64420,0x64420
.long 0x78490,0x78490,0x78490,0x78490,0x78480,0x78480,0x78480,0x78480,0x784b0,0x784b0,0x784b0,0x784b0,0x784a0,0x784a0,0x784a0,0x784a0
.long 0x8c510,0x8c510,0x8c510,0x8c510,0x8c500,0x8c500,0x8c500,0x8c500,0x8c530,0x8c530,0x8c530,0x8c530,0x8c520,0x8c520,0x8c520,0x8c520
.long 0x1d0,0x1d0,0x1d0,0x1d0,0x1c0,0x1c0,0x1c0,0x1c0,0x1f0,0x1f0,0x1f0,0x1f0,0x1e0,0x1e0,0x1e0,0x1e0
.long 0x14250,0x14250,0x14250,0x14250,0x14240,0x14240,0x14240,0x14240,0x14270,0x14270,0x14270,0x14270,0x14260,0x14260,0x14260,0x14260
.long 0x282d0,0x282d0,0x282d0,0x282d0,0x282c0,0x282c0,0x282c0,0x282c0,0x282f0,0x282f0,0x282f0,0x282f0,0x282e0,0x282e0,0x282e0,0x282e0
.long 0x3c350,0x3c350,0x3c350,0x3c350,0x3c340,0x3c340,0x3c340,0x3c340,0x3c370,0x3c370,0x3c370,0x3c370,0x3c360,0x3c360,0x3c360,0x3c360
.long 0x503d0,0x503d0,0x503d0,0x503d0,0x503c0,0x503c0,0x503c0,0x503c0,0x503f0,0x503f0,0x503f0,0x503f0,0x503e0,0x503e0,0x503e0,0x503e0
.long 0x64450,0x64450,0x64450,0x64450,0x64440,0x64440,0x64440,0x64440,0x64470,0x64470,0x64470,0x64470,0x64460,0x64460,0x64460,0x64460
.long 0x784d0,0x784d0,0x784d0,0x784d0,0x784c0,0x784c0,0x784c0,0x784c0,0x784f0,0x784f0,0x784f0,0x784f0,0x784e0,0x784e0,0x784e0,0x784e0
.long 0x8c550,0x8c550,0x8c550,0x8c550,0x8c540,0x8c540,0x8c540,0x8c540,0x8c570,0x8c570,0x8c570,0x8c570,0x8c560,0x8c560,0x8c560,0x8c560
.long 0x0,0x0,0x3f800000,0x3f803f80,0x0,0x0,0x0,0x3f803f80,0x0,0x0,0x0,0x3f800000,0x0,0x0,0x0,0x0
.long 0x0,0x0,0x0,0x0,0x0,0x0,0x0,0x0,0x0,0x0,0x0,0x0,0x0,0x0,0x0,0x0
.long 0x0,0x0,0x0,0x0,0x0,0x0,0x0,0x0,0x0,0x0,0x0,0x0,0x0,0x0,0x0,0x0
.long 0x0,0x0,0x0,0x0,0x0,0x0,0x0,0x0,0x0,0x0,0x0,0x0,0x0,0x0,0x0,0x0
.long 0x3f803f80,0x3f803f80,0x0,0x0,0x3f803f80,0x3f803f80,0x3f80,0x0,0x3f803f80,0x3f803f80,0x3f803f80,0x0,0x3f803f80,0x3f803f80,0x3f803f80,0x3f80
.long 0x3f800000,0x3f803f80,0x3f803f80,0x3f803f80,0x0,0x3f803f80,0x3f803f80,0x3f803f80,0x0,0x3f800000,0x3f803f80,0x3f803f80,0x0,0x0,0x3f803f80,0x3f803f80
.long 0x0,0x0,0x3f800000,0x3f803f80,0x0,0x0,0x0,0x3f803f80,0x0,0x0,0x0,0x3f800000,0x0,0x0,0x0,0x0
.long 0x0,0x0,0x0,0x0,0x0,0x0,0x0,0x0,0x0,0x0,0x0,0x0,0x0,0x0,0x0,0x0
.long 0x0,0x0,0x0,0x0,0x0,0x0,0x0,0x0,0x0,0x0,0x0,0x0,0x0,0x0,0x0,0x0
.long 0x0,0x0,0x0,0x0,0x3f80,0x0,0x0,0x0,0x3f803f80,0x0,0x0,0x0,0x3f803f80,0x3f80,0x0,0x0
.long 0x3f803f80,0x3f803f80,0x0,0x0,0x3f803f80,0x3f803f80,0x3f80,0x0,0x3f803f80,0x3f803f80,0x3f803f80,0x0,0x3f803f80,0x3f803f80,0x3f803f80,0x3f80
.long 0x3f800000,0x3f803f80,0x3f803f80,0x3f803f80,0x0,0x3f803f80,0x3f803f80,0x3f803f80,0x0,0x3f800000,0x3f803f80,0x3f803f80,0x0,0x0,0x3f803f80,0x3f803f80
.long 0x0,0x0,0x0,0x0,0x0,0x0,0x0,0x0,0x0,0x0,0x0,0x0,0x0,0x0,0x0,0x0
.long 0x0,0x0,0x0,0x0,0x0,0x0,0x0,0x0,0x0,0x0,0x0,0x0,0x0,0x0,0x0,0x0
.long 0x0,0x0,0x0,0x0,0x0,0x0,0x0,0x0,0x0,0x0,0x0,0x0,0x0,0x0,0x0,0x0
.long 0x0,0x0,0x0,0x0,0x3f80,0x0,0x0,0x0,0x3f803f80,0x0,0x0,0x0,0x3f803f80,0x3f80,0x0,0x0
.long 0x0,0x0,0x3f803f80,0x3f803f80,0x0,0x0,0x3f800000,0x3f803f80,0x0,0x0,0x0,0x3f803f80,0x0,0x0,0x0,0x3f800000
.long 0x0,0x0,0x0,0x0,0x0,0x0,0x0,0x0,0x0,0x0,0x0,0x0,0x0,0x0,0x0,0x0
.long 0x0,0x0,0x0,0x0,0x0,0x0,0x0,0x0,0x0,0x0,0x0,0x0,0x0,0x0,0x0,0x0
.long 0x0,0x0,0x0,0x0,0x0,0x0,0x0,0x0,0x0,0x0,0x0,0x0,0x0,0x0,0x0,0x0
.long 0x3f803f80,0x3f803f80,0x3f80,0x0,0x3f803f80,0x3f803f80,0x3f803f80,0x0,0x3f803f80,0x3f803f80,0x3f803f80,0x3f80,0x3f803f80,0x3f803f80,0x3f803f80,0x3f803f80
.long 0x3f803f80,0x3f803f80,0x3f803f80,0x3f803f80,0x3f800000,0x3f803f80,0x3f803f80,0x3f803f80,0x0,0x3f803f80,0x3f803f80,0x3f803f80,0x0,0x3f800000,0x3f803f80,0x3f803f80
.long 0x0,0x0,0x3f803f80,0x3f803f80,0x0,0x0,0x3f800000,0x3f803f80,0x0,0x0,0x0,0x3f803f80,0x0,0x0,0x0,0x3f800000
.long 0x0,0x0,0x0,0x0,0x0,0x0,0x0,0x0,0x0,0x0,0x0,0x0,0x0,0x0,0x0,0x0
.long 0x0,0x0,0x0,0x0,0x0,0x0,0x0,0x0,0x0,0x0,0x0,0x0,0x0,0x0,0x0,0x0
.long 0x3f80,0x0,0x0,0x0,0x3f803f80,0x0,0x0,0x0,0x3f803f80,0x3f80,0x0,0x0,0x3f803f80,0x3f803f80,0x0,0x0
.long 0x3f803f80,0x3f803f80,0x3f80,0x0,0x3f803f80,0x3f803f80,0x3f803f80,0x0,0x3f803f80,0x3f803f80,0x3f803f80,0x3f80,0x3f803f80,0x3f803f80,0x3f803f80,0x3f803f80
.long 0x3f803f80,0x3f803f80,0x3f803f80,0x3f803f80,0x3f800000,0x3f803f80,0x3f803f80,0x3f803f80,0x0,0x3f803f80,0x3f803f80,0x3f803f80,0x0,0x3f800000,0x3f803f80,0x3f803f80
.long 0x0,0x0,0x0,0x0,0x0,0x0,0x0,0x0,0x0,0x0,0x0,0x0,0x0,0x0,0x0,0x0
.long 0x0,0x0,0x0,0x0,0x0,0x0,0x0,0x0,0x0,0x0,0x0,0x0,0x0,0x0,0x0,0x0
.long 0x0,0x0,0x0,0x0,0x0,0x0,0x0,0x0,0x0,0x0,0x0,0x0,0x0,0x0,0x0,0x0
.long 0x3f80,0x0,0x0,0x0,0x3f803f80,0x0,0x0,0x0,0x3f803f80,0x3f80,0x0,0x0,0x3f803f80,0x3f803f80,0x0,0x0
.long 0x0,0x10,0x20,0x30,0x8,0x18,0x28,0x38,0x40,0x50,0x60,0x70,0x48,0x58,0x68,0x78
.long 0x80,0x90,0xa0,0xb0,0x88,0x98,0xa8,0xb8,0xc0,0xd0,0xe0,0xf0,0xc8,0xd8,0xe8,0xf8
.long 0x110,0x100,0x130,0x120,0x118,0x108,0x138,0x128,0x150,0x140,0x170,0x160,0x158,0x148,0x178,0x168
.long 0x190,0x180,0x1b0,0x1a0,0x198,0x188,0x1b8,0x1a8,0x1d0,0x1c0,0x1f0,0x1e0,0x1d8,0x1c8,0x1f8,0x1e8
.long 0x220,0x230,0x200,0x210,0x228,0x238,0x208,0x218,0x260,0x270,0x240,0x250,0x268,0x278,0x248,0x258
.long 0x2a0,0x2b0,0x280,0x290,0x2a8,0x2b8,0x288,0x298,0x2e0,0x2f0,0x2c0,0x2d0,0x2e8,0x2f8,0x2c8,0x2d8
.long 0x330,0x320,0x310,0x300,0x338,0x328,0x318,0x308,0x370,0x360,0x350,0x340,0x378,0x368,0x358,0x348
.long 0x3b0,0x3a0,0x390,0x380,0x3b8,0x3a8,0x398,0x388,0x3f0,0x3e0,0x3d0,0x3c0,0x3f8,0x3e8,0x3d8,0x3c8
.long 0x400,0x410,0x420,0x430,0x408,0x418,0x428,0x438,0x440,0x450,0x460,0x470,0x448,0x458,0x468,0x478
.long 0x480,0x490,0x4a0,0x4b0,0x488,0x498,0x4a8,0x4b8,0x4c0,0x4d0,0x4e0,0x4f0,0x4c8,0x4d8,0x4e8,0x4f8
.long 0x510,0x500,0x530,0x520,0x518,0x508,0x538,0x528,0x550,0x540,0x570,0x560,0x558,0x548,0x578,0x568
.long 0x590,0x580,0x5b0,0x5a0,0x598,0x588,0x5b8,0x5a8,0x5d0,0x5c0,0x5f0,0x5e0,0x5d8,0x5c8,0x5f8,0x5e8
.long 0x620,0x630,0x600,0x610,0x628,0x638,0x608,0x618,0x660,0x670,0x640,0x650,0x668,0x678,0x648,0x658
.long 0x6a0,0x6b0,0x680,0x690,0x6a8,0x6b8,0x688,0x698,0x6e0,0x6f0,0x6c0,0x6d0,0x6e8,0x6f8,0x6c8,0x6d8
.long 0x730,0x720,0x710,0x700,0x738,0x728,0x718,0x708,0x770,0x760,0x750,0x740,0x778,0x768,0x758,0x748
.long 0x7b0,0x7a0,0x790,0x780,0x7b8,0x7a8,0x798,0x788,0x7f0,0x7e0,0x7d0,0x7c0,0x7f8,0x7e8,0x7d8,0x7c8
.long 0x1800,0x1010,0x0,0x900,0x1808,0x1018,0x8,0xc900,0x1840,0x1050,0x40,0x18900,0x1848,0x1058,0x48,0x24900
.long 0x1880,0x1090,0x80,0x30900,0x1888,0x1098,0x88,0x3c900,0x18c0,0x10d0,0xc0,0x7ffffff0,0x18c8,0x10d8,0xc8,0x7ffffff0
.long 0x1910,0x1100,0x110,0x900,0x1918,0x1108,0x118,0xc900,0x1950,0x1140,0x150,0x18900,0x1958,0x1148,0x158,0x24900
.long 0x1990,0x1180,0x190,0x30900,0x1998,0x1188,0x198,0x3c900,0x19d0,0x11c0,0x1d0,0x7ffffff0,0x19d8,0x11c8,0x1d8,0x7ffffff0
.long 0x1a20,0x1230,0x220,0x940,0x1a28,0x1238,0x228,0xc940,0x1a60,0x1270,0x260,0x18940,0x1a68,0x1278,0x268,0x24940
.long 0x1aa0,0x12b0,0x2a0,0x30940,0x1aa8,0x12b8,0x2a8,0x3c940,0x1ae0,0x12f0,0x2e0,0x7ffffff0,0x1ae8,0x12f8,0x2e8,0x7ffffff0
.long 0x1b30,0x1320,0x330,0x940,0x1b38,0x1328,0x338,0xc940,0x1b70,0x1360,0x370,0x18940,0x1b78,0x1368,0x378,0x24940
.long 0x1bb0,0x13a0,0x3b0,0x30940,0x1bb8,0x13a8,0x3b8,0x3c940,0x1bf0,0x13e0,0x3f0,0x7ffffff0,0x1bf8,0x13e8,0x3f8,0x7ffffff0
.long 0x1c00,0x1410,0x400,0x980,0x1c08,0x1418,0x408,0xc980,0x1c40,0x1450,0x440,0x18980,0x1c48,0x1458,0x448,0x24980
.long 0x1c80,0x1490,0x480,0x30980,0x1c88,0x1498,0x488,0x3c980,0x1cc0,0x14d0,0x4c0,0x7ffffff0,0x1cc8,0x14d8,0x4c8,0x7ffffff0
.long 0x1d10,0x1500,0x510,0x980,0x1d18,0x1508,0x518,0xc980,0x1d50,0x1540,0x550,0x18980,0x1d58,0x1548,0x558,0x24980
.long 0x1d90,0x1580,0x590,0x30980,0x1d98,0x1588,0x598,0x3c980,0x1dd0,0x15c0,0x5d0,0x7ffffff0,0x1dd8,0x15c8,0x5d8,0x7ffffff0
.long 0x1e20,0x1630,0x620,0x9c0,0x1e28,0x1638,0x628,0xc9c0,0x1e60,0x1670,0x660,0x189c0,0x1e68,0x1678,0x668,0x249c0
.long 0x1ea0,0x16b0,0x6a0,0x309c0,0x1ea8,0x16b8,0x6a8,0x3c9c0,0x1ee0,0x16f0,0x6e0,0x7ffffff0,0x1ee8,0x16f8,0x6e8,0x7ffffff0
.long 0x1f30,0x1720,0x730,0x9c0,0x1f38,0x1728,0x738,0xc9c0,0x1f70,0x1760,0x770,0x189c0,0x1f78,0x1768,0x778,0x249c0
.long 0x1fb0,0x17a0,0x7b0,0x309c0,0x1fb8,0x17a8,0x7b8,0x3c9c0,0x1ff0,0x17e0,0x7f0,0x7ffffff0,0x1ff8,0x17e8,0x7f8,0x7ffffff0
.long 0x60,0x5040,0x7ffffff0,0x0,0x560,0x5540,0x7ffffff0,0x10,0xa60,0x5a40,0x7ffffff0,0x20,0xf60,0x5f40,0x7ffffff0,0x30
.long 0x1460,0x6440,0x7ffffff0,0x40,0x1960,0x6940,0x7ffffff0,0x50,0x1e60,0x6e40,0x7ffffff0,0x60,0x2360,0x7340,0x7ffffff0,0x70
.long 0x2860,0x7840,0x7ffffff0,0x80,0x2d60,0x7d40,0x7ffffff0,0x90,0x3260,0x8240,0x7ffffff0,0xa0,0x3760,0x8740,0x7ffffff0,0xb0
.long 0x3c60,0x8c40,0x7ffffff0,0xc0,0x4160,0x9140,0x7ffffff0,0xd0,0x4660,0x9640,0x7ffffff0,0xe0,0x4b60,0x9b40,0x7ffffff0,0xf0
.long 0x68,0x5048,0x7ffffff0,0x400,0x568,0x5548,0x7ffffff0,0x410,0xa68,0x5a48,0x7ffffff0,0x420,0xf68,0x5f48,0x7ffffff0,0x430
.long 0x1468,0x6448,0x7ffffff0,0x440,0x1968,0x6948,0x7ffffff0,0x450,0x1e68,0x6e48,0x7ffffff0,0x460,0x2368,0x7348,0x7ffffff0,0x470
.long 0x2868,0x7848,0x7ffffff0,0x480,0x2d68,0x7d48,0x7ffffff0,0x490,0x3268,0x8248,0x7ffffff0,0x4a0,0x3768,0x8748,0x7ffffff0,0x4b0
.long 0x3c68,0x8c48,0x7ffffff0,0x4c0,0x4168,0x9148,0x7ffffff0,0x4d0,0x4668,0x9648,0x7ffffff0,0x4e0,0x4b68,0x9b48,0x7ffffff0,0x4f0
.long 0x70,0x5050,0x7ffffff0,0x800,0x570,0x5550,0x7ffffff0,0x810,0xa70,0x5a50,0x7ffffff0,0x820,0xf70,0x5f50,0x7ffffff0,0x830
.long 0x1470,0x6450,0x7ffffff0,0x840,0x1970,0x6950,0x7ffffff0,0x850,0x1e70,0x6e50,0x7ffffff0,0x860,0x2370,0x7350,0x7ffffff0,0x870
.long 0x2870,0x7850,0x7ffffff0,0x880,0x2d70,0x7d50,0x7ffffff0,0x890,0x3270,0x8250,0x7ffffff0,0x8a0,0x3770,0x8750,0x7ffffff0,0x8b0
.long 0x3c70,0x8c50,0x7ffffff0,0x8c0,0x4170,0x9150,0x7ffffff0,0x8d0,0x4670,0x9650,0x7ffffff0,0x8e0,0x4b70,0x9b50,0x7ffffff0,0x8f0
.long 0x78,0x5058,0x7ffffff0,0xc00,0x578,0x5558,0x7ffffff0,0xc10,0xa78,0x5a58,0x7ffffff0,0xc20,0xf78,0x5f58,0x7ffffff0,0xc30
.long 0x1478,0x6458,0x7ffffff0,0xc40,0x1978,0x6958,0x7ffffff0,0xc50,0x1e78,0x6e58,0x7ffffff0,0xc60,0x2378,0x7358,0x7ffffff0,0xc70
.long 0x2878,0x7858,0x7ffffff0,0xc80,0x2d78,0x7d58,0x7ffffff0,0xc90,0x3278,0x8258,0x7ffffff0,0xca0,0x3778,0x8758,0x7ffffff0,0xcb0
.long 0x3c78,0x8c58,0x7ffffff0,0xcc0,0x4178,0x9158,0x7ffffff0,0xcd0,0x4678,0x9658,0x7ffffff0,0xce0,0x4b78,0x9b58,0x7ffffff0,0xcf0
.long 0x1200,0x12000,0xc00,0x3000,0x1210,0x12010,0xc10,0x3010,0x1220,0x12020,0xc20,0x3020,0x1230,0x12030,0xc30,0x3030
.long 0x1240,0x12040,0xc40,0x3040,0x1250,0x12050,0xc50,0x3050,0x1260,0x12060,0xc60,0x3060,0x1270,0x12070,0xc70,0x3070
.long 0x1280,0x12080,0xc80,0x3080,0x1290,0x12090,0xc90,0x3090,0x12a0,0x120a0,0xca0,0x30a0,0x12b0,0x120b0,0xcb0,0x30b0
.long 0x12c0,0x120c0,0xcc0,0x30c0,0x12d0,0x120d0,0xcd0,0x30d0,0x12e0,0x120e0,0xce0,0x30e0,0x12f0,0x120f0,0xcf0,0x30f0
.long 0x1300,0x12200,0xd00,0x3100,0x1310,0x12210,0xd10,0x3110,0x1320,0x12220,0xd20,0x3120,0x1330,0x12230,0xd30,0x3130
.long 0x1340,0x12240,0xd40,0x3140,0x1350,0x12250,0xd50,0x3150,0x1360,0x12260,0xd60,0x3160,0x1370,0x12270,0xd70,0x3170
.long 0x1380,0x12280,0xd80,0x3180,0x1390,0x12290,0xd90,0x3190,0x13a0,0x122a0,0xda0,0x31a0,0x13b0,0x122b0,0xdb0,0x31b0
.long 0x13c0,0x122c0,0xdc0,0x31c0,0x13d0,0x122d0,0xdd0,0x31d0,0x13e0,0x122e0,0xde0,0x31e0,0x13f0,0x122f0,0xdf0,0x31f0
.long 0x19200,0x12400,0xe00,0x3200,0x19210,0x12410,0xe10,0x3210,0x19220,0x12420,0xe20,0x3220,0x19230,0x12430,0xe30,0x3230
.long 0x19240,0x12440,0xe40,0x3240,0x19250,0x12450,0xe50,0x3250,0x19260,0x12460,0xe60,0x3260,0x19270,0x12470,0xe70,0x3270
.long 0x19280,0x12480,0xe80,0x3280,0x19290,0x12490,0xe90,0x3290,0x192a0,0x124a0,0xea0,0x32a0,0x192b0,0x124b0,0xeb0,0x32b0
.long 0x192c0,0x124c0,0xec0,0x32c0,0x192d0,0x124d0,0xed0,0x32d0,0x192e0,0x124e0,0xee0,0x32e0,0x192f0,0x124f0,0xef0,0x32f0
.long 0x19300,0x12600,0xf00,0x3300,0x19310,0x12610,0xf10,0x3310,0x19320,0x12620,0xf20,0x3320,0x19330,0x12630,0xf30,0x3330
.long 0x19340,0x12640,0xf40,0x3340,0x19350,0x12650,0xf50,0x3350,0x19360,0x12660,0xf60,0x3360,0x19370,0x12670,0xf70,0x3370
.long 0x19380,0x12680,0xf80,0x3380,0x19390,0x12690,0xf90,0x3390,0x193a0,0x126a0,0xfa0,0x33a0,0x193b0,0x126b0,0xfb0,0x33b0
.long 0x193c0,0x126c0,0xfc0,0x33c0,0x193d0,0x126d0,0xfd0,0x33d0,0x193e0,0x126e0,0xfe0,0x33e0,0x193f0,0x126f0,0xff0,0x33f0
.size K_ctab, .-K_ctab
.section .rodata,"a"
.p2align 6
.amdhsa_kernel sequential_preLN__ssm_conv_s4__swiglu_ffn__prompt_kernel
  .amdhsa_next_free_vgpr 512
  .amdhsa_next_free_sgpr 102
  .amdhsa_accum_offset 256
  .amdhsa_group_segment_fixed_size 0
  .amdhsa_kernarg_size 128
  .amdhsa_user_sgpr_count 2
  .amdhsa_user_sgpr_kernarg_segment_ptr 1
  .amdhsa_system_sgpr_workgroup_id_x 1
.end_amdhsa_kernel
```
